```python
import torch

def _softmax(x, axis=-1):
    return torch.softmax(x, dim=axis)
def _gelu(x):
    return torch.nn.functional.gelu(x, approximate="tanh")
def _silu(x):
    return torch.nn.functional.silu(x)
def _sigmoid(x):
    return torch.sigmoid(x)
def _layernorm(x, axis=-1, eps=1e-5):
    m = x.mean(dim=axis, keepdim=True)
    v = x.var(dim=axis, keepdim=True, unbiased=False)
    return (x - m) / torch.sqrt(v + eps)
def _scatter_add(tgt, idx, src, axis=0):
    return tgt.clone().index_add_(axis, idx, src)
def _segment_sum(src, seg, n):
    out = torch.zeros((n,) + src.shape[1:], dtype=src.dtype)
    return out.index_add_(0, seg, src)
def _pad(x, pw):
    flat = tuple(v for pair in reversed(pw) for v in pair)
    return torch.nn.functional.pad(x, flat)

kernel_name = 'recurrent_scan__linear_kernel_hedgehog__dense_activation_mish__prompt'

def setup_inputs():

    _w = (lambda a: (lambda t: t.to(torch.bfloat16) if t.is_floating_point() else t)(torch.as_tensor(a)))
    def _A_setup():
        B, S, D, H = 1, 2048, 640, 32
        Dh = D // H
        return {
            "x": _w((lambda *s: torch.randn(*s, dtype=torch.bfloat16) * 0.05)(B, S, D)),
            "wqkv": _w((lambda *s: torch.randn(*s, dtype=torch.bfloat16) * 0.4)(D, 3 * D)),
            "w_phi": _w((lambda *s: torch.randn(*s, dtype=torch.bfloat16) * 0.4)(H, Dh, Dh) * (Dh ** -0.5)),
            "wo": _w((lambda *s: torch.randn(*s, dtype=torch.bfloat16) * 0.2)(D, D)),
        }
    _A_in = _A_setup()

    def _B_setup():
        B, S, D, F = 1, 2048, 640, 1728
        return {
            "x": _w((lambda *s: torch.randn(*s, dtype=torch.bfloat16) * 0.05)(B, S, D)),
            "w1": _w((lambda *s: torch.randn(*s, dtype=torch.bfloat16) * 0.4)(D, F) * (D ** -0.5)),
            "b1": _w((lambda *s: torch.randn(*s, dtype=torch.bfloat16) * 0.4)(F)),
            "w2": _w((lambda *s: torch.randn(*s, dtype=torch.bfloat16) * 0.1)(F, D) * (F ** -0.5)),
        }
    _B_in = _B_setup()

    return {
        "A_x": _A_in["x"],
        "A_wqkv": _A_in["wqkv"],
        "A_w_phi": _A_in["w_phi"],
        "A_wo": _A_in["wo"],
        "B_x": _B_in["x"],
        "B_w1": _B_in["w1"],
        "B_b1": _B_in["b1"],
        "B_w2": _B_in["w2"],
    }

def reference(A_x, A_wqkv, A_w_phi, A_wo, B_x, B_w1, B_b1, B_w2):
    def _A_ref(x, wqkv, w_phi, wo):
        B, S, D = x.shape
        H = 32; Dh = D // H
        qkv = (lambda x, *d: x.permute(*d))((x @ wqkv).reshape(B, S, 3, H, Dh), 2, 0, 3, 1, 4)
        q, k, v = qkv[0], qkv[1], qkv[2]
        pq = torch.einsum("bhsd,hdf->bhsf", q, w_phi)
        pk = torch.einsum("bhsd,hdf->bhsf", k, w_phi)
        phi_q = torch.concatenate([_softmax(pq, axis=-1), _softmax(-pq, axis=-1)], axis=-1)
        phi_k = torch.concatenate([_softmax(pk, axis=-1), _softmax(-pk, axis=-1)], axis=-1)
        kv = torch.einsum("bhsf,bhsd->bhfd", phi_k, v)
        z  = torch.einsum("bhsf->bhf", phi_k)
        num = torch.einsum("bhqf,bhfd->bhqd", phi_q, kv)
        den = torch.einsum("bhqf,bhf->bhq", phi_q, z)[..., None] + 1e-6
        o = num / den
        return (lambda x, *d: x.permute(*d))(o, 0, 2, 1, 3).reshape(B, S, D) @ wo

    def _B_ref(x, w1, b1, w2):
        h = torch.einsum("bsd,df->bsf", x, w1) + b1
        sp = torch.log1p(torch.exp(-torch.abs(h))) + torch.where(h > 0, h, torch.zeros_like(h))
        act = h * torch.tanh(sp)
        return torch.einsum("bsf,fd->bsd", act, w2)

    x = A_x
    xn = _layernorm(x, axis=-1)
    s = _A_ref(xn, A_wqkv, A_w_phi, A_wo)
    g = _silu(_B_ref(xn, B_w1, B_b1, B_w2))
    return x + s * g
```

```asm
; @launch kernel=k1_kernel grid=(256,1,1) block=(512,1,1) lds=157760
; @launch kernel=k2_kernel grid=(256,1,1) block=(512,1,1) lds=163840
.amdgcn_target "amdgcn-amd-amdhsa--gfx950"
.text
.globl k1_kernel
.p2align 8
.type k1_kernel,@function
k1_kernel:
  s_cmp_ge_u32 s2, 256
  s_cbranch_scc1 L_k1_end
  s_load_dwordx4 s[4:7], s[0:1], 0
  s_load_dwordx2 s[8:9], s[0:1], 16
  s_load_dwordx4 s[12:15], s[0:1], 40
  s_load_dwordx4 s[16:19], s[0:1], 72
  s_load_dwordx2 s[88:89], s[0:1], 24
  s_load_dwordx2 s[90:91], s[0:1], 56
  s_bfe_u32 s40, s2, 0x10002
  s_lshl_b32 s40, s40, 3
  s_bfe_u32 s46, s2, 0x30003
  s_add_u32 s40, s40, s46
  s_lshr_b32 s41, s2, 6
  s_lshl_b32 s41, s41, 2
  s_and_b32 s46, s2, 3
  s_add_u32 s41, s41, s46
  v_and_b32 v1, 63, v0
  v_and_b32 v2, 15, v0
  v_bfe_u32 v3, v0, 4, 2
  v_and_b32 v16, 31, v0
  v_bfe_u32 v17, v0, 5, 1
  v_lshrrev_b32 v22, 6, v0
  s_nop 0
  v_readfirstlane_b32 s42, v22
  s_nop 0
  s_and_b32 s43, s42, 3
  s_lshr_b32 s44, s42, 2
  s_mov_b32 s48, 0x3fb8aa3b
  v_mov_b32 v20, 0x3f803f80
  s_waitcnt lgkmcnt(0)
  s_mov_b32 s20, s4
  s_and_b32 s21, s5, 0xffff
  s_mov_b32 s22, 0x280000
  s_mov_b32 s23, 0x20000
  s_mov_b32 s28, s18
  s_and_b32 s29, s19, 0xffff
  s_mov_b32 s30, 0x11bd000
  s_mov_b32 s31, 0x20000
  s_mov_b32 s36, s16
  s_and_b32 s37, s17, 0xffff
  s_mov_b32 s38, 0x100
  s_mov_b32 s39, 0x20000
  s_cmp_ge_u32 s41, 8
  s_cbranch_scc1 L_k1_ffn
  s_mov_b32 s24, s6
  s_and_b32 s25, s7, 0xffff
  s_mov_b32 s26, 0x258000
  s_mov_b32 s27, 0x20000
  v_mul_u32_u24 v200, 3277, v1
  v_lshrrev_b32 v200, 16, v200
  v_mul_u32_u24 v201, 20, v200
  v_sub_u32 v201, v1, v201
  v_add_u32 v202, 1, v200
  v_cmp_eq_u32 vcc, 2, v200
  s_nop 1
  v_cndmask_b32 v202, v202, 0, vcc
  v_mul_u32_u24 v202, 1280, v202
  v_lshl_add_u32 v236, v201, 3, v202
  s_mul_i32 s54, s41, 160
  v_add_u32 v236, s54, v236
  v_mov_b32 v237, 0x7ffffff0
  v_cmp_gt_u32 vcc, 60, v1
  s_nop 1
  v_cndmask_b32 v236, v237, v236, vcc
  s_mul_i32 s46, s40, 40
  s_mul_i32 s54, s42, 5
  s_add_u32 s46, s46, s54
  s_mul_i32 s46, s46, 3840
  buffer_load_dwordx2 v[224:225], v236, s[24:27], s46 offen
  s_add_u32 s46, s46, 3840
  buffer_load_dwordx2 v[226:227], v236, s[24:27], s46 offen
  s_add_u32 s46, s46, 3840
  buffer_load_dwordx2 v[228:229], v236, s[24:27], s46 offen
  s_add_u32 s46, s46, 3840
  buffer_load_dwordx2 v[230:231], v236, s[24:27], s46 offen
  s_add_u32 s46, s46, 3840
  buffer_load_dwordx2 v[232:233], v236, s[24:27], s46 offen
  s_lshl_b32 s46, s42, 7
  v_add_u32 v200, s46, v1
  v_lshrrev_b32 v201, 3, v200
  v_bfe_u32 v202, v200, 4, 3
  v_and_b32 v200, 7, v200
  v_xor_b32 v200, v200, v202
  v_mul_u32_u24 v201, 1280, v201
  v_lshl_add_u32 v8, v200, 4, v201
  v_add_u32 v200, s46, v1
  v_add_u32 v200, 64, v200
  v_lshrrev_b32 v201, 3, v200
  v_bfe_u32 v202, v200, 4, 3
  v_and_b32 v200, 7, v200
  v_xor_b32 v200, v200, v202
  v_mul_u32_u24 v201, 1280, v201
  v_lshl_add_u32 v9, v200, 4, v201
  s_mul_i32 s49, s40, 163840
  s_lshl_b32 s47, s42, 11
  v_bfe_u32 v200, v16, 1, 3
  v_xor_b32 v200, v200, v17
  v_lshlrev_b32 v200, 4, v200
  v_lshl_add_u32 v200, v16, 7, v200
  s_lshl_b32 s46, s43, 12
  s_add_u32 s46, s46, 92160
  v_xor_b32 v201, 0, v200
  v_add_u32 v10, s46, v201
  v_xor_b32 v201, 32, v200
  v_add_u32 v11, s46, v201
  v_xor_b32 v201, 64, v200
  v_add_u32 v12, s46, v201
  v_xor_b32 v201, 96, v200
  v_add_u32 v13, s46, v201
  s_add_u32 s50, s49, 0
  s_add_u32 m0, s47, 92160
  s_nop 0
  buffer_load_dwordx4 v8, s[20:23], s50 offen lds
  s_add_u32 m0, s47, 93184
  s_nop 0
  buffer_load_dwordx4 v9, s[20:23], s50 offen lds
  s_mul_i32 s46, s42, 120
  s_mul_i32 s54, s41, 160
  v_add_u32 v200, s46, v1
  v_mul_u32_u24 v201, 2185, v200
  v_lshrrev_b32 v201, 16, v201
  v_mul_u32_u24 v202, 30, v201
  v_sub_u32 v202, v200, v202
  v_mul_u32_u24 v205, 6554, v202
  v_lshrrev_b32 v205, 16, v205
  v_mul_u32_u24 v207, 10, v205
  v_sub_u32 v207, v202, v207
  v_and_b32 v203, 24, v201
  v_and_b32 v204, 1, v201
  v_lshl_or_b32 v203, v204, 2, v203
  v_bfe_u32 v204, v201, 1, 2
  v_or_b32 v203, v203, v204
  v_mul_u32_u24 v203, 3840, v203
  v_lshl_add_u32 v203, v207, 4, v203
  v_add_u32 v206, 1, v205
  v_cmp_gt_u32 vcc, 2, v205
  s_nop 1
  v_cndmask_b32 v206, 0, v206, vcc
  v_mul_u32_u24 v206, 1280, v206
  v_add3_u32 v4, s54, v203, v206
  v_add_u32 v200, s46, v1
  v_add_u32 v200, 64, v200
  v_mul_u32_u24 v201, 2185, v200
  v_lshrrev_b32 v201, 16, v201
  v_mul_u32_u24 v202, 30, v201
  v_sub_u32 v202, v200, v202
  v_mul_u32_u24 v205, 6554, v202
  v_lshrrev_b32 v205, 16, v205
  v_mul_u32_u24 v207, 10, v205
  v_sub_u32 v207, v202, v207
  v_and_b32 v203, 24, v201
  v_and_b32 v204, 1, v201
  v_lshl_or_b32 v203, v204, 2, v203
  v_bfe_u32 v204, v201, 1, 2
  v_or_b32 v203, v203, v204
  v_mul_u32_u24 v203, 3840, v203
  v_lshl_add_u32 v203, v207, 4, v203
  v_add_u32 v206, 1, v205
  v_cmp_gt_u32 vcc, 2, v205
  s_nop 1
  v_cndmask_b32 v206, 0, v206, vcc
  v_mul_u32_u24 v206, 1280, v206
  v_add3_u32 v5, s54, v203, v206
  s_mul_i32 s45, s42, 1920
  s_mov_b32 s50, 0
  s_add_u32 m0, s45, 0
  s_nop 0
  buffer_load_dwordx4 v4, s[24:27], s50 offen lds
  s_add_u32 m0, s45, 1024
  s_mov_b32 exec_hi, 0xffffff
  buffer_load_dwordx4 v5, s[24:27], s50 offen lds
  s_mov_b64 exec, -1
  s_mov_b32 s50, 122880
  s_add_u32 m0, s45, 15360
  s_nop 0
  buffer_load_dwordx4 v4, s[24:27], s50 offen lds
  s_add_u32 m0, s45, 16384
  s_mov_b32 exec_hi, 0xffffff
  buffer_load_dwordx4 v5, s[24:27], s50 offen lds
  s_mov_b64 exec, -1
  s_add_u32 s50, s49, 128
  s_add_u32 m0, s47, 108544
  s_nop 0
  buffer_load_dwordx4 v8, s[20:23], s50 offen lds
  s_add_u32 m0, s47, 109568
  s_nop 0
  buffer_load_dwordx4 v9, s[20:23], s50 offen lds
  s_mov_b32 s32, s8
  s_and_b32 s33, s9, 0xffff
  s_mov_b32 s34, 0x6400
  s_mov_b32 s35, 0x20000
  s_mov_b32 s50, 245760
  s_add_u32 m0, s45, 30720
  s_nop 0
  buffer_load_dwordx4 v4, s[24:27], s50 offen lds
  s_add_u32 m0, s45, 31744
  s_mov_b32 exec_hi, 0xffffff
  buffer_load_dwordx4 v5, s[24:27], s50 offen lds
  s_mov_b64 exec, -1
  v_bfe_u32 v200, v1, 2, 2
  v_lshlrev_b32 v200, 1, v200
  v_lshl_add_u32 v200, v17, 3, v200
  v_mul_u32_u24 v200, 480, v200
  v_and_b32 v201, 1, v3
  v_lshl_add_u32 v200, v201, 5, v200
  v_and_b32 v201, 3, v1
  v_lshl_add_u32 v6, v201, 3, v200
  s_lshl_b32 s46, s44, 8
  v_add_u32 v6, s46, v6
  v_add_u32 v7, 46080, v6
  v_mov_b32 v200, 157696
  v_mov_b32 v201, 0
  ds_write_b32 v200, v201
  s_waitcnt lgkmcnt(0)
  s_cmp_eq_u32 s44, 1
  s_cbranch_scc1 L_att_B
  s_waitcnt vmcnt(4)
  s_barrier
  ds_read_b128 v[104:107], v10 offset:0
  ds_read_b128 v[108:111], v11 offset:0
  ds_read_b128 v[112:115], v12 offset:0
  ds_read_b128 v[116:119], v13 offset:0
  s_mov_b32 s50, 368640
  s_add_u32 m0, s45, 46080
  s_nop 0
  buffer_load_dwordx4 v4, s[24:27], s50 offen lds
  s_add_u32 m0, s45, 47104
  s_mov_b32 exec_hi, 0xffffff
  buffer_load_dwordx4 v5, s[24:27], s50 offen lds
  s_mov_b64 exec, -1
  ds_read_b64_tr_b16 v[24:25], v6 offset:0
  ds_read_b64_tr_b16 v[26:27], v6 offset:480
  ds_read_b64_tr_b16 v[28:29], v6 offset:64
  ds_read_b64_tr_b16 v[30:31], v6 offset:544
  ds_read_b64_tr_b16 v[32:33], v6 offset:128
  ds_read_b64_tr_b16 v[34:35], v6 offset:608
  ds_read_b64_tr_b16 v[36:37], v6 offset:192
  ds_read_b64_tr_b16 v[38:39], v6 offset:672
  s_waitcnt lgkmcnt(6)
  v_mfma_f32_32x32x16_bf16 v[40:55], v[24:27], v[104:107], 0
  v_lshlrev_b32 v244, 16, v224
  v_and_b32 v245, 0xffff0000, v224
  v_lshlrev_b32 v246, 16, v225
  ds_read_b64_tr_b16 v[24:25], v6 offset:7680
  ds_read_b64_tr_b16 v[26:27], v6 offset:8160
  s_waitcnt lgkmcnt(6)
  v_mfma_f32_32x32x16_bf16 v[56:71], v[28:31], v[104:107], 0
  s_mov_b32 s50, 491520
  s_add_u32 m0, s45, 61440
  s_nop 0
  buffer_load_dwordx4 v4, s[24:27], s50 offen lds
  s_add_u32 m0, s45, 62464
  s_mov_b32 exec_hi, 0xffffff
  buffer_load_dwordx4 v5, s[24:27], s50 offen lds
  s_mov_b64 exec, -1
  s_add_u32 s50, s49, 256
  s_add_u32 m0, s47, 124928
  s_nop 0
  buffer_load_dwordx4 v8, s[20:23], s50 offen lds
  s_add_u32 m0, s47, 125952
  s_nop 0
  buffer_load_dwordx4 v9, s[20:23], s50 offen lds
  v_and_b32 v247, 0xffff0000, v225
  v_lshlrev_b32 v238, 16, v226
  v_and_b32 v239, 0xffff0000, v226
  v_add_f32 v244, v244, v238
  ds_read_b64_tr_b16 v[28:29], v6 offset:7744
  ds_read_b64_tr_b16 v[30:31], v6 offset:8224
  s_waitcnt lgkmcnt(6)
  v_mfma_f32_32x32x16_bf16 v[72:87], v[32:35], v[104:107], 0
  v_add_f32 v245, v245, v239
  v_lshlrev_b32 v238, 16, v227
  v_and_b32 v239, 0xffff0000, v227
  v_add_f32 v246, v246, v238
  ds_read_b64_tr_b16 v[32:33], v6 offset:7808
  ds_read_b64_tr_b16 v[34:35], v6 offset:8288
  s_waitcnt lgkmcnt(6)
  v_mfma_f32_32x32x16_bf16 v[88:103], v[36:39], v[104:107], 0
  v_add_f32 v247, v247, v239
  v_lshlrev_b32 v238, 16, v228
  v_and_b32 v239, 0xffff0000, v228
  v_add_f32 v244, v244, v238
  ds_read_b64_tr_b16 v[36:37], v6 offset:7872
  ds_read_b64_tr_b16 v[38:39], v6 offset:8352
  s_waitcnt lgkmcnt(6)
  v_mfma_f32_32x32x16_bf16 v[40:55], v[24:27], v[108:111], v[40:55]
  v_add_f32 v245, v245, v239
  v_lshlrev_b32 v238, 16, v229
  v_and_b32 v239, 0xffff0000, v229
  v_add_f32 v246, v246, v238
  ds_read_b64_tr_b16 v[24:25], v6 offset:15360
  ds_read_b64_tr_b16 v[26:27], v6 offset:15840
  s_waitcnt lgkmcnt(6)
  v_mfma_f32_32x32x16_bf16 v[56:71], v[28:31], v[108:111], v[56:71]
  v_add_f32 v247, v247, v239
  v_lshlrev_b32 v238, 16, v230
  v_and_b32 v239, 0xffff0000, v230
  v_add_f32 v244, v244, v238
  ds_read_b64_tr_b16 v[28:29], v6 offset:15424
  ds_read_b64_tr_b16 v[30:31], v6 offset:15904
  s_waitcnt lgkmcnt(6)
  v_mfma_f32_32x32x16_bf16 v[72:87], v[32:35], v[108:111], v[72:87]
  v_add_f32 v245, v245, v239
  v_lshlrev_b32 v238, 16, v231
  v_and_b32 v239, 0xffff0000, v231
  v_add_f32 v246, v246, v238
  ds_read_b64_tr_b16 v[32:33], v6 offset:15488
  ds_read_b64_tr_b16 v[34:35], v6 offset:15968
  s_waitcnt lgkmcnt(6)
  v_mfma_f32_32x32x16_bf16 v[88:103], v[36:39], v[108:111], v[88:103]
  v_add_f32 v247, v247, v239
  v_lshlrev_b32 v238, 16, v232
  v_and_b32 v239, 0xffff0000, v232
  v_add_f32 v244, v244, v238
  ds_read_b64_tr_b16 v[36:37], v6 offset:15552
  ds_read_b64_tr_b16 v[38:39], v6 offset:16032
  s_waitcnt lgkmcnt(6)
  v_mfma_f32_32x32x16_bf16 v[40:55], v[24:27], v[112:115], v[40:55]
  v_add_f32 v245, v245, v239
  v_lshlrev_b32 v238, 16, v233
  v_and_b32 v239, 0xffff0000, v233
  v_add_f32 v246, v246, v238
  ds_read_b64_tr_b16 v[24:25], v6 offset:23040
  ds_read_b64_tr_b16 v[26:27], v6 offset:23520
  s_waitcnt lgkmcnt(6)
  v_mfma_f32_32x32x16_bf16 v[56:71], v[28:31], v[112:115], v[56:71]
  v_add_f32 v247, v247, v239
  s_lshl_b32 s62, s42, 10
  s_add_u32 s62, s62, 141312
  v_lshlrev_b32 v238, 4, v1
  ds_read_b64_tr_b16 v[28:29], v6 offset:23104
  ds_read_b64_tr_b16 v[30:31], v6 offset:23584
  s_waitcnt lgkmcnt(6)
  v_mfma_f32_32x32x16_bf16 v[72:87], v[32:35], v[112:115], v[72:87]
  v_add_u32 v238, s62, v238
  ds_write_b128 v238, v[244:247]
  v_add_u32 v200, 0, v0
  v_mul_u32_u24 v201, 2731, v200
  ds_read_b64_tr_b16 v[32:33], v6 offset:23168
  ds_read_b64_tr_b16 v[34:35], v6 offset:23648
  s_waitcnt lgkmcnt(7)
  v_mfma_f32_32x32x16_bf16 v[88:103], v[36:39], v[112:115], v[88:103]
  v_lshrrev_b32 v201, 16, v201
  v_mul_u32_u24 v202, 24, v201
  v_sub_u32 v202, v200, v202
  v_mul_u32_u24 v203, 3277, v201
  ds_read_b64_tr_b16 v[36:37], v6 offset:23232
  ds_read_b64_tr_b16 v[38:39], v6 offset:23712
  s_waitcnt lgkmcnt(7)
  v_mfma_f32_32x32x16_bf16 v[40:55], v[24:27], v[116:119], v[40:55]
  v_lshrrev_b32 v203, 16, v203
  v_mul_u32_u24 v204, 20, v203
  v_sub_u32 v204, v201, v204
  v_lshrrev_b32 v205, 1, v202
  s_waitcnt vmcnt(4) lgkmcnt(4)
  s_barrier
  ds_read_b128 v[120:123], v10 offset:16384
  ds_read_b128 v[124:127], v11 offset:16384
  ds_read_b128 v[128:131], v12 offset:16384
  ds_read_b128 v[132:135], v13 offset:16384
  s_mov_b32 s50, 614400
  s_add_u32 m0, s45, 76800
  s_nop 0
  buffer_load_dwordx4 v4, s[24:27], s50 offen lds
  s_add_u32 m0, s45, 77824
  s_mov_b32 exec_hi, 0xffffff
  buffer_load_dwordx4 v5, s[24:27], s50 offen lds
  s_mov_b64 exec, -1
  ds_read_b64_tr_b16 v[24:25], v6 offset:30720
  ds_read_b64_tr_b16 v[26:27], v6 offset:31200
  v_mfma_f32_32x32x16_bf16 v[56:71], v[28:31], v[116:119], v[56:71]
  v_lshlrev_b32 v205, 2, v205
  v_and_b32 v206, 1, v202
  v_lshlrev_b32 v206, 1, v206
  v_cmp_lt_u32 vcc, 19, v205
  ds_read_b64_tr_b16 v[28:29], v6 offset:30784
  ds_read_b64_tr_b16 v[30:31], v6 offset:31264
  s_waitcnt lgkmcnt(10)
  v_mfma_f32_32x32x16_bf16 v[72:87], v[32:35], v[116:119], v[72:87]
  v_addc_co_u32 v206, vcc, 0, v206, vcc
  v_cmp_lt_u32 vcc, 19, v205
  v_subrev_u32 v208, 20, v205
  s_nop 0
  v_cndmask_b32 v208, v205, v208, vcc
  ds_read_b64_tr_b16 v[32:33], v6 offset:30848
  ds_read_b64_tr_b16 v[34:35], v6 offset:31328
  s_waitcnt lgkmcnt(10)
  v_mfma_f32_32x32x16_bf16 v[88:103], v[36:39], v[116:119], v[88:103]
  v_mul_u32_u24 v207, 800, v203
  v_mul_u32_u24 v204, 40, v204
  v_add_u32 v207, v207, v204
  v_lshl_add_u32 v207, v208, 1, v207
  ds_read_b64_tr_b16 v[36:37], v6 offset:30912
  ds_read_b64_tr_b16 v[38:39], v6 offset:31392
  s_waitcnt lgkmcnt(6)
  v_mfma_f32_32x32x16_bf16 v[40:55], v[24:27], v[120:123], v[40:55]
  v_mov_b32 v204, 0x7ffffff0
  v_cmp_eq_u32 vcc, v206, v203
  s_nop 1
  v_cndmask_b32 v207, v204, v207, vcc
  v_cmp_gt_u32 vcc, 40, v205
  ds_read_b64_tr_b16 v[24:25], v6 offset:38400
  ds_read_b64_tr_b16 v[26:27], v6 offset:38880
  s_waitcnt lgkmcnt(6)
  v_mfma_f32_32x32x16_bf16 v[56:71], v[28:31], v[120:123], v[56:71]
  s_mov_b32 s50, 737280
  s_add_u32 m0, s45, 0
  s_nop 0
  buffer_load_dwordx4 v4, s[24:27], s50 offen lds
  s_add_u32 m0, s45, 1024
  s_mov_b32 exec_hi, 0xffffff
  buffer_load_dwordx4 v5, s[24:27], s50 offen lds
  s_mov_b64 exec, -1
  s_add_u32 s50, s49, 384
  s_add_u32 m0, s47, 92160
  s_nop 0
  buffer_load_dwordx4 v8, s[20:23], s50 offen lds
  s_add_u32 m0, s47, 93184
  s_nop 0
  buffer_load_dwordx4 v9, s[20:23], s50 offen lds
  v_cndmask_b32 v207, v204, v207, vcc
  s_mul_i32 s85, s41, 3200
  buffer_load_dwordx2 v[184:185], v207, s[32:35], s85 offen
  v_lshlrev_b32 v192, 3, v200
  ds_read_b64_tr_b16 v[28:29], v6 offset:38464
  ds_read_b64_tr_b16 v[30:31], v6 offset:38944
  s_waitcnt lgkmcnt(6)
  v_mfma_f32_32x32x16_bf16 v[72:87], v[32:35], v[120:123], v[72:87]
  v_add_u32 v192, 141312, v192
  v_add_u32 v200, 512, v0
  v_mul_u32_u24 v201, 2731, v200
  v_lshrrev_b32 v201, 16, v201
  ds_read_b64_tr_b16 v[32:33], v6 offset:38528
  ds_read_b64_tr_b16 v[34:35], v6 offset:39008
  s_waitcnt lgkmcnt(6)
  v_mfma_f32_32x32x16_bf16 v[88:103], v[36:39], v[120:123], v[88:103]
  v_mul_u32_u24 v202, 24, v201
  v_sub_u32 v202, v200, v202
  v_mul_u32_u24 v203, 3277, v201
  v_lshrrev_b32 v203, 16, v203
  ds_read_b64_tr_b16 v[36:37], v6 offset:38592
  ds_read_b64_tr_b16 v[38:39], v6 offset:39072
  s_waitcnt lgkmcnt(6)
  v_mfma_f32_32x32x16_bf16 v[40:55], v[24:27], v[124:127], v[40:55]
  v_mul_u32_u24 v204, 20, v203
  v_sub_u32 v204, v201, v204
  v_lshrrev_b32 v205, 1, v202
  v_lshlrev_b32 v205, 2, v205
  ds_read_b64_tr_b16 v[24:25], v7 offset:0
  ds_read_b64_tr_b16 v[26:27], v7 offset:480
  s_waitcnt lgkmcnt(6)
  v_mfma_f32_32x32x16_bf16 v[56:71], v[28:31], v[124:127], v[56:71]
  v_and_b32 v206, 1, v202
  v_lshlrev_b32 v206, 1, v206
  v_cmp_lt_u32 vcc, 19, v205
  s_nop 1
  v_addc_co_u32 v206, vcc, 0, v206, vcc
  ds_read_b64_tr_b16 v[28:29], v7 offset:64
  ds_read_b64_tr_b16 v[30:31], v7 offset:544
  s_waitcnt lgkmcnt(6)
  v_mfma_f32_32x32x16_bf16 v[72:87], v[32:35], v[124:127], v[72:87]
  v_cmp_lt_u32 vcc, 19, v205
  v_subrev_u32 v208, 20, v205
  s_nop 0
  v_cndmask_b32 v208, v205, v208, vcc
  v_mul_u32_u24 v207, 800, v203
  ds_read_b64_tr_b16 v[32:33], v7 offset:128
  ds_read_b64_tr_b16 v[34:35], v7 offset:608
  s_waitcnt lgkmcnt(6)
  v_mfma_f32_32x32x16_bf16 v[88:103], v[36:39], v[124:127], v[88:103]
  v_mul_u32_u24 v204, 40, v204
  v_add_u32 v207, v207, v204
  v_lshl_add_u32 v207, v208, 1, v207
  v_mov_b32 v204, 0x7ffffff0
  ds_read_b64_tr_b16 v[36:37], v7 offset:192
  ds_read_b64_tr_b16 v[38:39], v7 offset:672
  s_waitcnt lgkmcnt(6)
  v_mfma_f32_32x32x16_bf16 v[40:55], v[24:27], v[128:131], v[40:55]
  v_cmp_eq_u32 vcc, v206, v203
  s_nop 1
  v_cndmask_b32 v207, v204, v207, vcc
  v_cmp_gt_u32 vcc, 40, v205
  s_nop 1
  v_cndmask_b32 v207, v204, v207, vcc
  ds_read_b64_tr_b16 v[24:25], v7 offset:7680
  ds_read_b64_tr_b16 v[26:27], v7 offset:8160
  s_waitcnt lgkmcnt(6)
  v_mfma_f32_32x32x16_bf16 v[56:71], v[28:31], v[128:131], v[56:71]
  s_mul_i32 s85, s41, 3200
  buffer_load_dwordx2 v[186:187], v207, s[32:35], s85 offen
  v_lshlrev_b32 v193, 3, v200
  v_add_u32 v193, 141312, v193
  ds_read_b64_tr_b16 v[28:29], v7 offset:7744
  ds_read_b64_tr_b16 v[30:31], v7 offset:8224
  s_waitcnt lgkmcnt(6)
  v_mfma_f32_32x32x16_bf16 v[72:87], v[32:35], v[128:131], v[72:87]
  v_add_u32 v200, 1024, v0
  v_mul_u32_u24 v201, 2731, v200
  v_lshrrev_b32 v201, 16, v201
  v_mul_u32_u24 v202, 24, v201
  ds_read_b64_tr_b16 v[32:33], v7 offset:7808
  ds_read_b64_tr_b16 v[34:35], v7 offset:8288
  s_waitcnt lgkmcnt(6)
  v_mfma_f32_32x32x16_bf16 v[88:103], v[36:39], v[128:131], v[88:103]
  v_sub_u32 v202, v200, v202
  v_mul_u32_u24 v203, 3277, v201
  v_lshrrev_b32 v203, 16, v203
  v_mul_u32_u24 v204, 20, v203
  ds_read_b64_tr_b16 v[36:37], v7 offset:7872
  ds_read_b64_tr_b16 v[38:39], v7 offset:8352
  s_waitcnt lgkmcnt(6)
  v_mfma_f32_32x32x16_bf16 v[40:55], v[24:27], v[132:135], v[40:55]
  v_sub_u32 v204, v201, v204
  v_lshrrev_b32 v205, 1, v202
  v_lshlrev_b32 v205, 2, v205
  v_and_b32 v206, 1, v202
  s_waitcnt vmcnt(6)
  s_barrier
  ds_read_b128 v[104:107], v10 offset:32768
  ds_read_b128 v[108:111], v11 offset:32768
  ds_read_b128 v[112:115], v12 offset:32768
  ds_read_b128 v[116:119], v13 offset:32768
  s_mov_b32 s50, 860160
  s_add_u32 m0, s45, 15360
  s_nop 0
  buffer_load_dwordx4 v4, s[24:27], s50 offen lds
  s_add_u32 m0, s45, 16384
  s_mov_b32 exec_hi, 0xffffff
  buffer_load_dwordx4 v5, s[24:27], s50 offen lds
  s_mov_b64 exec, -1
  ds_read_b64_tr_b16 v[24:25], v7 offset:15360
  ds_read_b64_tr_b16 v[26:27], v7 offset:15840
  s_waitcnt lgkmcnt(10)
  v_mfma_f32_32x32x16_bf16 v[56:71], v[28:31], v[132:135], v[56:71]
  v_lshlrev_b32 v206, 1, v206
  v_cmp_lt_u32 vcc, 19, v205
  s_nop 1
  v_addc_co_u32 v206, vcc, 0, v206, vcc
  v_cmp_lt_u32 vcc, 19, v205
  ds_read_b64_tr_b16 v[28:29], v7 offset:15424
  ds_read_b64_tr_b16 v[30:31], v7 offset:15904
  s_waitcnt lgkmcnt(10)
  v_mfma_f32_32x32x16_bf16 v[72:87], v[32:35], v[132:135], v[72:87]
  v_subrev_u32 v208, 20, v205
  v_cndmask_b32 v208, v205, v208, vcc
  v_mul_u32_u24 v207, 800, v203
  v_mul_u32_u24 v204, 40, v204
  ds_read_b64_tr_b16 v[32:33], v7 offset:15488
  ds_read_b64_tr_b16 v[34:35], v7 offset:15968
  s_waitcnt lgkmcnt(10)
  v_mfma_f32_32x32x16_bf16 v[88:103], v[36:39], v[132:135], v[88:103]
  v_add_u32 v207, v207, v204
  v_lshl_add_u32 v207, v208, 1, v207
  v_mov_b32 v204, 0x7ffffff0
  v_cmp_eq_u32 vcc, v206, v203
  s_lshl_b32 s46, s43, 8
  s_add_u32 s46, s46, 141312
  v_lshlrev_b32 v144, 2, v1
  v_add_u32 v145, s46, v144
  ds_read_b32 v136, v145 offset:0
  ds_read_b32 v137, v145 offset:1024
  ds_read_b32 v138, v145 offset:2048
  ds_read_b32 v139, v145 offset:3072
  ds_read_b32 v140, v145 offset:4096
  ds_read_b32 v141, v145 offset:5120
  ds_read_b32 v142, v145 offset:6144
  ds_read_b32 v143, v145 offset:7168
  ds_read_b64_tr_b16 v[36:37], v7 offset:15552
  ds_read_b64_tr_b16 v[38:39], v7 offset:16032
  s_waitcnt lgkmcnt(14)
  v_mfma_f32_32x32x16_bf16 v[40:55], v[24:27], v[104:107], v[40:55]
  v_cndmask_b32 v207, v204, v207, vcc
  v_cmp_gt_u32 vcc, 40, v205
  s_nop 1
  v_cndmask_b32 v207, v204, v207, vcc
  s_mul_i32 s85, s41, 3200
  ds_read_b64_tr_b16 v[24:25], v7 offset:23040
  ds_read_b64_tr_b16 v[26:27], v7 offset:23520
  s_waitcnt lgkmcnt(14)
  v_mfma_f32_32x32x16_bf16 v[56:71], v[28:31], v[104:107], v[56:71]
  s_mov_b32 s50, 983040
  s_add_u32 m0, s45, 30720
  s_nop 0
  buffer_load_dwordx4 v4, s[24:27], s50 offen lds
  s_add_u32 m0, s45, 31744
  s_mov_b32 exec_hi, 0xffffff
  buffer_load_dwordx4 v5, s[24:27], s50 offen lds
  s_mov_b64 exec, -1
  s_add_u32 s50, s49, 512
  s_add_u32 m0, s47, 108544
  s_nop 0
  buffer_load_dwordx4 v8, s[20:23], s50 offen lds
  s_add_u32 m0, s47, 109568
  s_nop 0
  buffer_load_dwordx4 v9, s[20:23], s50 offen lds
  buffer_load_dwordx2 v[188:189], v207, s[32:35], s85 offen
  v_lshlrev_b32 v194, 3, v200
  v_add_u32 v194, 141312, v194
  v_add_u32 v200, 1536, v0
  ds_read_b64_tr_b16 v[28:29], v7 offset:23104
  ds_read_b64_tr_b16 v[30:31], v7 offset:23584
  s_waitcnt lgkmcnt(14)
  v_mfma_f32_32x32x16_bf16 v[72:87], v[32:35], v[104:107], v[72:87]
  v_mul_u32_u24 v201, 2731, v200
  v_lshrrev_b32 v201, 16, v201
  v_mul_u32_u24 v202, 24, v201
  v_sub_u32 v202, v200, v202
  ds_read_b64_tr_b16 v[32:33], v7 offset:23168
  ds_read_b64_tr_b16 v[34:35], v7 offset:23648
  s_waitcnt lgkmcnt(6)
  v_mfma_f32_32x32x16_bf16 v[88:103], v[36:39], v[104:107], v[88:103]
  v_mul_u32_u24 v203, 3277, v201
  v_lshrrev_b32 v203, 16, v203
  v_mul_u32_u24 v204, 20, v203
  v_sub_u32 v204, v201, v204
  ds_read_b64_tr_b16 v[36:37], v7 offset:23232
  ds_read_b64_tr_b16 v[38:39], v7 offset:23712
  s_waitcnt lgkmcnt(6)
  v_mfma_f32_32x32x16_bf16 v[40:55], v[24:27], v[108:111], v[40:55]
  v_lshrrev_b32 v205, 1, v202
  v_lshlrev_b32 v205, 2, v205
  v_and_b32 v206, 1, v202
  v_lshlrev_b32 v206, 1, v206
  ds_read_b64_tr_b16 v[24:25], v7 offset:30720
  ds_read_b64_tr_b16 v[26:27], v7 offset:31200
  s_waitcnt lgkmcnt(6)
  v_mfma_f32_32x32x16_bf16 v[56:71], v[28:31], v[108:111], v[56:71]
  v_cmp_lt_u32 vcc, 19, v205
  s_nop 1
  v_addc_co_u32 v206, vcc, 0, v206, vcc
  v_cmp_lt_u32 vcc, 19, v205
  v_subrev_u32 v208, 20, v205
  ds_read_b64_tr_b16 v[28:29], v7 offset:30784
  ds_read_b64_tr_b16 v[30:31], v7 offset:31264
  s_waitcnt lgkmcnt(6)
  v_mfma_f32_32x32x16_bf16 v[72:87], v[32:35], v[108:111], v[72:87]
  v_cndmask_b32 v208, v205, v208, vcc
  v_mul_u32_u24 v207, 800, v203
  v_mul_u32_u24 v204, 40, v204
  v_add_u32 v207, v207, v204
  ds_read_b64_tr_b16 v[32:33], v7 offset:30848
  ds_read_b64_tr_b16 v[34:35], v7 offset:31328
  s_waitcnt lgkmcnt(6)
  v_mfma_f32_32x32x16_bf16 v[88:103], v[36:39], v[108:111], v[88:103]
  v_lshl_add_u32 v207, v208, 1, v207
  v_mov_b32 v204, 0x7ffffff0
  v_cmp_eq_u32 vcc, v206, v203
  s_nop 1
  v_cndmask_b32 v207, v204, v207, vcc
  v_add_f32 v136, v136, v137
  v_add_f32 v136, v136, v138
  v_add_f32 v136, v136, v139
  v_add_f32 v136, v136, v140
  v_add_f32 v136, v136, v141
  v_add_f32 v136, v136, v142
  v_add_f32 v136, v136, v143
  s_lshl_b32 s46, s41, 4
  s_add_u32 s46, s46, s40
  s_lshl_b32 s46, s46, 10
  s_lshl_b32 s54, s43, 8
  s_add_u32 s46, s46, s54
  s_add_u32 s46, s46, 12677120
  buffer_store_dword v136, v144, s[28:31], s46 offen sc1
  ds_read_b64_tr_b16 v[36:37], v7 offset:30912
  ds_read_b64_tr_b16 v[38:39], v7 offset:31392
  s_waitcnt lgkmcnt(6)
  v_mfma_f32_32x32x16_bf16 v[40:55], v[24:27], v[112:115], v[40:55]
  v_cmp_gt_u32 vcc, 40, v205
  s_nop 1
  v_cndmask_b32 v207, v204, v207, vcc
  s_mul_i32 s85, s41, 3200
  buffer_load_dwordx2 v[190:191], v207, s[32:35], s85 offen
  ds_read_b64_tr_b16 v[24:25], v7 offset:38400
  ds_read_b64_tr_b16 v[26:27], v7 offset:38880
  s_waitcnt lgkmcnt(6)
  v_mfma_f32_32x32x16_bf16 v[56:71], v[28:31], v[112:115], v[56:71]
  v_lshlrev_b32 v195, 3, v200
  v_add_u32 v195, 141312, v195
  ds_read_b64_tr_b16 v[28:29], v7 offset:38464
  ds_read_b64_tr_b16 v[30:31], v7 offset:38944
  s_waitcnt lgkmcnt(6)
  v_mfma_f32_32x32x16_bf16 v[72:87], v[32:35], v[112:115], v[72:87]
  ds_read_b64_tr_b16 v[32:33], v7 offset:38528
  ds_read_b64_tr_b16 v[34:35], v7 offset:39008
  s_waitcnt lgkmcnt(6)
  v_mfma_f32_32x32x16_bf16 v[88:103], v[36:39], v[112:115], v[88:103]
  ds_read_b64_tr_b16 v[36:37], v7 offset:38592
  ds_read_b64_tr_b16 v[38:39], v7 offset:39072
  s_waitcnt lgkmcnt(6)
  v_mfma_f32_32x32x16_bf16 v[40:55], v[24:27], v[116:119], v[40:55]
  s_waitcnt vmcnt(7)
  s_barrier
  ds_read_b128 v[120:123], v10 offset:0
  ds_read_b128 v[124:127], v11 offset:0
  ds_read_b128 v[128:131], v12 offset:0
  ds_read_b128 v[132:135], v13 offset:0
  s_mov_b32 s50, 1105920
  s_add_u32 m0, s45, 46080
  s_nop 0
  buffer_load_dwordx4 v4, s[24:27], s50 offen lds
  s_add_u32 m0, s45, 47104
  s_mov_b32 exec_hi, 0xffffff
  buffer_load_dwordx4 v5, s[24:27], s50 offen lds
  s_mov_b64 exec, -1
  ds_read_b64_tr_b16 v[24:25], v6 offset:0
  ds_read_b64_tr_b16 v[26:27], v6 offset:480
  s_waitcnt lgkmcnt(10)
  v_mfma_f32_32x32x16_bf16 v[56:71], v[28:31], v[116:119], v[56:71]
  ds_read_b64_tr_b16 v[28:29], v6 offset:64
  ds_read_b64_tr_b16 v[30:31], v6 offset:544
  s_waitcnt lgkmcnt(10)
  v_mfma_f32_32x32x16_bf16 v[72:87], v[32:35], v[116:119], v[72:87]
  ds_read_b64_tr_b16 v[32:33], v6 offset:128
  ds_read_b64_tr_b16 v[34:35], v6 offset:608
  s_waitcnt lgkmcnt(10)
  v_mfma_f32_32x32x16_bf16 v[88:103], v[36:39], v[116:119], v[88:103]
  ds_read_b64_tr_b16 v[36:37], v6 offset:192
  ds_read_b64_tr_b16 v[38:39], v6 offset:672
  s_waitcnt lgkmcnt(6)
  v_mfma_f32_32x32x16_bf16 v[40:55], v[24:27], v[120:123], v[40:55]
  ds_read_b64_tr_b16 v[24:25], v6 offset:7680
  ds_read_b64_tr_b16 v[26:27], v6 offset:8160
  s_waitcnt lgkmcnt(6)
  v_mfma_f32_32x32x16_bf16 v[56:71], v[28:31], v[120:123], v[56:71]
  s_mov_b32 s50, 1228800
  s_add_u32 m0, s45, 61440
  s_nop 0
  buffer_load_dwordx4 v4, s[24:27], s50 offen lds
  s_add_u32 m0, s45, 62464
  s_mov_b32 exec_hi, 0xffffff
  buffer_load_dwordx4 v5, s[24:27], s50 offen lds
  s_mov_b64 exec, -1
  s_add_u32 s50, s49, 640
  s_add_u32 m0, s47, 124928
  s_nop 0
  buffer_load_dwordx4 v8, s[20:23], s50 offen lds
  s_add_u32 m0, s47, 125952
  s_nop 0
  buffer_load_dwordx4 v9, s[20:23], s50 offen lds
  ds_read_b64_tr_b16 v[28:29], v6 offset:7744
  ds_read_b64_tr_b16 v[30:31], v6 offset:8224
  s_waitcnt lgkmcnt(6)
  v_mfma_f32_32x32x16_bf16 v[72:87], v[32:35], v[120:123], v[72:87]
  ds_read_b64_tr_b16 v[32:33], v6 offset:7808
  ds_read_b64_tr_b16 v[34:35], v6 offset:8288
  s_waitcnt lgkmcnt(6)
  v_mfma_f32_32x32x16_bf16 v[88:103], v[36:39], v[120:123], v[88:103]
  ds_read_b64_tr_b16 v[36:37], v6 offset:7872
  ds_read_b64_tr_b16 v[38:39], v6 offset:8352
  s_waitcnt lgkmcnt(6)
  v_mfma_f32_32x32x16_bf16 v[40:55], v[24:27], v[124:127], v[40:55]
  ds_read_b64_tr_b16 v[24:25], v6 offset:15360
  ds_read_b64_tr_b16 v[26:27], v6 offset:15840
  s_waitcnt lgkmcnt(6)
  v_mfma_f32_32x32x16_bf16 v[56:71], v[28:31], v[124:127], v[56:71]
  ds_read_b64_tr_b16 v[28:29], v6 offset:15424
  ds_read_b64_tr_b16 v[30:31], v6 offset:15904
  s_waitcnt lgkmcnt(6)
  v_mfma_f32_32x32x16_bf16 v[72:87], v[32:35], v[124:127], v[72:87]
  ds_read_b64_tr_b16 v[32:33], v6 offset:15488
  ds_read_b64_tr_b16 v[34:35], v6 offset:15968
  s_waitcnt lgkmcnt(6)
  v_mfma_f32_32x32x16_bf16 v[88:103], v[36:39], v[124:127], v[88:103]
  s_waitcnt vmcnt(7)
  ds_read_b64_tr_b16 v[36:37], v6 offset:15552
  ds_read_b64_tr_b16 v[38:39], v6 offset:16032
  s_waitcnt lgkmcnt(6)
  v_mfma_f32_32x32x16_bf16 v[40:55], v[24:27], v[128:131], v[40:55]
  s_waitcnt vmcnt(6)
  ds_write_b64 v192, v[184:185]
  ds_write_b64 v193, v[186:187]
  ds_write_b64 v194, v[188:189]
  ds_read_b64_tr_b16 v[24:25], v6 offset:23040
  ds_read_b64_tr_b16 v[26:27], v6 offset:23520
  s_waitcnt lgkmcnt(9)
  v_mfma_f32_32x32x16_bf16 v[56:71], v[28:31], v[128:131], v[56:71]
  v_cmp_gt_u32 vcc, 384, v0
  s_nop 0
  s_and_saveexec_b64 s[52:53], vcc
  ds_write_b64 v195, v[190:191]
  s_mov_b64 exec, -1
  ds_read_b64_tr_b16 v[28:29], v6 offset:23104
  ds_read_b64_tr_b16 v[30:31], v6 offset:23584
  s_waitcnt lgkmcnt(10)
  v_mfma_f32_32x32x16_bf16 v[72:87], v[32:35], v[128:131], v[72:87]
  ds_read_b64_tr_b16 v[32:33], v6 offset:23168
  ds_read_b64_tr_b16 v[34:35], v6 offset:23648
  s_waitcnt lgkmcnt(10)
  v_mfma_f32_32x32x16_bf16 v[88:103], v[36:39], v[128:131], v[88:103]
  ds_read_b64_tr_b16 v[36:37], v6 offset:23232
  ds_read_b64_tr_b16 v[38:39], v6 offset:23712
  s_waitcnt lgkmcnt(7)
  v_mfma_f32_32x32x16_bf16 v[40:55], v[24:27], v[132:135], v[40:55]
  s_waitcnt vmcnt(4) lgkmcnt(6)
  s_barrier
  ds_read_b128 v[104:107], v10 offset:16384
  ds_read_b128 v[108:111], v11 offset:16384
  ds_read_b128 v[112:115], v12 offset:16384
  ds_read_b128 v[116:119], v13 offset:16384
  s_mov_b32 s50, 1351680
  s_add_u32 m0, s45, 76800
  s_nop 0
  buffer_load_dwordx4 v4, s[24:27], s50 offen lds
  s_add_u32 m0, s45, 77824
  s_mov_b32 exec_hi, 0xffffff
  buffer_load_dwordx4 v5, s[24:27], s50 offen lds
  s_mov_b64 exec, -1
  ds_read_b64_tr_b16 v[24:25], v6 offset:30720
  ds_read_b64_tr_b16 v[26:27], v6 offset:31200
  s_waitcnt lgkmcnt(10)
  v_mfma_f32_32x32x16_bf16 v[56:71], v[28:31], v[132:135], v[56:71]
  ds_read_b64_tr_b16 v[28:29], v6 offset:30784
  ds_read_b64_tr_b16 v[30:31], v6 offset:31264
  s_waitcnt lgkmcnt(10)
  v_mfma_f32_32x32x16_bf16 v[72:87], v[32:35], v[132:135], v[72:87]
  ds_read_b64_tr_b16 v[32:33], v6 offset:30848
  ds_read_b64_tr_b16 v[34:35], v6 offset:31328
  s_waitcnt lgkmcnt(10)
  v_mfma_f32_32x32x16_bf16 v[88:103], v[36:39], v[132:135], v[88:103]
  v_mov_b32 v146, 1
  s_and_b32 s46, s2, 1
  s_lshl_b32 s46, s46, 7
  v_mov_b32 v147, s46
  v_lshlrev_b32 v19, 7, v1
  v_and_b32 v19, 128, v19
  s_cmp_lg_u32 s43, 0
  s_cbranch_scc1 L_att0_nosig
  s_mov_b64 exec, 1
  buffer_atomic_add v146, v147, s[36:39], 0 offen sc1
  s_mov_b64 exec, -1
L_att0_nosig:
  ds_read_b64_tr_b16 v[36:37], v6 offset:30912
  ds_read_b64_tr_b16 v[38:39], v6 offset:31392
  s_waitcnt lgkmcnt(6)
  v_mfma_f32_32x32x16_bf16 v[40:55], v[24:27], v[104:107], v[40:55]
  ds_read_b64_tr_b16 v[24:25], v6 offset:38400
  ds_read_b64_tr_b16 v[26:27], v6 offset:38880
  s_waitcnt lgkmcnt(6)
  v_mfma_f32_32x32x16_bf16 v[56:71], v[28:31], v[104:107], v[56:71]
  s_mov_b32 s50, 1474560
  s_add_u32 m0, s45, 0
  s_nop 0
  buffer_load_dwordx4 v4, s[24:27], s50 offen lds
  s_add_u32 m0, s45, 1024
  s_mov_b32 exec_hi, 0xffffff
  buffer_load_dwordx4 v5, s[24:27], s50 offen lds
  s_mov_b64 exec, -1
  s_add_u32 s50, s49, 768
  s_add_u32 m0, s47, 92160
  s_nop 0
  buffer_load_dwordx4 v8, s[20:23], s50 offen lds
  s_add_u32 m0, s47, 93184
  s_nop 0
  buffer_load_dwordx4 v9, s[20:23], s50 offen lds
  ds_read_b64_tr_b16 v[28:29], v6 offset:38464
  ds_read_b64_tr_b16 v[30:31], v6 offset:38944
  s_waitcnt lgkmcnt(6)
  v_mfma_f32_32x32x16_bf16 v[72:87], v[32:35], v[104:107], v[72:87]
  ds_read_b64_tr_b16 v[32:33], v6 offset:38528
  ds_read_b64_tr_b16 v[34:35], v6 offset:39008
  s_waitcnt lgkmcnt(6)
  v_mfma_f32_32x32x16_bf16 v[88:103], v[36:39], v[104:107], v[88:103]
  ds_read_b64_tr_b16 v[36:37], v6 offset:38592
  ds_read_b64_tr_b16 v[38:39], v6 offset:39072
  s_waitcnt lgkmcnt(6)
  v_mfma_f32_32x32x16_bf16 v[40:55], v[24:27], v[108:111], v[40:55]
  ds_read_b64_tr_b16 v[24:25], v7 offset:0
  ds_read_b64_tr_b16 v[26:27], v7 offset:480
  s_waitcnt lgkmcnt(6)
  v_mfma_f32_32x32x16_bf16 v[56:71], v[28:31], v[108:111], v[56:71]
  ds_read_b64_tr_b16 v[28:29], v7 offset:64
  ds_read_b64_tr_b16 v[30:31], v7 offset:544
  s_waitcnt lgkmcnt(6)
  v_mfma_f32_32x32x16_bf16 v[72:87], v[32:35], v[108:111], v[72:87]
  ds_read_b64_tr_b16 v[32:33], v7 offset:128
  ds_read_b64_tr_b16 v[34:35], v7 offset:608
  s_waitcnt lgkmcnt(6)
  v_mfma_f32_32x32x16_bf16 v[88:103], v[36:39], v[108:111], v[88:103]
  ds_read_b64_tr_b16 v[36:37], v7 offset:192
  ds_read_b64_tr_b16 v[38:39], v7 offset:672
  s_waitcnt lgkmcnt(6)
  v_mfma_f32_32x32x16_bf16 v[40:55], v[24:27], v[112:115], v[40:55]
  ds_read_b64_tr_b16 v[24:25], v7 offset:7680
  ds_read_b64_tr_b16 v[26:27], v7 offset:8160
  s_waitcnt lgkmcnt(6)
  v_mfma_f32_32x32x16_bf16 v[56:71], v[28:31], v[112:115], v[56:71]
  ds_read_b64_tr_b16 v[28:29], v7 offset:7744
  ds_read_b64_tr_b16 v[30:31], v7 offset:8224
  s_waitcnt lgkmcnt(6)
  v_mfma_f32_32x32x16_bf16 v[72:87], v[32:35], v[112:115], v[72:87]
  ds_read_b64_tr_b16 v[32:33], v7 offset:7808
  ds_read_b64_tr_b16 v[34:35], v7 offset:8288
  s_waitcnt lgkmcnt(6)
  v_mfma_f32_32x32x16_bf16 v[88:103], v[36:39], v[112:115], v[88:103]
  ds_read_b64_tr_b16 v[36:37], v7 offset:7872
  ds_read_b64_tr_b16 v[38:39], v7 offset:8352
  s_waitcnt lgkmcnt(6)
  v_mfma_f32_32x32x16_bf16 v[40:55], v[24:27], v[116:119], v[40:55]
  s_waitcnt vmcnt(4)
  s_barrier
  ds_read_b128 v[120:123], v10 offset:32768
  ds_read_b128 v[124:127], v11 offset:32768
  ds_read_b128 v[128:131], v12 offset:32768
  ds_read_b128 v[132:135], v13 offset:32768
  s_mov_b32 s50, 1597440
  s_add_u32 m0, s45, 15360
  s_nop 0
  buffer_load_dwordx4 v4, s[24:27], s50 offen lds
  s_add_u32 m0, s45, 16384
  s_mov_b32 exec_hi, 0xffffff
  buffer_load_dwordx4 v5, s[24:27], s50 offen lds
  s_mov_b64 exec, -1
  ds_read_b64_tr_b16 v[24:25], v7 offset:15360
  ds_read_b64_tr_b16 v[26:27], v7 offset:15840
  s_waitcnt lgkmcnt(10)
  v_mfma_f32_32x32x16_bf16 v[56:71], v[28:31], v[116:119], v[56:71]
  ds_read_b64_tr_b16 v[28:29], v7 offset:15424
  ds_read_b64_tr_b16 v[30:31], v7 offset:15904
  s_waitcnt lgkmcnt(10)
  v_mfma_f32_32x32x16_bf16 v[72:87], v[32:35], v[116:119], v[72:87]
  ds_read_b64_tr_b16 v[32:33], v7 offset:15488
  ds_read_b64_tr_b16 v[34:35], v7 offset:15968
  s_waitcnt lgkmcnt(10)
  v_mfma_f32_32x32x16_bf16 v[88:103], v[36:39], v[116:119], v[88:103]
  ds_read_b64_tr_b16 v[36:37], v7 offset:15552
  ds_read_b64_tr_b16 v[38:39], v7 offset:16032
  s_waitcnt lgkmcnt(6)
  v_mfma_f32_32x32x16_bf16 v[40:55], v[24:27], v[120:123], v[40:55]
  ds_read_b64_tr_b16 v[24:25], v7 offset:23040
  ds_read_b64_tr_b16 v[26:27], v7 offset:23520
  s_waitcnt lgkmcnt(6)
  v_mfma_f32_32x32x16_bf16 v[56:71], v[28:31], v[120:123], v[56:71]
  s_mov_b32 s50, 1720320
  s_add_u32 m0, s45, 30720
  s_nop 0
  buffer_load_dwordx4 v4, s[24:27], s50 offen lds
  s_add_u32 m0, s45, 31744
  s_mov_b32 exec_hi, 0xffffff
  buffer_load_dwordx4 v5, s[24:27], s50 offen lds
  s_mov_b64 exec, -1
  s_add_u32 s50, s49, 896
  s_add_u32 m0, s47, 108544
  s_nop 0
  buffer_load_dwordx4 v8, s[20:23], s50 offen lds
  s_add_u32 m0, s47, 109568
  s_nop 0
  buffer_load_dwordx4 v9, s[20:23], s50 offen lds
  ds_read_b64_tr_b16 v[28:29], v7 offset:23104
  ds_read_b64_tr_b16 v[30:31], v7 offset:23584
  s_waitcnt lgkmcnt(6)
  v_mfma_f32_32x32x16_bf16 v[72:87], v[32:35], v[120:123], v[72:87]
  ds_read_b64_tr_b16 v[32:33], v7 offset:23168
  ds_read_b64_tr_b16 v[34:35], v7 offset:23648
  s_waitcnt lgkmcnt(6)
  v_mfma_f32_32x32x16_bf16 v[88:103], v[36:39], v[120:123], v[88:103]
  ds_read_b64_tr_b16 v[36:37], v7 offset:23232
  ds_read_b64_tr_b16 v[38:39], v7 offset:23712
  s_waitcnt lgkmcnt(6)
  v_mfma_f32_32x32x16_bf16 v[40:55], v[24:27], v[124:127], v[40:55]
  ds_read_b64_tr_b16 v[24:25], v7 offset:30720
  ds_read_b64_tr_b16 v[26:27], v7 offset:31200
  s_waitcnt lgkmcnt(6)
  v_mfma_f32_32x32x16_bf16 v[56:71], v[28:31], v[124:127], v[56:71]
  ds_read_b64_tr_b16 v[28:29], v7 offset:30784
  ds_read_b64_tr_b16 v[30:31], v7 offset:31264
  s_waitcnt lgkmcnt(6)
  v_mfma_f32_32x32x16_bf16 v[72:87], v[32:35], v[124:127], v[72:87]
  ds_read_b64_tr_b16 v[32:33], v7 offset:30848
  ds_read_b64_tr_b16 v[34:35], v7 offset:31328
  s_waitcnt lgkmcnt(6)
  v_mfma_f32_32x32x16_bf16 v[88:103], v[36:39], v[124:127], v[88:103]
  ds_read_b64_tr_b16 v[36:37], v7 offset:30912
  ds_read_b64_tr_b16 v[38:39], v7 offset:31392
  s_waitcnt lgkmcnt(6)
  v_mfma_f32_32x32x16_bf16 v[40:55], v[24:27], v[128:131], v[40:55]
  ds_read_b64_tr_b16 v[24:25], v7 offset:38400
  ds_read_b64_tr_b16 v[26:27], v7 offset:38880
  s_waitcnt lgkmcnt(6)
  v_mfma_f32_32x32x16_bf16 v[56:71], v[28:31], v[128:131], v[56:71]
  ds_read_b64_tr_b16 v[28:29], v7 offset:38464
  ds_read_b64_tr_b16 v[30:31], v7 offset:38944
  s_waitcnt lgkmcnt(6)
  v_mfma_f32_32x32x16_bf16 v[72:87], v[32:35], v[128:131], v[72:87]
  ds_read_b64_tr_b16 v[32:33], v7 offset:38528
  ds_read_b64_tr_b16 v[34:35], v7 offset:39008
  s_waitcnt lgkmcnt(6)
  v_mfma_f32_32x32x16_bf16 v[88:103], v[36:39], v[128:131], v[88:103]
  ds_read_b64_tr_b16 v[36:37], v7 offset:38592
  ds_read_b64_tr_b16 v[38:39], v7 offset:39072
  s_waitcnt lgkmcnt(6)
  v_mfma_f32_32x32x16_bf16 v[40:55], v[24:27], v[132:135], v[40:55]
  s_waitcnt vmcnt(4)
  s_barrier
  ds_read_b128 v[104:107], v10 offset:0
  ds_read_b128 v[108:111], v11 offset:0
  ds_read_b128 v[112:115], v12 offset:0
  ds_read_b128 v[116:119], v13 offset:0
  s_mov_b32 s50, 1843200
  s_add_u32 m0, s45, 46080
  s_nop 0
  buffer_load_dwordx4 v4, s[24:27], s50 offen lds
  s_add_u32 m0, s45, 47104
  s_mov_b32 exec_hi, 0xffffff
  buffer_load_dwordx4 v5, s[24:27], s50 offen lds
  s_mov_b64 exec, -1
  ds_read_b64_tr_b16 v[24:25], v6 offset:0
  ds_read_b64_tr_b16 v[26:27], v6 offset:480
  s_waitcnt lgkmcnt(10)
  v_mfma_f32_32x32x16_bf16 v[56:71], v[28:31], v[132:135], v[56:71]
  ds_read_b64_tr_b16 v[28:29], v6 offset:64
  ds_read_b64_tr_b16 v[30:31], v6 offset:544
  s_waitcnt lgkmcnt(10)
  v_mfma_f32_32x32x16_bf16 v[72:87], v[32:35], v[132:135], v[72:87]
  ds_read_b64_tr_b16 v[32:33], v6 offset:128
  ds_read_b64_tr_b16 v[34:35], v6 offset:608
  s_waitcnt lgkmcnt(10)
  v_mfma_f32_32x32x16_bf16 v[88:103], v[36:39], v[132:135], v[88:103]
  ds_read_b64_tr_b16 v[36:37], v6 offset:192
  ds_read_b64_tr_b16 v[38:39], v6 offset:672
  s_waitcnt lgkmcnt(6)
  v_mfma_f32_32x32x16_bf16 v[40:55], v[24:27], v[104:107], v[40:55]
  ds_read_b64_tr_b16 v[24:25], v6 offset:7680
  ds_read_b64_tr_b16 v[26:27], v6 offset:8160
  s_waitcnt lgkmcnt(6)
  v_mfma_f32_32x32x16_bf16 v[56:71], v[28:31], v[104:107], v[56:71]
  s_mov_b32 s50, 1966080
  s_add_u32 m0, s45, 61440
  s_nop 0
  buffer_load_dwordx4 v4, s[24:27], s50 offen lds
  s_add_u32 m0, s45, 62464
  s_mov_b32 exec_hi, 0xffffff
  buffer_load_dwordx4 v5, s[24:27], s50 offen lds
  s_mov_b64 exec, -1
  s_add_u32 s50, s49, 1024
  s_add_u32 m0, s47, 124928
  s_nop 0
  buffer_load_dwordx4 v8, s[20:23], s50 offen lds
  s_add_u32 m0, s47, 125952
  s_nop 0
  buffer_load_dwordx4 v9, s[20:23], s50 offen lds
  ds_read_b64_tr_b16 v[28:29], v6 offset:7744
  ds_read_b64_tr_b16 v[30:31], v6 offset:8224
  s_waitcnt lgkmcnt(6)
  v_mfma_f32_32x32x16_bf16 v[72:87], v[32:35], v[104:107], v[72:87]
  ds_read_b64_tr_b16 v[32:33], v6 offset:7808
  ds_read_b64_tr_b16 v[34:35], v6 offset:8288
  s_waitcnt lgkmcnt(6)
  v_mfma_f32_32x32x16_bf16 v[88:103], v[36:39], v[104:107], v[88:103]
  ds_read_b64_tr_b16 v[36:37], v6 offset:7872
  ds_read_b64_tr_b16 v[38:39], v6 offset:8352
  s_waitcnt lgkmcnt(6)
  v_mfma_f32_32x32x16_bf16 v[40:55], v[24:27], v[108:111], v[40:55]
  ds_read_b64_tr_b16 v[24:25], v6 offset:15360
  ds_read_b64_tr_b16 v[26:27], v6 offset:15840
  s_waitcnt lgkmcnt(6)
  v_mfma_f32_32x32x16_bf16 v[56:71], v[28:31], v[108:111], v[56:71]
  ds_read_b64_tr_b16 v[28:29], v6 offset:15424
  ds_read_b64_tr_b16 v[30:31], v6 offset:15904
  s_waitcnt lgkmcnt(6)
  v_mfma_f32_32x32x16_bf16 v[72:87], v[32:35], v[108:111], v[72:87]
  ds_read_b64_tr_b16 v[32:33], v6 offset:15488
  ds_read_b64_tr_b16 v[34:35], v6 offset:15968
  s_waitcnt lgkmcnt(6)
  v_mfma_f32_32x32x16_bf16 v[88:103], v[36:39], v[108:111], v[88:103]
  ds_read_b64_tr_b16 v[36:37], v6 offset:15552
  ds_read_b64_tr_b16 v[38:39], v6 offset:16032
  s_waitcnt lgkmcnt(6)
  v_mfma_f32_32x32x16_bf16 v[40:55], v[24:27], v[112:115], v[40:55]
  ds_read_b64_tr_b16 v[24:25], v6 offset:23040
  ds_read_b64_tr_b16 v[26:27], v6 offset:23520
  s_waitcnt lgkmcnt(6)
  v_mfma_f32_32x32x16_bf16 v[56:71], v[28:31], v[112:115], v[56:71]
  ds_read_b64_tr_b16 v[28:29], v6 offset:23104
  ds_read_b64_tr_b16 v[30:31], v6 offset:23584
  s_waitcnt lgkmcnt(6)
  v_mfma_f32_32x32x16_bf16 v[72:87], v[32:35], v[112:115], v[72:87]
  ds_read_b64_tr_b16 v[32:33], v6 offset:23168
  ds_read_b64_tr_b16 v[34:35], v6 offset:23648
  s_waitcnt lgkmcnt(6)
  v_mfma_f32_32x32x16_bf16 v[88:103], v[36:39], v[112:115], v[88:103]
  ds_read_b64_tr_b16 v[36:37], v6 offset:23232
  ds_read_b64_tr_b16 v[38:39], v6 offset:23712
  s_waitcnt lgkmcnt(6)
  v_mfma_f32_32x32x16_bf16 v[40:55], v[24:27], v[116:119], v[40:55]
  s_waitcnt vmcnt(4)
  s_barrier
  ds_read_b128 v[120:123], v10 offset:16384
  ds_read_b128 v[124:127], v11 offset:16384
  ds_read_b128 v[128:131], v12 offset:16384
  ds_read_b128 v[132:135], v13 offset:16384
  s_mov_b32 s50, 2088960
  s_add_u32 m0, s45, 76800
  s_nop 0
  buffer_load_dwordx4 v4, s[24:27], s50 offen lds
  s_add_u32 m0, s45, 77824
  s_mov_b32 exec_hi, 0xffffff
  buffer_load_dwordx4 v5, s[24:27], s50 offen lds
  s_mov_b64 exec, -1
  ds_read_b64_tr_b16 v[24:25], v6 offset:30720
  ds_read_b64_tr_b16 v[26:27], v6 offset:31200
  s_waitcnt lgkmcnt(10)
  v_mfma_f32_32x32x16_bf16 v[56:71], v[28:31], v[116:119], v[56:71]
  ds_read_b64_tr_b16 v[28:29], v6 offset:30784
  ds_read_b64_tr_b16 v[30:31], v6 offset:31264
  s_waitcnt lgkmcnt(10)
  v_mfma_f32_32x32x16_bf16 v[72:87], v[32:35], v[116:119], v[72:87]
  ds_read_b64_tr_b16 v[32:33], v6 offset:30848
  ds_read_b64_tr_b16 v[34:35], v6 offset:31328
  s_waitcnt lgkmcnt(10)
  v_mfma_f32_32x32x16_bf16 v[88:103], v[36:39], v[116:119], v[88:103]
  ds_read_b64_tr_b16 v[36:37], v6 offset:30912
  ds_read_b64_tr_b16 v[38:39], v6 offset:31392
  s_waitcnt lgkmcnt(6)
  v_mfma_f32_32x32x16_bf16 v[40:55], v[24:27], v[120:123], v[40:55]
  ds_read_b64_tr_b16 v[24:25], v6 offset:38400
  ds_read_b64_tr_b16 v[26:27], v6 offset:38880
  s_waitcnt lgkmcnt(6)
  v_mfma_f32_32x32x16_bf16 v[56:71], v[28:31], v[120:123], v[56:71]
  s_mov_b32 s50, 2211840
  s_add_u32 m0, s45, 0
  s_nop 0
  buffer_load_dwordx4 v4, s[24:27], s50 offen lds
  s_add_u32 m0, s45, 1024
  s_mov_b32 exec_hi, 0xffffff
  buffer_load_dwordx4 v5, s[24:27], s50 offen lds
  s_mov_b64 exec, -1
  s_add_u32 s50, s49, 1152
  s_add_u32 m0, s47, 92160
  s_nop 0
  buffer_load_dwordx4 v8, s[20:23], s50 offen lds
  s_add_u32 m0, s47, 93184
  s_nop 0
  buffer_load_dwordx4 v9, s[20:23], s50 offen lds
  ds_read_b64_tr_b16 v[28:29], v6 offset:38464
  ds_read_b64_tr_b16 v[30:31], v6 offset:38944
  s_waitcnt lgkmcnt(6)
  v_mfma_f32_32x32x16_bf16 v[72:87], v[32:35], v[120:123], v[72:87]
  ds_read_b64_tr_b16 v[32:33], v6 offset:38528
  ds_read_b64_tr_b16 v[34:35], v6 offset:39008
  s_waitcnt lgkmcnt(6)
  v_mfma_f32_32x32x16_bf16 v[88:103], v[36:39], v[120:123], v[88:103]
  ds_read_b64_tr_b16 v[36:37], v6 offset:38592
  ds_read_b64_tr_b16 v[38:39], v6 offset:39072
  s_waitcnt lgkmcnt(6)
  v_mfma_f32_32x32x16_bf16 v[40:55], v[24:27], v[124:127], v[40:55]
  ds_read_b64_tr_b16 v[24:25], v7 offset:0
  ds_read_b64_tr_b16 v[26:27], v7 offset:480
  s_waitcnt lgkmcnt(6)
  v_mfma_f32_32x32x16_bf16 v[56:71], v[28:31], v[124:127], v[56:71]
  ds_read_b64_tr_b16 v[28:29], v7 offset:64
  ds_read_b64_tr_b16 v[30:31], v7 offset:544
  s_waitcnt lgkmcnt(6)
  v_mfma_f32_32x32x16_bf16 v[72:87], v[32:35], v[124:127], v[72:87]
  ds_read_b64_tr_b16 v[32:33], v7 offset:128
  ds_read_b64_tr_b16 v[34:35], v7 offset:608
  s_waitcnt lgkmcnt(6)
  v_mfma_f32_32x32x16_bf16 v[88:103], v[36:39], v[124:127], v[88:103]
  ds_read_b64_tr_b16 v[36:37], v7 offset:192
  ds_read_b64_tr_b16 v[38:39], v7 offset:672
  s_waitcnt lgkmcnt(6)
  v_mfma_f32_32x32x16_bf16 v[40:55], v[24:27], v[128:131], v[40:55]
  ds_read_b64_tr_b16 v[24:25], v7 offset:7680
  ds_read_b64_tr_b16 v[26:27], v7 offset:8160
  s_waitcnt lgkmcnt(6)
  v_mfma_f32_32x32x16_bf16 v[56:71], v[28:31], v[128:131], v[56:71]
  ds_read_b64_tr_b16 v[28:29], v7 offset:7744
  ds_read_b64_tr_b16 v[30:31], v7 offset:8224
  s_waitcnt lgkmcnt(6)
  v_mfma_f32_32x32x16_bf16 v[72:87], v[32:35], v[128:131], v[72:87]
  ds_read_b64_tr_b16 v[32:33], v7 offset:7808
  ds_read_b64_tr_b16 v[34:35], v7 offset:8288
  s_waitcnt lgkmcnt(6)
  v_mfma_f32_32x32x16_bf16 v[88:103], v[36:39], v[128:131], v[88:103]
  ds_read_b64_tr_b16 v[36:37], v7 offset:7872
  ds_read_b64_tr_b16 v[38:39], v7 offset:8352
  s_waitcnt lgkmcnt(6)
  v_mfma_f32_32x32x16_bf16 v[40:55], v[24:27], v[132:135], v[40:55]
  s_waitcnt vmcnt(4)
  s_barrier
  ds_read_b128 v[104:107], v10 offset:32768
  ds_read_b128 v[108:111], v11 offset:32768
  ds_read_b128 v[112:115], v12 offset:32768
  ds_read_b128 v[116:119], v13 offset:32768
  s_mov_b32 s50, 2334720
  s_add_u32 m0, s45, 15360
  s_nop 0
  buffer_load_dwordx4 v4, s[24:27], s50 offen lds
  s_add_u32 m0, s45, 16384
  s_mov_b32 exec_hi, 0xffffff
  buffer_load_dwordx4 v5, s[24:27], s50 offen lds
  s_mov_b64 exec, -1
  ds_read_b64_tr_b16 v[24:25], v7 offset:15360
  ds_read_b64_tr_b16 v[26:27], v7 offset:15840
  s_waitcnt lgkmcnt(10)
  v_mfma_f32_32x32x16_bf16 v[56:71], v[28:31], v[132:135], v[56:71]
  ds_read_b64_tr_b16 v[28:29], v7 offset:15424
  ds_read_b64_tr_b16 v[30:31], v7 offset:15904
  s_waitcnt lgkmcnt(10)
  v_mfma_f32_32x32x16_bf16 v[72:87], v[32:35], v[132:135], v[72:87]
  ds_read_b64_tr_b16 v[32:33], v7 offset:15488
  ds_read_b64_tr_b16 v[34:35], v7 offset:15968
  s_waitcnt lgkmcnt(10)
  v_mfma_f32_32x32x16_bf16 v[88:103], v[36:39], v[132:135], v[88:103]
  s_mul_i32 s46, s43, 0x1000
  buffer_load_dword v18, v19, s[36:39], s46 offen sc1
  ds_read_b64_tr_b16 v[36:37], v7 offset:15552
  ds_read_b64_tr_b16 v[38:39], v7 offset:16032
  s_waitcnt lgkmcnt(6)
  v_mfma_f32_32x32x16_bf16 v[40:55], v[24:27], v[104:107], v[40:55]
  ds_read_b64_tr_b16 v[24:25], v7 offset:23040
  ds_read_b64_tr_b16 v[26:27], v7 offset:23520
  s_waitcnt lgkmcnt(6)
  v_mfma_f32_32x32x16_bf16 v[56:71], v[28:31], v[104:107], v[56:71]
  ds_read_b64_tr_b16 v[28:29], v7 offset:23104
  ds_read_b64_tr_b16 v[30:31], v7 offset:23584
  s_waitcnt lgkmcnt(6)
  v_mfma_f32_32x32x16_bf16 v[72:87], v[32:35], v[104:107], v[72:87]
  ds_read_b64_tr_b16 v[32:33], v7 offset:23168
  ds_read_b64_tr_b16 v[34:35], v7 offset:23648
  s_waitcnt lgkmcnt(6)
  v_mfma_f32_32x32x16_bf16 v[88:103], v[36:39], v[104:107], v[88:103]
  ds_read_b64_tr_b16 v[36:37], v7 offset:23232
  ds_read_b64_tr_b16 v[38:39], v7 offset:23712
  s_waitcnt lgkmcnt(6)
  v_mfma_f32_32x32x16_bf16 v[40:55], v[24:27], v[108:111], v[40:55]
  ds_read_b64_tr_b16 v[24:25], v7 offset:30720
  ds_read_b64_tr_b16 v[26:27], v7 offset:31200
  s_waitcnt lgkmcnt(6)
  v_mfma_f32_32x32x16_bf16 v[56:71], v[28:31], v[108:111], v[56:71]
  ds_read_b64_tr_b16 v[28:29], v7 offset:30784
  ds_read_b64_tr_b16 v[30:31], v7 offset:31264
  s_waitcnt lgkmcnt(6)
  v_mfma_f32_32x32x16_bf16 v[72:87], v[32:35], v[108:111], v[72:87]
  ds_read_b64_tr_b16 v[32:33], v7 offset:30848
  ds_read_b64_tr_b16 v[34:35], v7 offset:31328
  s_waitcnt lgkmcnt(6)
  v_mfma_f32_32x32x16_bf16 v[88:103], v[36:39], v[108:111], v[88:103]
  s_waitcnt vmcnt(0)
  s_cmp_lg_u32 s43, 0
  s_cbranch_scc1 L_att0_pdone
L_att0_poll:
  v_readlane_b32 s46, v18, 0
  v_readlane_b32 s54, v18, 1
  s_nop 0
  s_min_u32 s46, s46, s54
  s_cmp_ge_u32 s46, 128
  s_cbranch_scc1 L_att0_pdone
  s_sleep 2
  buffer_load_dword v18, v19, s[36:39], 0 offen sc1
  s_waitcnt vmcnt(0)
  s_branch L_att0_poll
L_att0_pdone:
  s_nop 3
  ds_read_b64_tr_b16 v[36:37], v7 offset:30912
  ds_read_b64_tr_b16 v[38:39], v7 offset:31392
  s_waitcnt lgkmcnt(6)
  v_mfma_f32_32x32x16_bf16 v[40:55], v[24:27], v[112:115], v[40:55]
  ds_read_b64_tr_b16 v[24:25], v7 offset:38400
  ds_read_b64_tr_b16 v[26:27], v7 offset:38880
  s_waitcnt lgkmcnt(6)
  v_mfma_f32_32x32x16_bf16 v[56:71], v[28:31], v[112:115], v[56:71]
  ds_read_b64_tr_b16 v[28:29], v7 offset:38464
  ds_read_b64_tr_b16 v[30:31], v7 offset:38944
  s_waitcnt lgkmcnt(6)
  v_mfma_f32_32x32x16_bf16 v[72:87], v[32:35], v[112:115], v[72:87]
  ds_read_b64_tr_b16 v[32:33], v7 offset:38528
  ds_read_b64_tr_b16 v[34:35], v7 offset:39008
  s_waitcnt lgkmcnt(6)
  v_mfma_f32_32x32x16_bf16 v[88:103], v[36:39], v[112:115], v[88:103]
  ds_read_b64_tr_b16 v[36:37], v7 offset:38592
  ds_read_b64_tr_b16 v[38:39], v7 offset:39072
  s_waitcnt lgkmcnt(6)
  v_mfma_f32_32x32x16_bf16 v[40:55], v[24:27], v[116:119], v[40:55]
  s_barrier
  ds_read_b128 v[120:123], v10 offset:0
  ds_read_b128 v[124:127], v11 offset:0
  ds_read_b128 v[128:131], v12 offset:0
  ds_read_b128 v[132:135], v13 offset:0
  ds_read_b64_tr_b16 v[24:25], v6 offset:0
  ds_read_b64_tr_b16 v[26:27], v6 offset:480
  s_waitcnt lgkmcnt(10)
  v_mfma_f32_32x32x16_bf16 v[56:71], v[28:31], v[116:119], v[56:71]
  ds_read_b64_tr_b16 v[28:29], v6 offset:64
  ds_read_b64_tr_b16 v[30:31], v6 offset:544
  s_waitcnt lgkmcnt(10)
  v_mfma_f32_32x32x16_bf16 v[72:87], v[32:35], v[116:119], v[72:87]
  ds_read_b64_tr_b16 v[32:33], v6 offset:128
  ds_read_b64_tr_b16 v[34:35], v6 offset:608
  s_waitcnt lgkmcnt(10)
  v_mfma_f32_32x32x16_bf16 v[88:103], v[36:39], v[116:119], v[88:103]
  s_lshl_b32 s46, s40, 10
  s_lshl_b32 s54, s43, 8
  s_add_u32 s46, s46, s54
  s_add_u32 s46, s46, 12644352
  v_lshlrev_b32 v22, 3, v16
  buffer_load_dwordx2 v[14:15], v22, s[28:31], s46 offen sc1
  s_lshl_b32 s46, s41, 14
  s_lshl_b32 s54, s43, 8
  s_add_u32 s46, s46, s54
  s_add_u32 s46, s46, 12677120
  v_lshlrev_b32 v23, 2, v1
  buffer_load_dword v136, v23, s[28:31], s46 offen offset:0 sc1
  buffer_load_dword v137, v23, s[28:31], s46 offen offset:1024 sc1
  buffer_load_dword v138, v23, s[28:31], s46 offen offset:2048 sc1
  buffer_load_dword v139, v23, s[28:31], s46 offen offset:3072 sc1
  s_add_u32 s46, s46, 4096
  buffer_load_dword v140, v23, s[28:31], s46 offen offset:0 sc1
  buffer_load_dword v141, v23, s[28:31], s46 offen offset:1024 sc1
  buffer_load_dword v142, v23, s[28:31], s46 offen offset:2048 sc1
  buffer_load_dword v143, v23, s[28:31], s46 offen offset:3072 sc1
  s_add_u32 s46, s46, 4096
  buffer_load_dword v144, v23, s[28:31], s46 offen offset:0 sc1
  buffer_load_dword v145, v23, s[28:31], s46 offen offset:1024 sc1
  buffer_load_dword v146, v23, s[28:31], s46 offen offset:2048 sc1
  buffer_load_dword v147, v23, s[28:31], s46 offen offset:3072 sc1
  s_add_u32 s46, s46, 4096
  buffer_load_dword v148, v23, s[28:31], s46 offen offset:0 sc1
  buffer_load_dword v149, v23, s[28:31], s46 offen offset:1024 sc1
  buffer_load_dword v150, v23, s[28:31], s46 offen offset:2048 sc1
  buffer_load_dword v151, v23, s[28:31], s46 offen offset:3072 sc1
  ds_read_b64_tr_b16 v[36:37], v6 offset:192
  ds_read_b64_tr_b16 v[38:39], v6 offset:672
  s_waitcnt lgkmcnt(6)
  v_mfma_f32_32x32x16_bf16 v[40:55], v[24:27], v[120:123], v[40:55]
  ds_read_b64_tr_b16 v[24:25], v6 offset:7680
  ds_read_b64_tr_b16 v[26:27], v6 offset:8160
  s_waitcnt lgkmcnt(6)
  v_mfma_f32_32x32x16_bf16 v[56:71], v[28:31], v[120:123], v[56:71]
  ds_read_b64_tr_b16 v[28:29], v6 offset:7744
  ds_read_b64_tr_b16 v[30:31], v6 offset:8224
  s_waitcnt lgkmcnt(6)
  v_mfma_f32_32x32x16_bf16 v[72:87], v[32:35], v[120:123], v[72:87]
  ds_read_b64_tr_b16 v[32:33], v6 offset:7808
  ds_read_b64_tr_b16 v[34:35], v6 offset:8288
  s_waitcnt lgkmcnt(6)
  v_mfma_f32_32x32x16_bf16 v[88:103], v[36:39], v[120:123], v[88:103]
  ds_read_b64_tr_b16 v[36:37], v6 offset:7872
  ds_read_b64_tr_b16 v[38:39], v6 offset:8352
  s_waitcnt lgkmcnt(6)
  v_mfma_f32_32x32x16_bf16 v[40:55], v[24:27], v[124:127], v[40:55]
  ds_read_b64_tr_b16 v[24:25], v6 offset:15360
  ds_read_b64_tr_b16 v[26:27], v6 offset:15840
  s_waitcnt lgkmcnt(6)
  v_mfma_f32_32x32x16_bf16 v[56:71], v[28:31], v[124:127], v[56:71]
  ds_read_b64_tr_b16 v[28:29], v6 offset:15424
  ds_read_b64_tr_b16 v[30:31], v6 offset:15904
  s_waitcnt lgkmcnt(6)
  v_mfma_f32_32x32x16_bf16 v[72:87], v[32:35], v[124:127], v[72:87]
  ds_read_b64_tr_b16 v[32:33], v6 offset:15488
  ds_read_b64_tr_b16 v[34:35], v6 offset:15968
  s_waitcnt lgkmcnt(6)
  v_mfma_f32_32x32x16_bf16 v[88:103], v[36:39], v[124:127], v[88:103]
  ds_read_b64_tr_b16 v[36:37], v6 offset:15552
  ds_read_b64_tr_b16 v[38:39], v6 offset:16032
  s_waitcnt lgkmcnt(6)
  v_mfma_f32_32x32x16_bf16 v[40:55], v[24:27], v[128:131], v[40:55]
  ds_read_b64_tr_b16 v[24:25], v6 offset:23040
  ds_read_b64_tr_b16 v[26:27], v6 offset:23520
  s_waitcnt lgkmcnt(6)
  v_mfma_f32_32x32x16_bf16 v[56:71], v[28:31], v[128:131], v[56:71]
  ds_read_b64_tr_b16 v[28:29], v6 offset:23104
  ds_read_b64_tr_b16 v[30:31], v6 offset:23584
  s_waitcnt lgkmcnt(6)
  v_mfma_f32_32x32x16_bf16 v[72:87], v[32:35], v[128:131], v[72:87]
  ds_read_b64_tr_b16 v[32:33], v6 offset:23168
  ds_read_b64_tr_b16 v[34:35], v6 offset:23648
  s_waitcnt lgkmcnt(6)
  v_mfma_f32_32x32x16_bf16 v[88:103], v[36:39], v[128:131], v[88:103]
  ds_read_b64_tr_b16 v[36:37], v6 offset:23232
  ds_read_b64_tr_b16 v[38:39], v6 offset:23712
  s_waitcnt lgkmcnt(6)
  v_mfma_f32_32x32x16_bf16 v[40:55], v[24:27], v[132:135], v[40:55]
  s_waitcnt lgkmcnt(4)
  v_mfma_f32_32x32x16_bf16 v[56:71], v[28:31], v[132:135], v[56:71]
  s_waitcnt lgkmcnt(2)
  v_mfma_f32_32x32x16_bf16 v[72:87], v[32:35], v[132:135], v[72:87]
  s_waitcnt lgkmcnt(0)
  v_mfma_f32_32x32x16_bf16 v[88:103], v[36:39], v[132:135], v[88:103]
  s_waitcnt vmcnt(0)
  v_add_f32 v136, v136, v144
  v_add_f32 v137, v137, v145
  v_add_f32 v138, v138, v146
  v_add_f32 v139, v139, v147
  v_add_f32 v140, v140, v148
  v_add_f32 v141, v141, v149
  v_add_f32 v142, v142, v150
  v_add_f32 v143, v143, v151
  v_add_f32 v136, v136, v140
  v_add_f32 v137, v137, v141
  v_add_f32 v138, v138, v142
  v_add_f32 v139, v139, v143
  v_add_f32 v136, v136, v138
  v_add_f32 v137, v137, v139
  v_add_f32 v136, v136, v137
  s_lshl_b32 s46, s43, 8
  s_add_u32 s46, s46, 156672
  v_add_u32 v23, s46, v23
  ds_write_b32 v23, v136
  s_waitcnt lgkmcnt(0)
  v_bfe_u32 v247, v1, 2, 2
  v_lshl_add_u32 v247, v17, 2, v247
  v_mul_u32_u24 v247, 192, v247
  v_and_b32 v228, 1, v3
  v_lshl_add_u32 v247, v228, 5, v247
  v_and_b32 v228, 3, v1
  v_lshl_add_u32 v247, v228, 3, v247
  v_add_u32 v247, 141312, v247
  ds_read_b64_tr_b16 v[168:169], v247 offset:0
  ds_read_b64_tr_b16 v[170:171], v247 offset:1536
  ds_read_b64_tr_b16 v[172:173], v247 offset:3072
  ds_read_b64_tr_b16 v[174:175], v247 offset:4608
  ds_read_b64_tr_b16 v[176:177], v247 offset:6144
  ds_read_b64_tr_b16 v[178:179], v247 offset:7680
  ds_read_b64_tr_b16 v[180:181], v247 offset:9216
  ds_read_b64_tr_b16 v[182:183], v247 offset:10752
  ds_read_b64_tr_b16 v[184:185], v247 offset:12288
  ds_read_b64_tr_b16 v[186:187], v247 offset:13824
  ds_read_b64_tr_b16 v[188:189], v247 offset:64
  ds_read_b64_tr_b16 v[190:191], v247 offset:1600
  ds_read_b64_tr_b16 v[192:193], v247 offset:3136
  ds_read_b64_tr_b16 v[194:195], v247 offset:4672
  ds_read_b64_tr_b16 v[196:197], v247 offset:6208
  ds_read_b64_tr_b16 v[198:199], v247 offset:7744
  ds_read_b64_tr_b16 v[200:201], v247 offset:9280
  ds_read_b64_tr_b16 v[202:203], v247 offset:10816
  ds_read_b64_tr_b16 v[204:205], v247 offset:12352
  ds_read_b64_tr_b16 v[206:207], v247 offset:13888
  ds_read_b64_tr_b16 v[208:209], v247 offset:128
  ds_read_b64_tr_b16 v[210:211], v247 offset:1664
  ds_read_b64_tr_b16 v[212:213], v247 offset:3200
  ds_read_b64_tr_b16 v[214:215], v247 offset:4736
  ds_read_b64_tr_b16 v[216:217], v247 offset:6272
  ds_read_b64_tr_b16 v[218:219], v247 offset:7808
  ds_read_b64_tr_b16 v[220:221], v247 offset:9344
  ds_read_b64_tr_b16 v[222:223], v247 offset:10880
  ds_read_b64_tr_b16 v[224:225], v247 offset:12416
  ds_read_b64_tr_b16 v[226:227], v247 offset:13952
  v_mul_f32 v246, s48, v15
  s_barrier
  s_setprio 2
  v_lshlrev_b32 v229, 4, v17
  v_add_u32 v229, 156672, v229
  ds_read_b128 v[104:107], v229 offset:0
  ds_read_b128 v[108:111], v229 offset:32
  ds_read_b128 v[112:115], v229 offset:64
  ds_read_b128 v[116:119], v229 offset:96
  ds_read_b128 v[120:123], v229 offset:128
  ds_read_b128 v[124:127], v229 offset:160
  ds_read_b128 v[128:131], v229 offset:192
  ds_read_b128 v[132:135], v229 offset:224
  ds_read_b128 v[136:139], v229 offset:256
  ds_read_b128 v[140:143], v229 offset:288
  ds_read_b128 v[144:147], v229 offset:320
  ds_read_b128 v[148:151], v229 offset:352
  ds_read_b128 v[152:155], v229 offset:384
  ds_read_b128 v[156:159], v229 offset:416
  ds_read_b128 v[160:163], v229 offset:448
  ds_read_b128 v[164:167], v229 offset:480
  s_mul_i32 s46, s43, 5120
  s_add_u32 s46, s46, 45056
  v_mul_u32_u24 v228, 160, v16
  v_lshl_add_u32 v228, v17, 3, v228
  v_add_u32 v228, s46, v228
  s_waitcnt lgkmcnt(4)
  v_fma_f32 v80, v144, v14, v80
  v_fma_f32 v81, v145, v14, v81
  v_fma_f32 v82, v146, v14, v82
  v_fma_f32 v83, v147, v14, v83
  v_mul_f32 v80, v80, v15
  v_mul_f32 v81, v81, v15
  v_mul_f32 v82, v82, v15
  v_mul_f32 v83, v83, v15
  v_cvt_pk_bf16_f32 v80, v80, v81
  v_cvt_pk_bf16_f32 v81, v82, v83
  ds_write_b64 v228, v[80:81] offset:0
  v_fma_f32 v84, v148, v14, v84
  v_fma_f32 v85, v149, v14, v85
  v_fma_f32 v86, v150, v14, v86
  v_fma_f32 v87, v151, v14, v87
  v_mul_f32 v84, v84, v15
  v_mul_f32 v85, v85, v15
  v_mul_f32 v86, v86, v15
  v_mul_f32 v87, v87, v15
  v_cvt_pk_bf16_f32 v84, v84, v85
  v_cvt_pk_bf16_f32 v85, v86, v87
  ds_write_b64 v228, v[84:85] offset:16
  s_waitcnt lgkmcnt(2)
  v_fma_f32 v88, v152, v14, v88
  v_fma_f32 v89, v153, v14, v89
  v_fma_f32 v90, v154, v14, v90
  v_fma_f32 v91, v155, v14, v91
  v_mul_f32 v88, v88, v15
  v_mul_f32 v89, v89, v15
  v_mul_f32 v90, v90, v15
  v_mul_f32 v91, v91, v15
  v_cvt_pk_bf16_f32 v88, v88, v89
  v_cvt_pk_bf16_f32 v89, v90, v91
  ds_write_b64 v228, v[88:89] offset:32
  v_fma_f32 v92, v156, v14, v92
  v_fma_f32 v93, v157, v14, v93
  v_fma_f32 v94, v158, v14, v94
  v_fma_f32 v95, v159, v14, v95
  v_mul_f32 v92, v92, v15
  v_mul_f32 v93, v93, v15
  v_mul_f32 v94, v94, v15
  v_mul_f32 v95, v95, v15
  v_cvt_pk_bf16_f32 v92, v92, v93
  v_cvt_pk_bf16_f32 v93, v94, v95
  ds_write_b64 v228, v[92:93] offset:48
  v_fma_f32 v96, v160, v14, v96
  v_fma_f32 v97, v161, v14, v97
  v_fma_f32 v98, v162, v14, v98
  v_fma_f32 v99, v163, v14, v99
  v_mul_f32 v96, v96, v15
  v_mul_f32 v97, v97, v15
  v_mul_f32 v98, v98, v15
  v_mul_f32 v99, v99, v15
  v_cvt_pk_bf16_f32 v96, v96, v97
  v_cvt_pk_bf16_f32 v97, v98, v99
  ds_write_b64 v228, v[96:97] offset:64
  v_fma_f32 v100, v164, v14, v100
  v_fma_f32 v101, v165, v14, v101
  v_fma_f32 v102, v166, v14, v102
  v_fma_f32 v103, v167, v14, v103
  v_mul_f32 v100, v100, v15
  v_mul_f32 v101, v101, v15
  v_mul_f32 v102, v102, v15
  v_mul_f32 v103, v103, v15
  v_cvt_pk_bf16_f32 v100, v100, v101
  v_cvt_pk_bf16_f32 v101, v102, v103
  ds_write_b64 v228, v[100:101] offset:80
  v_fma_f32 v40, v104, v14, v40
  v_fma_f32 v41, v105, v14, v41
  v_fma_f32 v42, v106, v14, v42
  v_fma_f32 v43, v107, v14, v43
  v_fma_f32 v44, v108, v14, v44
  v_fma_f32 v45, v109, v14, v45
  v_fma_f32 v46, v110, v14, v46
  v_fma_f32 v47, v111, v14, v47
  v_cvt_pk_bf16_f32 v24, v40, v41
  v_cvt_pk_bf16_f32 v25, v42, v43
  v_cvt_pk_bf16_f32 v26, v44, v45
  v_cvt_pk_bf16_f32 v27, v46, v47
  v_fma_f32 v48, v112, v14, v48
  v_fma_f32 v49, v113, v14, v49
  v_fma_f32 v50, v114, v14, v50
  v_fma_f32 v51, v115, v14, v51
  v_fma_f32 v52, v116, v14, v52
  v_fma_f32 v53, v117, v14, v53
  v_fma_f32 v54, v118, v14, v54
  v_fma_f32 v55, v119, v14, v55
  v_cvt_pk_bf16_f32 v28, v48, v49
  v_cvt_pk_bf16_f32 v29, v50, v51
  v_cvt_pk_bf16_f32 v30, v52, v53
  v_cvt_pk_bf16_f32 v31, v54, v55
  v_fma_f32 v56, v120, v14, v56
  v_fma_f32 v57, v121, v14, v57
  v_fma_f32 v58, v122, v14, v58
  v_fma_f32 v59, v123, v14, v59
  v_fma_f32 v60, v124, v14, v60
  v_fma_f32 v61, v125, v14, v61
  v_fma_f32 v62, v126, v14, v62
  v_fma_f32 v63, v127, v14, v63
  v_cvt_pk_bf16_f32 v32, v56, v57
  v_cvt_pk_bf16_f32 v33, v58, v59
  v_cvt_pk_bf16_f32 v34, v60, v61
  v_cvt_pk_bf16_f32 v35, v62, v63
  v_fma_f32 v64, v128, v14, v64
  v_fma_f32 v65, v129, v14, v65
  v_fma_f32 v66, v130, v14, v66
  v_fma_f32 v67, v131, v14, v67
  v_fma_f32 v68, v132, v14, v68
  v_fma_f32 v69, v133, v14, v69
  v_fma_f32 v70, v134, v14, v70
  v_fma_f32 v71, v135, v14, v71
  v_cvt_pk_bf16_f32 v36, v64, v65
  v_cvt_pk_bf16_f32 v37, v66, v67
  v_cvt_pk_bf16_f32 v38, v68, v69
  v_cvt_pk_bf16_f32 v39, v70, v71
  v_fma_f32 v72, v136, v14, v72
  v_fma_f32 v73, v137, v14, v73
  v_fma_f32 v74, v138, v14, v74
  v_fma_f32 v75, v139, v14, v75
  v_fma_f32 v76, v140, v14, v76
  v_fma_f32 v77, v141, v14, v77
  v_fma_f32 v78, v142, v14, v78
  v_fma_f32 v79, v143, v14, v79
  v_cvt_pk_bf16_f32 v248, v72, v73
  v_cvt_pk_bf16_f32 v249, v74, v75
  v_cvt_pk_bf16_f32 v250, v76, v77
  v_cvt_pk_bf16_f32 v251, v78, v79
  v_mfma_f32_32x32x16_bf16 v[104:119], v[168:171], v[24:27], 0
  v_mfma_f32_32x32x16_bf16 v[120:135], v[188:191], v[24:27], 0
  v_mfma_f32_32x32x16_bf16 v[136:151], v[208:211], v[24:27], 0
  v_mfma_f32_32x32x16_bf16 v[104:119], v[172:175], v[28:31], v[104:119]
  v_mfma_f32_32x32x16_bf16 v[120:135], v[192:195], v[28:31], v[120:135]
  v_mfma_f32_32x32x16_bf16 v[136:151], v[212:215], v[28:31], v[136:151]
  v_mfma_f32_32x32x16_bf16 v[104:119], v[176:179], v[32:35], v[104:119]
  v_mfma_f32_32x32x16_bf16 v[120:135], v[196:199], v[32:35], v[120:135]
  v_mfma_f32_32x32x16_bf16 v[136:151], v[216:219], v[32:35], v[136:151]
  v_mfma_f32_32x32x16_bf16 v[104:119], v[180:183], v[36:39], v[104:119]
  v_mfma_f32_32x32x16_bf16 v[120:135], v[200:203], v[36:39], v[120:135]
  v_mfma_f32_32x32x16_bf16 v[136:151], v[220:223], v[36:39], v[136:151]
  v_mfma_f32_32x32x16_bf16 v[104:119], v[184:187], v[248:251], v[104:119]
  v_mfma_f32_32x32x16_bf16 v[120:135], v[204:207], v[248:251], v[120:135]
  v_mfma_f32_32x32x16_bf16 v[136:151], v[224:227], v[248:251], v[136:151]
  s_mul_i32 s46, s43, 11264
  s_add_u32 s46, s46, 0
  v_mul_u32_u24 v230, 352, v16
  v_mul_u32_u24 v231, 160, v17
  v_add3_u32 v230, s46, v230, v231
  s_nop 4
  v_max3_f32 v238, v104, v105, v106
  v_min3_f32 v239, v104, v105, v106
  v_max3_f32 v238, v238, v107, v108
  v_min3_f32 v239, v239, v107, v108
  v_max3_f32 v238, v238, v109, v110
  v_min3_f32 v239, v239, v109, v110
  v_max3_f32 v238, v238, v111, v112
  v_min3_f32 v239, v239, v111, v112
  v_max3_f32 v238, v238, v113, v114
  v_min3_f32 v239, v239, v113, v114
  v_max3_f32 v238, v238, v115, v116
  v_min3_f32 v239, v239, v115, v116
  v_max3_f32 v238, v238, v117, v118
  v_min3_f32 v239, v239, v117, v118
  v_max3_f32 v238, v238, v119, v120
  v_min3_f32 v239, v239, v119, v120
  v_max3_f32 v238, v238, v121, v122
  v_min3_f32 v239, v239, v121, v122
  v_max_f32 v238, v238, v123
  v_min_f32 v239, v239, v123
  v_mul_f32 v238, v238, v246
  v_mul_f32 v239, v239, v246
  v_fma_f32 v40, v104, v246, -v238
  v_fma_f32 v41, v105, v246, -v238
  v_fma_f32 v60, -v104, v246, v239
  v_fma_f32 v61, -v105, v246, v239
  v_fma_f32 v42, v106, v246, -v238
  v_fma_f32 v43, v107, v246, -v238
  v_fma_f32 v62, -v106, v246, v239
  v_fma_f32 v63, -v107, v246, v239
  v_fma_f32 v44, v108, v246, -v238
  v_fma_f32 v45, v109, v246, -v238
  v_fma_f32 v64, -v108, v246, v239
  v_fma_f32 v65, -v109, v246, v239
  v_fma_f32 v46, v110, v246, -v238
  v_fma_f32 v47, v111, v246, -v238
  v_fma_f32 v66, -v110, v246, v239
  v_fma_f32 v67, -v111, v246, v239
  v_fma_f32 v48, v112, v246, -v238
  v_fma_f32 v49, v113, v246, -v238
  v_fma_f32 v68, -v112, v246, v239
  v_fma_f32 v69, -v113, v246, v239
  v_fma_f32 v50, v114, v246, -v238
  v_fma_f32 v51, v115, v246, -v238
  v_fma_f32 v70, -v114, v246, v239
  v_fma_f32 v71, -v115, v246, v239
  v_fma_f32 v52, v116, v246, -v238
  v_fma_f32 v53, v117, v246, -v238
  v_fma_f32 v72, -v116, v246, v239
  v_fma_f32 v73, -v117, v246, v239
  v_fma_f32 v54, v118, v246, -v238
  v_fma_f32 v55, v119, v246, -v238
  v_fma_f32 v74, -v118, v246, v239
  v_fma_f32 v75, -v119, v246, v239
  v_fma_f32 v56, v120, v246, -v238
  v_fma_f32 v57, v121, v246, -v238
  v_fma_f32 v76, -v120, v246, v239
  v_fma_f32 v77, -v121, v246, v239
  v_fma_f32 v58, v122, v246, -v238
  v_fma_f32 v59, v123, v246, -v238
  v_fma_f32 v78, -v122, v246, v239
  v_fma_f32 v79, -v123, v246, v239
  v_exp_f32 v40, v40
  v_exp_f32 v60, v60
  v_exp_f32 v41, v41
  v_exp_f32 v61, v61
  v_exp_f32 v42, v42
  v_exp_f32 v62, v62
  v_exp_f32 v43, v43
  v_exp_f32 v63, v63
  v_exp_f32 v44, v44
  v_exp_f32 v64, v64
  v_exp_f32 v45, v45
  v_exp_f32 v65, v65
  v_exp_f32 v46, v46
  v_exp_f32 v66, v66
  v_exp_f32 v47, v47
  v_exp_f32 v67, v67
  v_exp_f32 v48, v48
  v_exp_f32 v68, v68
  v_exp_f32 v49, v49
  v_exp_f32 v69, v69
  v_exp_f32 v50, v50
  v_exp_f32 v70, v70
  v_exp_f32 v51, v51
  v_exp_f32 v71, v71
  v_exp_f32 v52, v52
  v_exp_f32 v72, v72
  v_exp_f32 v53, v53
  v_exp_f32 v73, v73
  v_exp_f32 v54, v54
  v_exp_f32 v74, v74
  v_exp_f32 v55, v55
  v_exp_f32 v75, v75
  v_exp_f32 v56, v56
  v_exp_f32 v76, v76
  v_exp_f32 v57, v57
  v_exp_f32 v77, v77
  v_exp_f32 v58, v58
  v_exp_f32 v78, v78
  v_exp_f32 v59, v59
  v_exp_f32 v79, v79
  v_add_f32 v240, v40, v42
  v_add_f32 v241, v41, v43
  v_add_f32 v242, v60, v62
  v_add_f32 v243, v61, v63
  v_add_f32 v240, v240, v44
  v_add_f32 v241, v241, v45
  v_add_f32 v242, v242, v64
  v_add_f32 v243, v243, v65
  v_add_f32 v240, v240, v46
  v_add_f32 v241, v241, v47
  v_add_f32 v242, v242, v66
  v_add_f32 v243, v243, v67
  v_add_f32 v240, v240, v48
  v_add_f32 v241, v241, v49
  v_add_f32 v242, v242, v68
  v_add_f32 v243, v243, v69
  v_add_f32 v240, v240, v50
  v_add_f32 v241, v241, v51
  v_add_f32 v242, v242, v70
  v_add_f32 v243, v243, v71
  v_add_f32 v240, v240, v52
  v_add_f32 v241, v241, v53
  v_add_f32 v242, v242, v72
  v_add_f32 v243, v243, v73
  v_add_f32 v240, v240, v54
  v_add_f32 v241, v241, v55
  v_add_f32 v242, v242, v74
  v_add_f32 v243, v243, v75
  v_add_f32 v240, v240, v56
  v_add_f32 v241, v241, v57
  v_add_f32 v242, v242, v76
  v_add_f32 v243, v243, v77
  v_add_f32 v240, v240, v58
  v_add_f32 v241, v241, v59
  v_add_f32 v242, v242, v78
  v_add_f32 v243, v243, v79
  v_add_f32 v244, v240, v241
  v_add_f32 v245, v242, v243
  v_rcp_f32 v244, v244
  v_rcp_f32 v245, v245
  v_mul_f32 v40, v40, v244
  v_mul_f32 v41, v41, v244
  v_mul_f32 v60, v60, v245
  v_mul_f32 v61, v61, v245
  v_mul_f32 v42, v42, v244
  v_mul_f32 v43, v43, v244
  v_mul_f32 v62, v62, v245
  v_mul_f32 v63, v63, v245
  v_mul_f32 v44, v44, v244
  v_mul_f32 v45, v45, v244
  v_mul_f32 v64, v64, v245
  v_mul_f32 v65, v65, v245
  v_mul_f32 v46, v46, v244
  v_mul_f32 v47, v47, v244
  v_mul_f32 v66, v66, v245
  v_mul_f32 v67, v67, v245
  v_mul_f32 v48, v48, v244
  v_mul_f32 v49, v49, v244
  v_mul_f32 v68, v68, v245
  v_mul_f32 v69, v69, v245
  v_mul_f32 v50, v50, v244
  v_mul_f32 v51, v51, v244
  v_mul_f32 v70, v70, v245
  v_mul_f32 v71, v71, v245
  v_mul_f32 v52, v52, v244
  v_mul_f32 v53, v53, v244
  v_mul_f32 v72, v72, v245
  v_mul_f32 v73, v73, v245
  v_mul_f32 v54, v54, v244
  v_mul_f32 v55, v55, v244
  v_mul_f32 v74, v74, v245
  v_mul_f32 v75, v75, v245
  v_mul_f32 v56, v56, v244
  v_mul_f32 v57, v57, v244
  v_mul_f32 v76, v76, v245
  v_mul_f32 v77, v77, v245
  v_mul_f32 v58, v58, v244
  v_mul_f32 v59, v59, v244
  v_mul_f32 v78, v78, v245
  v_mul_f32 v79, v79, v245
  v_cvt_pk_bf16_f32 v104, v40, v41
  v_cvt_pk_bf16_f32 v114, v60, v61
  v_cvt_pk_bf16_f32 v105, v42, v43
  v_cvt_pk_bf16_f32 v115, v62, v63
  v_cvt_pk_bf16_f32 v106, v44, v45
  v_cvt_pk_bf16_f32 v116, v64, v65
  v_cvt_pk_bf16_f32 v107, v46, v47
  v_cvt_pk_bf16_f32 v117, v66, v67
  v_cvt_pk_bf16_f32 v108, v48, v49
  v_cvt_pk_bf16_f32 v118, v68, v69
  v_cvt_pk_bf16_f32 v109, v50, v51
  v_cvt_pk_bf16_f32 v119, v70, v71
  v_cvt_pk_bf16_f32 v110, v52, v53
  v_cvt_pk_bf16_f32 v120, v72, v73
  v_cvt_pk_bf16_f32 v111, v54, v55
  v_cvt_pk_bf16_f32 v121, v74, v75
  v_cvt_pk_bf16_f32 v112, v56, v57
  v_cvt_pk_bf16_f32 v122, v76, v77
  v_cvt_pk_bf16_f32 v113, v58, v59
  v_cvt_pk_bf16_f32 v123, v78, v79
  ds_write_b128 v230, v[104:107] offset:0
  ds_write_b128 v230, v[108:111] offset:16
  ds_write_b128 v230, v[112:115] offset:32
  ds_write_b128 v230, v[116:119] offset:48
  ds_write_b128 v230, v[120:123] offset:64
  v_max3_f32 v238, v124, v125, v126
  v_min3_f32 v239, v124, v125, v126
  v_max3_f32 v238, v238, v127, v128
  v_min3_f32 v239, v239, v127, v128
  v_max3_f32 v238, v238, v129, v130
  v_min3_f32 v239, v239, v129, v130
  v_max3_f32 v238, v238, v131, v132
  v_min3_f32 v239, v239, v131, v132
  v_max3_f32 v238, v238, v133, v134
  v_min3_f32 v239, v239, v133, v134
  v_max3_f32 v238, v238, v135, v136
  v_min3_f32 v239, v239, v135, v136
  v_max3_f32 v238, v238, v137, v138
  v_min3_f32 v239, v239, v137, v138
  v_max3_f32 v238, v238, v139, v140
  v_min3_f32 v239, v239, v139, v140
  v_max3_f32 v238, v238, v141, v142
  v_min3_f32 v239, v239, v141, v142
  v_max_f32 v238, v238, v143
  v_min_f32 v239, v239, v143
  v_mul_f32 v238, v238, v246
  v_mul_f32 v239, v239, v246
  v_fma_f32 v40, v124, v246, -v238
  v_fma_f32 v41, v125, v246, -v238
  v_fma_f32 v60, -v124, v246, v239
  v_fma_f32 v61, -v125, v246, v239
  v_fma_f32 v42, v126, v246, -v238
  v_fma_f32 v43, v127, v246, -v238
  v_fma_f32 v62, -v126, v246, v239
  v_fma_f32 v63, -v127, v246, v239
  v_fma_f32 v44, v128, v246, -v238
  v_fma_f32 v45, v129, v246, -v238
  v_fma_f32 v64, -v128, v246, v239
  v_fma_f32 v65, -v129, v246, v239
  v_fma_f32 v46, v130, v246, -v238
  v_fma_f32 v47, v131, v246, -v238
  v_fma_f32 v66, -v130, v246, v239
  v_fma_f32 v67, -v131, v246, v239
  v_fma_f32 v48, v132, v246, -v238
  v_fma_f32 v49, v133, v246, -v238
  v_fma_f32 v68, -v132, v246, v239
  v_fma_f32 v69, -v133, v246, v239
  v_fma_f32 v50, v134, v246, -v238
  v_fma_f32 v51, v135, v246, -v238
  v_fma_f32 v70, -v134, v246, v239
  v_fma_f32 v71, -v135, v246, v239
  v_fma_f32 v52, v136, v246, -v238
  v_fma_f32 v53, v137, v246, -v238
  v_fma_f32 v72, -v136, v246, v239
  v_fma_f32 v73, -v137, v246, v239
  v_fma_f32 v54, v138, v246, -v238
  v_fma_f32 v55, v139, v246, -v238
  v_fma_f32 v74, -v138, v246, v239
  v_fma_f32 v75, -v139, v246, v239
  v_fma_f32 v56, v140, v246, -v238
  v_fma_f32 v57, v141, v246, -v238
  v_fma_f32 v76, -v140, v246, v239
  v_fma_f32 v77, -v141, v246, v239
  v_fma_f32 v58, v142, v246, -v238
  v_fma_f32 v59, v143, v246, -v238
  v_fma_f32 v78, -v142, v246, v239
  v_fma_f32 v79, -v143, v246, v239
  v_exp_f32 v40, v40
  v_exp_f32 v60, v60
  v_exp_f32 v41, v41
  v_exp_f32 v61, v61
  v_exp_f32 v42, v42
  v_exp_f32 v62, v62
  v_exp_f32 v43, v43
  v_exp_f32 v63, v63
  v_exp_f32 v44, v44
  v_exp_f32 v64, v64
  v_exp_f32 v45, v45
  v_exp_f32 v65, v65
  v_exp_f32 v46, v46
  v_exp_f32 v66, v66
  v_exp_f32 v47, v47
  v_exp_f32 v67, v67
  v_exp_f32 v48, v48
  v_exp_f32 v68, v68
  v_exp_f32 v49, v49
  v_exp_f32 v69, v69
  v_exp_f32 v50, v50
  v_exp_f32 v70, v70
  v_exp_f32 v51, v51
  v_exp_f32 v71, v71
  v_exp_f32 v52, v52
  v_exp_f32 v72, v72
  v_exp_f32 v53, v53
  v_exp_f32 v73, v73
  v_exp_f32 v54, v54
  v_exp_f32 v74, v74
  v_exp_f32 v55, v55
  v_exp_f32 v75, v75
  v_exp_f32 v56, v56
  v_exp_f32 v76, v76
  v_exp_f32 v57, v57
  v_exp_f32 v77, v77
  v_exp_f32 v58, v58
  v_exp_f32 v78, v78
  v_exp_f32 v59, v59
  v_exp_f32 v79, v79
  v_add_f32 v240, v40, v42
  v_add_f32 v241, v41, v43
  v_add_f32 v242, v60, v62
  v_add_f32 v243, v61, v63
  v_add_f32 v240, v240, v44
  v_add_f32 v241, v241, v45
  v_add_f32 v242, v242, v64
  v_add_f32 v243, v243, v65
  v_add_f32 v240, v240, v46
  v_add_f32 v241, v241, v47
  v_add_f32 v242, v242, v66
  v_add_f32 v243, v243, v67
  v_add_f32 v240, v240, v48
  v_add_f32 v241, v241, v49
  v_add_f32 v242, v242, v68
  v_add_f32 v243, v243, v69
  v_add_f32 v240, v240, v50
  v_add_f32 v241, v241, v51
  v_add_f32 v242, v242, v70
  v_add_f32 v243, v243, v71
  v_add_f32 v240, v240, v52
  v_add_f32 v241, v241, v53
  v_add_f32 v242, v242, v72
  v_add_f32 v243, v243, v73
  v_add_f32 v240, v240, v54
  v_add_f32 v241, v241, v55
  v_add_f32 v242, v242, v74
  v_add_f32 v243, v243, v75
  v_add_f32 v240, v240, v56
  v_add_f32 v241, v241, v57
  v_add_f32 v242, v242, v76
  v_add_f32 v243, v243, v77
  v_add_f32 v240, v240, v58
  v_add_f32 v241, v241, v59
  v_add_f32 v242, v242, v78
  v_add_f32 v243, v243, v79
  v_add_f32 v244, v240, v241
  v_add_f32 v245, v242, v243
  v_rcp_f32 v244, v244
  v_rcp_f32 v245, v245
  v_mul_f32 v40, v40, v244
  v_mul_f32 v41, v41, v244
  v_mul_f32 v60, v60, v245
  v_mul_f32 v61, v61, v245
  v_mul_f32 v42, v42, v244
  v_mul_f32 v43, v43, v244
  v_mul_f32 v62, v62, v245
  v_mul_f32 v63, v63, v245
  v_mul_f32 v44, v44, v244
  v_mul_f32 v45, v45, v244
  v_mul_f32 v64, v64, v245
  v_mul_f32 v65, v65, v245
  v_mul_f32 v46, v46, v244
  v_mul_f32 v47, v47, v244
  v_mul_f32 v66, v66, v245
  v_mul_f32 v67, v67, v245
  v_mul_f32 v48, v48, v244
  v_mul_f32 v49, v49, v244
  v_mul_f32 v68, v68, v245
  v_mul_f32 v69, v69, v245
  v_mul_f32 v50, v50, v244
  v_mul_f32 v51, v51, v244
  v_mul_f32 v70, v70, v245
  v_mul_f32 v71, v71, v245
  v_mul_f32 v52, v52, v244
  v_mul_f32 v53, v53, v244
  v_mul_f32 v72, v72, v245
  v_mul_f32 v73, v73, v245
  v_mul_f32 v54, v54, v244
  v_mul_f32 v55, v55, v244
  v_mul_f32 v74, v74, v245
  v_mul_f32 v75, v75, v245
  v_mul_f32 v56, v56, v244
  v_mul_f32 v57, v57, v244
  v_mul_f32 v76, v76, v245
  v_mul_f32 v77, v77, v245
  v_mul_f32 v58, v58, v244
  v_mul_f32 v59, v59, v244
  v_mul_f32 v78, v78, v245
  v_mul_f32 v79, v79, v245
  v_cvt_pk_bf16_f32 v124, v40, v41
  v_cvt_pk_bf16_f32 v134, v60, v61
  v_cvt_pk_bf16_f32 v125, v42, v43
  v_cvt_pk_bf16_f32 v135, v62, v63
  v_cvt_pk_bf16_f32 v126, v44, v45
  v_cvt_pk_bf16_f32 v136, v64, v65
  v_cvt_pk_bf16_f32 v127, v46, v47
  v_cvt_pk_bf16_f32 v137, v66, v67
  v_cvt_pk_bf16_f32 v128, v48, v49
  v_cvt_pk_bf16_f32 v138, v68, v69
  v_cvt_pk_bf16_f32 v129, v50, v51
  v_cvt_pk_bf16_f32 v139, v70, v71
  v_cvt_pk_bf16_f32 v130, v52, v53
  v_cvt_pk_bf16_f32 v140, v72, v73
  v_cvt_pk_bf16_f32 v131, v54, v55
  v_cvt_pk_bf16_f32 v141, v74, v75
  v_cvt_pk_bf16_f32 v132, v56, v57
  v_cvt_pk_bf16_f32 v142, v76, v77
  v_cvt_pk_bf16_f32 v133, v58, v59
  v_cvt_pk_bf16_f32 v143, v78, v79
  ds_write_b128 v230, v[124:127] offset:80
  ds_write_b128 v230, v[128:131] offset:96
  ds_write_b128 v230, v[132:135] offset:112
  ds_write_b128 v230, v[136:139] offset:128
  ds_write_b128 v230, v[140:143] offset:144
  v_lshrrev_b32 v234, 1, v3
  v_lshlrev_b32 v234, 4, v234
  v_and_b32 v235, 1, v3
  v_lshl_add_u32 v234, v235, 2, v234
  v_bfe_u32 v235, v1, 2, 2
  v_add_u32 v234, v234, v235
  v_mul_u32_u24 v234, 352, v234
  v_and_b32 v235, 3, v1
  v_lshl_add_u32 v232, v235, 3, v234
  s_mul_i32 s46, s43, 80
  s_add_u32 s46, s46, 0
  v_add_u32 v232, s46, v232
  v_lshrrev_b32 v234, 1, v3
  v_lshlrev_b32 v234, 4, v234
  v_and_b32 v235, 1, v3
  v_lshl_add_u32 v234, v235, 2, v234
  v_bfe_u32 v235, v1, 2, 2
  v_add_u32 v234, v234, v235
  v_mul_u32_u24 v234, 160, v234
  v_and_b32 v235, 3, v1
  v_lshl_add_u32 v233, v235, 3, v234
  s_mul_i32 s46, s43, 40
  s_add_u32 s46, s46, 45056
  v_add_u32 v233, s46, v233
  v_cmp_eq_u32 s[52:53], 4, v2
  s_waitcnt lgkmcnt(0)
  v_mov_b32 v234, 157696
  v_mov_b32 v235, 1
  s_mov_b64 exec, 1
  ds_add_u32 v234, v235
  s_mov_b64 exec, -1
L_kvflag:
  ds_read_b32 v235, v234
  s_waitcnt lgkmcnt(0)
  v_readfirstlane_b32 s46, v235
  s_nop 0
  s_cmp_ge_u32 s46, 8
  s_cbranch_scc0 L_kvflag
  ds_read_b64_tr_b16 v[104:105], v232 offset:0
  ds_read_b64_tr_b16 v[106:107], v232 offset:2816
  ds_read_b64_tr_b16 v[108:109], v232 offset:32
  ds_read_b64_tr_b16 v[110:111], v232 offset:2848
  ds_read_b64_tr_b16 v[112:113], v232 offset:64
  ds_read_b64_tr_b16 v[114:115], v232 offset:2880
  ds_read_b64_tr_b16 v[116:117], v233 offset:0
  ds_read_b64_tr_b16 v[118:119], v233 offset:1280
  ds_read_b64_tr_b16 v[120:121], v233 offset:32
  ds_read_b64_tr_b16 v[122:123], v233 offset:1312
  ds_read_b64_tr_b16 v[124:125], v232 offset:11264
  ds_read_b64_tr_b16 v[126:127], v232 offset:14080
  ds_read_b64_tr_b16 v[128:129], v232 offset:11296
  ds_read_b64_tr_b16 v[130:131], v232 offset:14112
  ds_read_b64_tr_b16 v[132:133], v232 offset:11328
  ds_read_b64_tr_b16 v[134:135], v232 offset:14144
  ds_read_b64_tr_b16 v[136:137], v233 offset:5120
  ds_read_b64_tr_b16 v[138:139], v233 offset:6400
  ds_read_b64_tr_b16 v[140:141], v233 offset:5152
  ds_read_b64_tr_b16 v[142:143], v233 offset:6432
  ds_read_b64_tr_b16 v[144:145], v232 offset:22528
  ds_read_b64_tr_b16 v[146:147], v232 offset:25344
  ds_read_b64_tr_b16 v[148:149], v232 offset:22560
  ds_read_b64_tr_b16 v[150:151], v232 offset:25376
  ds_read_b64_tr_b16 v[152:153], v232 offset:22592
  ds_read_b64_tr_b16 v[154:155], v232 offset:25408
  ds_read_b64_tr_b16 v[156:157], v233 offset:10240
  ds_read_b64_tr_b16 v[158:159], v233 offset:11520
  ds_read_b64_tr_b16 v[160:161], v233 offset:10272
  ds_read_b64_tr_b16 v[162:163], v233 offset:11552
  ds_read_b64_tr_b16 v[164:165], v232 offset:33792
  ds_read_b64_tr_b16 v[166:167], v232 offset:36608
  ds_read_b64_tr_b16 v[168:169], v232 offset:33824
  ds_read_b64_tr_b16 v[170:171], v232 offset:36640
  ds_read_b64_tr_b16 v[172:173], v232 offset:33856
  ds_read_b64_tr_b16 v[174:175], v232 offset:36672
  ds_read_b64_tr_b16 v[176:177], v233 offset:15360
  ds_read_b64_tr_b16 v[178:179], v233 offset:16640
  ds_read_b64_tr_b16 v[180:181], v233 offset:15392
  ds_read_b64_tr_b16 v[182:183], v233 offset:16672
  s_waitcnt lgkmcnt(15)
  v_cndmask_b32 v120, v120, v20, s[52:53]
  v_cndmask_b32 v121, v121, v20, s[52:53]
  v_cndmask_b32 v122, v122, v20, s[52:53]
  v_cndmask_b32 v123, v123, v20, s[52:53]
  v_mfma_f32_16x16x32_bf16 v[40:43], v[116:119], v[104:107], 0
  v_mfma_f32_16x16x32_bf16 v[44:47], v[116:119], v[108:111], 0
  v_mfma_f32_16x16x32_bf16 v[48:51], v[116:119], v[112:115], 0
  v_mfma_f32_16x16x32_bf16 v[52:55], v[120:123], v[104:107], 0
  v_mfma_f32_16x16x32_bf16 v[56:59], v[120:123], v[108:111], 0
  v_mfma_f32_16x16x32_bf16 v[60:63], v[120:123], v[112:115], 0
  v_cndmask_b32 v140, v140, v20, s[52:53]
  v_cndmask_b32 v141, v141, v20, s[52:53]
  v_cndmask_b32 v142, v142, v20, s[52:53]
  v_cndmask_b32 v143, v143, v20, s[52:53]
  v_mfma_f32_16x16x32_bf16 v[40:43], v[136:139], v[124:127], v[40:43]
  v_mfma_f32_16x16x32_bf16 v[44:47], v[136:139], v[128:131], v[44:47]
  v_mfma_f32_16x16x32_bf16 v[48:51], v[136:139], v[132:135], v[48:51]
  v_mfma_f32_16x16x32_bf16 v[52:55], v[140:143], v[124:127], v[52:55]
  v_mfma_f32_16x16x32_bf16 v[56:59], v[140:143], v[128:131], v[56:59]
  v_mfma_f32_16x16x32_bf16 v[60:63], v[140:143], v[132:135], v[60:63]
  s_waitcnt lgkmcnt(10)
  v_cndmask_b32 v160, v160, v20, s[52:53]
  v_cndmask_b32 v161, v161, v20, s[52:53]
  v_cndmask_b32 v162, v162, v20, s[52:53]
  v_cndmask_b32 v163, v163, v20, s[52:53]
  v_mfma_f32_16x16x32_bf16 v[40:43], v[156:159], v[144:147], v[40:43]
  v_mfma_f32_16x16x32_bf16 v[44:47], v[156:159], v[148:151], v[44:47]
  v_mfma_f32_16x16x32_bf16 v[48:51], v[156:159], v[152:155], v[48:51]
  v_mfma_f32_16x16x32_bf16 v[52:55], v[160:163], v[144:147], v[52:55]
  v_mfma_f32_16x16x32_bf16 v[56:59], v[160:163], v[148:151], v[56:59]
  v_mfma_f32_16x16x32_bf16 v[60:63], v[160:163], v[152:155], v[60:63]
  s_waitcnt lgkmcnt(0)
  v_cndmask_b32 v180, v180, v20, s[52:53]
  v_cndmask_b32 v181, v181, v20, s[52:53]
  v_cndmask_b32 v182, v182, v20, s[52:53]
  v_cndmask_b32 v183, v183, v20, s[52:53]
  v_mfma_f32_16x16x32_bf16 v[40:43], v[176:179], v[164:167], v[40:43]
  v_mfma_f32_16x16x32_bf16 v[44:47], v[176:179], v[168:171], v[44:47]
  v_mfma_f32_16x16x32_bf16 v[48:51], v[176:179], v[172:175], v[48:51]
  v_mfma_f32_16x16x32_bf16 v[52:55], v[180:183], v[164:167], v[52:55]
  v_mfma_f32_16x16x32_bf16 v[56:59], v[180:183], v[168:171], v[56:59]
  v_mfma_f32_16x16x32_bf16 v[60:63], v[180:183], v[172:175], v[60:63]
  s_lshl_b32 s46, s41, 2
  s_add_u32 s46, s46, s43
  s_mul_i32 s46, s46, 3360
  s_add_u32 s46, s46, 12320768
  s_mul_i32 s54, s40, 43
  s_lshr_b32 s54, s54, 7
  s_mul_i32 s54, s54, 3
  s_sub_u32 s54, s40, s54
  s_mul_i32 s54, s54, 107520
  s_add_u32 s46, s46, s54
  s_lshl_b32 s54, s43, 12
  s_add_u32 s54, s54, 65536
  v_mul_u32_u24 v228, 640, v3
  v_lshl_add_u32 v228, v2, 2, v228
  v_add_u32 v228, s54, v228
  s_mov_b32 exec_lo, 0xffffffff
  s_mov_b32 exec_hi, 0xffffffff
  ds_write_b32 v228, v40 offset:0
  s_mov_b32 exec_lo, 0xffffffff
  s_mov_b32 exec_hi, 0xffffffff
  ds_write_b32 v228, v41 offset:160
  s_mov_b32 exec_lo, 0xffffffff
  s_mov_b32 exec_hi, 0xffffffff
  ds_write_b32 v228, v42 offset:320
  s_mov_b32 exec_lo, 0xffffffff
  s_mov_b32 exec_hi, 0xffffffff
  ds_write_b32 v228, v43 offset:480
  s_mov_b32 exec_lo, 0xffffffff
  s_mov_b32 exec_hi, 0xffffffff
  ds_write_b32 v228, v44 offset:64
  s_mov_b32 exec_lo, 0xffffffff
  s_mov_b32 exec_hi, 0xffffffff
  ds_write_b32 v228, v45 offset:224
  s_mov_b32 exec_lo, 0xffffffff
  s_mov_b32 exec_hi, 0xffffffff
  ds_write_b32 v228, v46 offset:384
  s_mov_b32 exec_lo, 0xffffffff
  s_mov_b32 exec_hi, 0xffffffff
  ds_write_b32 v228, v47 offset:544
  s_mov_b32 exec_lo, 0xff00ff
  s_mov_b32 exec_hi, 0xff00ff
  ds_write_b32 v228, v48 offset:128
  s_mov_b32 exec_lo, 0xff00ff
  s_mov_b32 exec_hi, 0xff00ff
  ds_write_b32 v228, v49 offset:288
  s_mov_b32 exec_lo, 0xff00ff
  s_mov_b32 exec_hi, 0xff00ff
  ds_write_b32 v228, v50 offset:448
  s_mov_b32 exec_lo, 0xff00ff
  s_mov_b32 exec_hi, 0xff00ff
  ds_write_b32 v228, v51 offset:608
  s_mov_b32 exec_lo, 0xffffffff
  s_mov_b32 exec_hi, 0x0
  ds_write_b32 v228, v52 offset:2560
  s_mov_b32 exec_lo, 0xffff
  s_mov_b32 exec_hi, 0x0
  ds_write_b32 v228, v53 offset:2720
  s_mov_b32 exec_lo, 0xffff
  s_mov_b32 exec_hi, 0x0
  ds_write_b32 v228, v54 offset:2880
  s_mov_b32 exec_lo, 0xffff
  s_mov_b32 exec_hi, 0x0
  ds_write_b32 v228, v55 offset:3040
  s_mov_b32 exec_lo, 0xffffffff
  s_mov_b32 exec_hi, 0x0
  ds_write_b32 v228, v56 offset:2624
  s_mov_b32 exec_lo, 0xffff
  s_mov_b32 exec_hi, 0x0
  ds_write_b32 v228, v57 offset:2784
  s_mov_b32 exec_lo, 0xffff
  s_mov_b32 exec_hi, 0x0
  ds_write_b32 v228, v58 offset:2944
  s_mov_b32 exec_lo, 0xffff
  s_mov_b32 exec_hi, 0x0
  ds_write_b32 v228, v59 offset:3104
  s_mov_b32 exec_lo, 0xff00ff
  s_mov_b32 exec_hi, 0x0
  ds_write_b32 v228, v60 offset:2688
  s_mov_b32 exec_lo, 0xff
  s_mov_b32 exec_hi, 0x0
  ds_write_b32 v228, v61 offset:2848
  s_mov_b32 exec_lo, 0xff
  s_mov_b32 exec_hi, 0x0
  ds_write_b32 v228, v62 offset:3008
  s_mov_b32 exec_lo, 0xff
  s_mov_b32 exec_hi, 0x0
  ds_write_b32 v228, v63 offset:3168
  s_mov_b64 exec, -1
  v_lshlrev_b32 v229, 2, v1
  v_add_u32 v228, s54, v229
  ds_read_b32 v104, v228 offset:0
  ds_read_b32 v105, v228 offset:256
  ds_read_b32 v106, v228 offset:512
  ds_read_b32 v107, v228 offset:768
  ds_read_b32 v108, v228 offset:1024
  ds_read_b32 v109, v228 offset:1280
  ds_read_b32 v110, v228 offset:1536
  ds_read_b32 v111, v228 offset:1792
  ds_read_b32 v112, v228 offset:2048
  ds_read_b32 v113, v228 offset:2304
  ds_read_b32 v114, v228 offset:2560
  ds_read_b32 v115, v228 offset:2816
  ds_read_b32 v116, v228 offset:3072
  ds_read_b32 v117, v228 offset:3328
  s_waitcnt lgkmcnt(13)
  buffer_atomic_add_f32 v104, v229, s[28:31], s46 offen offset:0
  s_waitcnt lgkmcnt(12)
  buffer_atomic_add_f32 v105, v229, s[28:31], s46 offen offset:256
  s_waitcnt lgkmcnt(11)
  buffer_atomic_add_f32 v106, v229, s[28:31], s46 offen offset:512
  s_waitcnt lgkmcnt(10)
  buffer_atomic_add_f32 v107, v229, s[28:31], s46 offen offset:768
  s_waitcnt lgkmcnt(9)
  buffer_atomic_add_f32 v108, v229, s[28:31], s46 offen offset:1024
  s_waitcnt lgkmcnt(8)
  buffer_atomic_add_f32 v109, v229, s[28:31], s46 offen offset:1280
  s_waitcnt lgkmcnt(7)
  buffer_atomic_add_f32 v110, v229, s[28:31], s46 offen offset:1536
  s_waitcnt lgkmcnt(6)
  buffer_atomic_add_f32 v111, v229, s[28:31], s46 offen offset:1792
  s_waitcnt lgkmcnt(5)
  buffer_atomic_add_f32 v112, v229, s[28:31], s46 offen offset:2048
  s_waitcnt lgkmcnt(4)
  buffer_atomic_add_f32 v113, v229, s[28:31], s46 offen offset:2304
  s_waitcnt lgkmcnt(3)
  buffer_atomic_add_f32 v114, v229, s[28:31], s46 offen offset:2560
  s_waitcnt lgkmcnt(2)
  buffer_atomic_add_f32 v115, v229, s[28:31], s46 offen offset:2816
  s_waitcnt lgkmcnt(1)
  buffer_atomic_add_f32 v116, v229, s[28:31], s46 offen offset:3072
  s_waitcnt lgkmcnt(0)
  s_mov_b64 exec, 0xff
  buffer_atomic_add_f32 v117, v229, s[28:31], s46 offen offset:3328
  s_mov_b64 exec, -1
  s_waitcnt vmcnt(0)
  s_endpgm
L_att_B:
  s_waitcnt vmcnt(4)
  s_barrier
  ds_read_b128 v[104:107], v10 offset:0
  ds_read_b128 v[108:111], v11 offset:0
  ds_read_b128 v[112:115], v12 offset:0
  ds_read_b128 v[116:119], v13 offset:0
  s_mov_b32 s50, 368640
  s_add_u32 m0, s45, 46080
  s_nop 0
  buffer_load_dwordx4 v4, s[24:27], s50 offen lds
  s_add_u32 m0, s45, 47104
  s_mov_b32 exec_hi, 0xffffff
  buffer_load_dwordx4 v5, s[24:27], s50 offen lds
  s_mov_b64 exec, -1
  ds_read_b64_tr_b16 v[24:25], v6 offset:0
  ds_read_b64_tr_b16 v[26:27], v6 offset:480
  ds_read_b64_tr_b16 v[28:29], v6 offset:64
  ds_read_b64_tr_b16 v[30:31], v6 offset:544
  ds_read_b64_tr_b16 v[32:33], v6 offset:128
  ds_read_b64_tr_b16 v[34:35], v6 offset:608
  ds_read_b64_tr_b16 v[36:37], v6 offset:192
  ds_read_b64_tr_b16 v[38:39], v6 offset:672
  s_waitcnt lgkmcnt(6)
  v_mfma_f32_32x32x16_bf16 v[40:55], v[24:27], v[104:107], 0
  v_lshlrev_b32 v244, 16, v224
  v_and_b32 v245, 0xffff0000, v224
  v_lshlrev_b32 v246, 16, v225
  ds_read_b64_tr_b16 v[24:25], v6 offset:7680
  ds_read_b64_tr_b16 v[26:27], v6 offset:8160
  s_waitcnt lgkmcnt(6)
  v_mfma_f32_32x32x16_bf16 v[56:71], v[28:31], v[104:107], 0
  v_and_b32 v247, 0xffff0000, v225
  v_lshlrev_b32 v238, 16, v226
  v_and_b32 v239, 0xffff0000, v226
  v_add_f32 v244, v244, v238
  ds_read_b64_tr_b16 v[28:29], v6 offset:7744
  ds_read_b64_tr_b16 v[30:31], v6 offset:8224
  s_waitcnt lgkmcnt(6)
  v_mfma_f32_32x32x16_bf16 v[72:87], v[32:35], v[104:107], 0
  v_add_f32 v245, v245, v239
  v_lshlrev_b32 v238, 16, v227
  v_and_b32 v239, 0xffff0000, v227
  v_add_f32 v246, v246, v238
  ds_read_b64_tr_b16 v[32:33], v6 offset:7808
  ds_read_b64_tr_b16 v[34:35], v6 offset:8288
  s_waitcnt lgkmcnt(6)
  v_mfma_f32_32x32x16_bf16 v[88:103], v[36:39], v[104:107], 0
  s_mov_b32 s50, 491520
  s_add_u32 m0, s45, 61440
  s_nop 0
  buffer_load_dwordx4 v4, s[24:27], s50 offen lds
  s_add_u32 m0, s45, 62464
  s_mov_b32 exec_hi, 0xffffff
  buffer_load_dwordx4 v5, s[24:27], s50 offen lds
  s_mov_b64 exec, -1
  s_add_u32 s50, s49, 256
  s_add_u32 m0, s47, 124928
  s_nop 0
  buffer_load_dwordx4 v8, s[20:23], s50 offen lds
  s_add_u32 m0, s47, 125952
  s_nop 0
  buffer_load_dwordx4 v9, s[20:23], s50 offen lds
  v_add_f32 v247, v247, v239
  v_lshlrev_b32 v238, 16, v228
  v_and_b32 v239, 0xffff0000, v228
  v_add_f32 v244, v244, v238
  ds_read_b64_tr_b16 v[36:37], v6 offset:7872
  ds_read_b64_tr_b16 v[38:39], v6 offset:8352
  s_waitcnt lgkmcnt(6)
  v_mfma_f32_32x32x16_bf16 v[40:55], v[24:27], v[108:111], v[40:55]
  v_add_f32 v245, v245, v239
  v_lshlrev_b32 v238, 16, v229
  v_and_b32 v239, 0xffff0000, v229
  v_add_f32 v246, v246, v238
  ds_read_b64_tr_b16 v[24:25], v6 offset:15360
  ds_read_b64_tr_b16 v[26:27], v6 offset:15840
  s_waitcnt lgkmcnt(6)
  v_mfma_f32_32x32x16_bf16 v[56:71], v[28:31], v[108:111], v[56:71]
  v_add_f32 v247, v247, v239
  v_lshlrev_b32 v238, 16, v230
  v_and_b32 v239, 0xffff0000, v230
  v_add_f32 v244, v244, v238
  ds_read_b64_tr_b16 v[28:29], v6 offset:15424
  ds_read_b64_tr_b16 v[30:31], v6 offset:15904
  s_waitcnt lgkmcnt(6)
  v_mfma_f32_32x32x16_bf16 v[72:87], v[32:35], v[108:111], v[72:87]
  v_add_f32 v245, v245, v239
  v_lshlrev_b32 v238, 16, v231
  v_and_b32 v239, 0xffff0000, v231
  v_add_f32 v246, v246, v238
  ds_read_b64_tr_b16 v[32:33], v6 offset:15488
  ds_read_b64_tr_b16 v[34:35], v6 offset:15968
  s_waitcnt lgkmcnt(6)
  v_mfma_f32_32x32x16_bf16 v[88:103], v[36:39], v[108:111], v[88:103]
  v_add_f32 v247, v247, v239
  v_lshlrev_b32 v238, 16, v232
  v_and_b32 v239, 0xffff0000, v232
  v_add_f32 v244, v244, v238
  ds_read_b64_tr_b16 v[36:37], v6 offset:15552
  ds_read_b64_tr_b16 v[38:39], v6 offset:16032
  s_waitcnt lgkmcnt(6)
  v_mfma_f32_32x32x16_bf16 v[40:55], v[24:27], v[112:115], v[40:55]
  v_add_f32 v245, v245, v239
  v_lshlrev_b32 v238, 16, v233
  v_and_b32 v239, 0xffff0000, v233
  v_add_f32 v246, v246, v238
  ds_read_b64_tr_b16 v[24:25], v6 offset:23040
  ds_read_b64_tr_b16 v[26:27], v6 offset:23520
  s_waitcnt lgkmcnt(6)
  v_mfma_f32_32x32x16_bf16 v[56:71], v[28:31], v[112:115], v[56:71]
  v_add_f32 v247, v247, v239
  s_lshl_b32 s62, s42, 10
  s_add_u32 s62, s62, 141312
  v_lshlrev_b32 v238, 4, v1
  ds_read_b64_tr_b16 v[28:29], v6 offset:23104
  ds_read_b64_tr_b16 v[30:31], v6 offset:23584
  s_waitcnt lgkmcnt(6)
  v_mfma_f32_32x32x16_bf16 v[72:87], v[32:35], v[112:115], v[72:87]
  v_add_u32 v238, s62, v238
  ds_write_b128 v238, v[244:247]
  v_add_u32 v200, 0, v0
  v_mul_u32_u24 v201, 2731, v200
  ds_read_b64_tr_b16 v[32:33], v6 offset:23168
  ds_read_b64_tr_b16 v[34:35], v6 offset:23648
  s_waitcnt lgkmcnt(7)
  v_mfma_f32_32x32x16_bf16 v[88:103], v[36:39], v[112:115], v[88:103]
  v_lshrrev_b32 v201, 16, v201
  v_mul_u32_u24 v202, 24, v201
  v_sub_u32 v202, v200, v202
  v_mul_u32_u24 v203, 3277, v201
  ds_read_b64_tr_b16 v[36:37], v6 offset:23232
  ds_read_b64_tr_b16 v[38:39], v6 offset:23712
  s_waitcnt lgkmcnt(7)
  v_mfma_f32_32x32x16_bf16 v[40:55], v[24:27], v[116:119], v[40:55]
  v_lshrrev_b32 v203, 16, v203
  v_mul_u32_u24 v204, 20, v203
  v_sub_u32 v204, v201, v204
  v_lshrrev_b32 v205, 1, v202
  s_waitcnt vmcnt(4) lgkmcnt(4)
  s_barrier
  ds_read_b128 v[120:123], v10 offset:16384
  ds_read_b128 v[124:127], v11 offset:16384
  ds_read_b128 v[128:131], v12 offset:16384
  ds_read_b128 v[132:135], v13 offset:16384
  s_mov_b32 s50, 614400
  s_add_u32 m0, s45, 76800
  s_nop 0
  buffer_load_dwordx4 v4, s[24:27], s50 offen lds
  s_add_u32 m0, s45, 77824
  s_mov_b32 exec_hi, 0xffffff
  buffer_load_dwordx4 v5, s[24:27], s50 offen lds
  s_mov_b64 exec, -1
  ds_read_b64_tr_b16 v[24:25], v6 offset:30720
  ds_read_b64_tr_b16 v[26:27], v6 offset:31200
  v_mfma_f32_32x32x16_bf16 v[56:71], v[28:31], v[116:119], v[56:71]
  v_lshlrev_b32 v205, 2, v205
  v_and_b32 v206, 1, v202
  v_lshlrev_b32 v206, 1, v206
  v_cmp_lt_u32 vcc, 19, v205
  ds_read_b64_tr_b16 v[28:29], v6 offset:30784
  ds_read_b64_tr_b16 v[30:31], v6 offset:31264
  s_waitcnt lgkmcnt(10)
  v_mfma_f32_32x32x16_bf16 v[72:87], v[32:35], v[116:119], v[72:87]
  v_addc_co_u32 v206, vcc, 0, v206, vcc
  v_cmp_lt_u32 vcc, 19, v205
  v_subrev_u32 v208, 20, v205
  s_nop 0
  v_cndmask_b32 v208, v205, v208, vcc
  ds_read_b64_tr_b16 v[32:33], v6 offset:30848
  ds_read_b64_tr_b16 v[34:35], v6 offset:31328
  s_waitcnt lgkmcnt(10)
  v_mfma_f32_32x32x16_bf16 v[88:103], v[36:39], v[116:119], v[88:103]
  v_mul_u32_u24 v207, 800, v203
  v_mul_u32_u24 v204, 40, v204
  v_add_u32 v207, v207, v204
  v_lshl_add_u32 v207, v208, 1, v207
  ds_read_b64_tr_b16 v[36:37], v6 offset:30912
  ds_read_b64_tr_b16 v[38:39], v6 offset:31392
  s_waitcnt lgkmcnt(6)
  v_mfma_f32_32x32x16_bf16 v[40:55], v[24:27], v[120:123], v[40:55]
  v_mov_b32 v204, 0x7ffffff0
  v_cmp_eq_u32 vcc, v206, v203
  s_nop 1
  v_cndmask_b32 v207, v204, v207, vcc
  v_cmp_gt_u32 vcc, 40, v205
  ds_read_b64_tr_b16 v[24:25], v6 offset:38400
  ds_read_b64_tr_b16 v[26:27], v6 offset:38880
  s_waitcnt lgkmcnt(6)
  v_mfma_f32_32x32x16_bf16 v[56:71], v[28:31], v[120:123], v[56:71]
  v_cndmask_b32 v207, v204, v207, vcc
  s_mul_i32 s85, s41, 3200
  buffer_load_dwordx2 v[184:185], v207, s[32:35], s85 offen
  v_lshlrev_b32 v192, 3, v200
  ds_read_b64_tr_b16 v[28:29], v6 offset:38464
  ds_read_b64_tr_b16 v[30:31], v6 offset:38944
  s_waitcnt lgkmcnt(6)
  v_mfma_f32_32x32x16_bf16 v[72:87], v[32:35], v[120:123], v[72:87]
  v_add_u32 v192, 141312, v192
  v_add_u32 v200, 512, v0
  v_mul_u32_u24 v201, 2731, v200
  v_lshrrev_b32 v201, 16, v201
  ds_read_b64_tr_b16 v[32:33], v6 offset:38528
  ds_read_b64_tr_b16 v[34:35], v6 offset:39008
  s_waitcnt lgkmcnt(6)
  v_mfma_f32_32x32x16_bf16 v[88:103], v[36:39], v[120:123], v[88:103]
  s_mov_b32 s50, 737280
  s_add_u32 m0, s45, 0
  s_nop 0
  buffer_load_dwordx4 v4, s[24:27], s50 offen lds
  s_add_u32 m0, s45, 1024
  s_mov_b32 exec_hi, 0xffffff
  buffer_load_dwordx4 v5, s[24:27], s50 offen lds
  s_mov_b64 exec, -1
  s_add_u32 s50, s49, 384
  s_add_u32 m0, s47, 92160
  s_nop 0
  buffer_load_dwordx4 v8, s[20:23], s50 offen lds
  s_add_u32 m0, s47, 93184
  s_nop 0
  buffer_load_dwordx4 v9, s[20:23], s50 offen lds
  v_mul_u32_u24 v202, 24, v201
  v_sub_u32 v202, v200, v202
  v_mul_u32_u24 v203, 3277, v201
  v_lshrrev_b32 v203, 16, v203
  ds_read_b64_tr_b16 v[36:37], v6 offset:38592
  ds_read_b64_tr_b16 v[38:39], v6 offset:39072
  s_waitcnt lgkmcnt(6)
  v_mfma_f32_32x32x16_bf16 v[40:55], v[24:27], v[124:127], v[40:55]
  v_mul_u32_u24 v204, 20, v203
  v_sub_u32 v204, v201, v204
  v_lshrrev_b32 v205, 1, v202
  v_lshlrev_b32 v205, 2, v205
  ds_read_b64_tr_b16 v[24:25], v7 offset:0
  ds_read_b64_tr_b16 v[26:27], v7 offset:480
  s_waitcnt lgkmcnt(6)
  v_mfma_f32_32x32x16_bf16 v[56:71], v[28:31], v[124:127], v[56:71]
  v_and_b32 v206, 1, v202
  v_lshlrev_b32 v206, 1, v206
  v_cmp_lt_u32 vcc, 19, v205
  s_nop 1
  v_addc_co_u32 v206, vcc, 0, v206, vcc
  ds_read_b64_tr_b16 v[28:29], v7 offset:64
  ds_read_b64_tr_b16 v[30:31], v7 offset:544
  s_waitcnt lgkmcnt(6)
  v_mfma_f32_32x32x16_bf16 v[72:87], v[32:35], v[124:127], v[72:87]
  v_cmp_lt_u32 vcc, 19, v205
  v_subrev_u32 v208, 20, v205
  s_nop 0
  v_cndmask_b32 v208, v205, v208, vcc
  v_mul_u32_u24 v207, 800, v203
  ds_read_b64_tr_b16 v[32:33], v7 offset:128
  ds_read_b64_tr_b16 v[34:35], v7 offset:608
  s_waitcnt lgkmcnt(6)
  v_mfma_f32_32x32x16_bf16 v[88:103], v[36:39], v[124:127], v[88:103]
  v_mul_u32_u24 v204, 40, v204
  v_add_u32 v207, v207, v204
  v_lshl_add_u32 v207, v208, 1, v207
  v_mov_b32 v204, 0x7ffffff0
  ds_read_b64_tr_b16 v[36:37], v7 offset:192
  ds_read_b64_tr_b16 v[38:39], v7 offset:672
  s_waitcnt lgkmcnt(6)
  v_mfma_f32_32x32x16_bf16 v[40:55], v[24:27], v[128:131], v[40:55]
  v_cmp_eq_u32 vcc, v206, v203
  s_nop 1
  v_cndmask_b32 v207, v204, v207, vcc
  v_cmp_gt_u32 vcc, 40, v205
  s_nop 1
  v_cndmask_b32 v207, v204, v207, vcc
  ds_read_b64_tr_b16 v[24:25], v7 offset:7680
  ds_read_b64_tr_b16 v[26:27], v7 offset:8160
  s_waitcnt lgkmcnt(6)
  v_mfma_f32_32x32x16_bf16 v[56:71], v[28:31], v[128:131], v[56:71]
  s_mul_i32 s85, s41, 3200
  buffer_load_dwordx2 v[186:187], v207, s[32:35], s85 offen
  v_lshlrev_b32 v193, 3, v200
  v_add_u32 v193, 141312, v193
  ds_read_b64_tr_b16 v[28:29], v7 offset:7744
  ds_read_b64_tr_b16 v[30:31], v7 offset:8224
  s_waitcnt lgkmcnt(6)
  v_mfma_f32_32x32x16_bf16 v[72:87], v[32:35], v[128:131], v[72:87]
  v_add_u32 v200, 1024, v0
  v_mul_u32_u24 v201, 2731, v200
  v_lshrrev_b32 v201, 16, v201
  v_mul_u32_u24 v202, 24, v201
  ds_read_b64_tr_b16 v[32:33], v7 offset:7808
  ds_read_b64_tr_b16 v[34:35], v7 offset:8288
  s_waitcnt lgkmcnt(6)
  v_mfma_f32_32x32x16_bf16 v[88:103], v[36:39], v[128:131], v[88:103]
  v_sub_u32 v202, v200, v202
  v_mul_u32_u24 v203, 3277, v201
  v_lshrrev_b32 v203, 16, v203
  v_mul_u32_u24 v204, 20, v203
  ds_read_b64_tr_b16 v[36:37], v7 offset:7872
  ds_read_b64_tr_b16 v[38:39], v7 offset:8352
  s_waitcnt lgkmcnt(6)
  v_mfma_f32_32x32x16_bf16 v[40:55], v[24:27], v[132:135], v[40:55]
  v_sub_u32 v204, v201, v204
  v_lshrrev_b32 v205, 1, v202
  v_lshlrev_b32 v205, 2, v205
  v_and_b32 v206, 1, v202
  s_waitcnt vmcnt(6)
  s_barrier
  ds_read_b128 v[104:107], v10 offset:32768
  ds_read_b128 v[108:111], v11 offset:32768
  ds_read_b128 v[112:115], v12 offset:32768
  ds_read_b128 v[116:119], v13 offset:32768
  s_mov_b32 s50, 860160
  s_add_u32 m0, s45, 15360
  s_nop 0
  buffer_load_dwordx4 v4, s[24:27], s50 offen lds
  s_add_u32 m0, s45, 16384
  s_mov_b32 exec_hi, 0xffffff
  buffer_load_dwordx4 v5, s[24:27], s50 offen lds
  s_mov_b64 exec, -1
  ds_read_b64_tr_b16 v[24:25], v7 offset:15360
  ds_read_b64_tr_b16 v[26:27], v7 offset:15840
  s_waitcnt lgkmcnt(10)
  v_mfma_f32_32x32x16_bf16 v[56:71], v[28:31], v[132:135], v[56:71]
  v_lshlrev_b32 v206, 1, v206
  v_cmp_lt_u32 vcc, 19, v205
  s_nop 1
  v_addc_co_u32 v206, vcc, 0, v206, vcc
  v_cmp_lt_u32 vcc, 19, v205
  ds_read_b64_tr_b16 v[28:29], v7 offset:15424
  ds_read_b64_tr_b16 v[30:31], v7 offset:15904
  s_waitcnt lgkmcnt(10)
  v_mfma_f32_32x32x16_bf16 v[72:87], v[32:35], v[132:135], v[72:87]
  v_subrev_u32 v208, 20, v205
  v_cndmask_b32 v208, v205, v208, vcc
  v_mul_u32_u24 v207, 800, v203
  v_mul_u32_u24 v204, 40, v204
  ds_read_b64_tr_b16 v[32:33], v7 offset:15488
  ds_read_b64_tr_b16 v[34:35], v7 offset:15968
  s_waitcnt lgkmcnt(10)
  v_mfma_f32_32x32x16_bf16 v[88:103], v[36:39], v[132:135], v[88:103]
  v_add_u32 v207, v207, v204
  v_lshl_add_u32 v207, v208, 1, v207
  v_mov_b32 v204, 0x7ffffff0
  v_cmp_eq_u32 vcc, v206, v203
  ds_read_b64_tr_b16 v[36:37], v7 offset:15552
  ds_read_b64_tr_b16 v[38:39], v7 offset:16032
  s_waitcnt lgkmcnt(6)
  v_mfma_f32_32x32x16_bf16 v[40:55], v[24:27], v[104:107], v[40:55]
  v_cndmask_b32 v207, v204, v207, vcc
  v_cmp_gt_u32 vcc, 40, v205
  s_nop 1
  v_cndmask_b32 v207, v204, v207, vcc
  s_mul_i32 s85, s41, 3200
  ds_read_b64_tr_b16 v[24:25], v7 offset:23040
  ds_read_b64_tr_b16 v[26:27], v7 offset:23520
  s_waitcnt lgkmcnt(6)
  v_mfma_f32_32x32x16_bf16 v[56:71], v[28:31], v[104:107], v[56:71]
  buffer_load_dwordx2 v[188:189], v207, s[32:35], s85 offen
  v_lshlrev_b32 v194, 3, v200
  v_add_u32 v194, 141312, v194
  v_add_u32 v200, 1536, v0
  ds_read_b64_tr_b16 v[28:29], v7 offset:23104
  ds_read_b64_tr_b16 v[30:31], v7 offset:23584
  s_waitcnt lgkmcnt(6)
  v_mfma_f32_32x32x16_bf16 v[72:87], v[32:35], v[104:107], v[72:87]
  v_mul_u32_u24 v201, 2731, v200
  v_lshrrev_b32 v201, 16, v201
  v_mul_u32_u24 v202, 24, v201
  v_sub_u32 v202, v200, v202
  ds_read_b64_tr_b16 v[32:33], v7 offset:23168
  ds_read_b64_tr_b16 v[34:35], v7 offset:23648
  s_waitcnt lgkmcnt(6)
  v_mfma_f32_32x32x16_bf16 v[88:103], v[36:39], v[104:107], v[88:103]
  s_mov_b32 s50, 983040
  s_add_u32 m0, s45, 30720
  s_nop 0
  buffer_load_dwordx4 v4, s[24:27], s50 offen lds
  s_add_u32 m0, s45, 31744
  s_mov_b32 exec_hi, 0xffffff
  buffer_load_dwordx4 v5, s[24:27], s50 offen lds
  s_mov_b64 exec, -1
  s_add_u32 s50, s49, 512
  s_add_u32 m0, s47, 108544
  s_nop 0
  buffer_load_dwordx4 v8, s[20:23], s50 offen lds
  s_add_u32 m0, s47, 109568
  s_nop 0
  buffer_load_dwordx4 v9, s[20:23], s50 offen lds
  v_mul_u32_u24 v203, 3277, v201
  v_lshrrev_b32 v203, 16, v203
  v_mul_u32_u24 v204, 20, v203
  v_sub_u32 v204, v201, v204
  ds_read_b64_tr_b16 v[36:37], v7 offset:23232
  ds_read_b64_tr_b16 v[38:39], v7 offset:23712
  s_waitcnt lgkmcnt(6)
  v_mfma_f32_32x32x16_bf16 v[40:55], v[24:27], v[108:111], v[40:55]
  v_lshrrev_b32 v205, 1, v202
  v_lshlrev_b32 v205, 2, v205
  v_and_b32 v206, 1, v202
  v_lshlrev_b32 v206, 1, v206
  ds_read_b64_tr_b16 v[24:25], v7 offset:30720
  ds_read_b64_tr_b16 v[26:27], v7 offset:31200
  s_waitcnt lgkmcnt(6)
  v_mfma_f32_32x32x16_bf16 v[56:71], v[28:31], v[108:111], v[56:71]
  v_cmp_lt_u32 vcc, 19, v205
  s_nop 1
  v_addc_co_u32 v206, vcc, 0, v206, vcc
  v_cmp_lt_u32 vcc, 19, v205
  v_subrev_u32 v208, 20, v205
  ds_read_b64_tr_b16 v[28:29], v7 offset:30784
  ds_read_b64_tr_b16 v[30:31], v7 offset:31264
  s_waitcnt lgkmcnt(6)
  v_mfma_f32_32x32x16_bf16 v[72:87], v[32:35], v[108:111], v[72:87]
  v_cndmask_b32 v208, v205, v208, vcc
  v_mul_u32_u24 v207, 800, v203
  v_mul_u32_u24 v204, 40, v204
  v_add_u32 v207, v207, v204
  ds_read_b64_tr_b16 v[32:33], v7 offset:30848
  ds_read_b64_tr_b16 v[34:35], v7 offset:31328
  s_waitcnt lgkmcnt(6)
  v_mfma_f32_32x32x16_bf16 v[88:103], v[36:39], v[108:111], v[88:103]
  v_lshl_add_u32 v207, v208, 1, v207
  v_mov_b32 v204, 0x7ffffff0
  v_cmp_eq_u32 vcc, v206, v203
  s_nop 1
  v_cndmask_b32 v207, v204, v207, vcc
  ds_read_b64_tr_b16 v[36:37], v7 offset:30912
  ds_read_b64_tr_b16 v[38:39], v7 offset:31392
  s_waitcnt lgkmcnt(6)
  v_mfma_f32_32x32x16_bf16 v[40:55], v[24:27], v[112:115], v[40:55]
  v_cmp_gt_u32 vcc, 40, v205
  s_nop 1
  v_cndmask_b32 v207, v204, v207, vcc
  s_mul_i32 s85, s41, 3200
  buffer_load_dwordx2 v[190:191], v207, s[32:35], s85 offen
  ds_read_b64_tr_b16 v[24:25], v7 offset:38400
  ds_read_b64_tr_b16 v[26:27], v7 offset:38880
  s_waitcnt lgkmcnt(6)
  v_mfma_f32_32x32x16_bf16 v[56:71], v[28:31], v[112:115], v[56:71]
  v_lshlrev_b32 v195, 3, v200
  v_add_u32 v195, 141312, v195
  ds_read_b64_tr_b16 v[28:29], v7 offset:38464
  ds_read_b64_tr_b16 v[30:31], v7 offset:38944
  s_waitcnt lgkmcnt(6)
  v_mfma_f32_32x32x16_bf16 v[72:87], v[32:35], v[112:115], v[72:87]
  ds_read_b64_tr_b16 v[32:33], v7 offset:38528
  ds_read_b64_tr_b16 v[34:35], v7 offset:39008
  s_waitcnt lgkmcnt(6)
  v_mfma_f32_32x32x16_bf16 v[88:103], v[36:39], v[112:115], v[88:103]
  ds_read_b64_tr_b16 v[36:37], v7 offset:38592
  ds_read_b64_tr_b16 v[38:39], v7 offset:39072
  s_waitcnt lgkmcnt(6)
  v_mfma_f32_32x32x16_bf16 v[40:55], v[24:27], v[116:119], v[40:55]
  s_waitcnt vmcnt(6)
  s_barrier
  ds_read_b128 v[120:123], v10 offset:0
  ds_read_b128 v[124:127], v11 offset:0
  ds_read_b128 v[128:131], v12 offset:0
  ds_read_b128 v[132:135], v13 offset:0
  s_mov_b32 s50, 1105920
  s_add_u32 m0, s45, 46080
  s_nop 0
  buffer_load_dwordx4 v4, s[24:27], s50 offen lds
  s_add_u32 m0, s45, 47104
  s_mov_b32 exec_hi, 0xffffff
  buffer_load_dwordx4 v5, s[24:27], s50 offen lds
  s_mov_b64 exec, -1
  ds_read_b64_tr_b16 v[24:25], v6 offset:0
  ds_read_b64_tr_b16 v[26:27], v6 offset:480
  s_waitcnt lgkmcnt(10)
  v_mfma_f32_32x32x16_bf16 v[56:71], v[28:31], v[116:119], v[56:71]
  ds_read_b64_tr_b16 v[28:29], v6 offset:64
  ds_read_b64_tr_b16 v[30:31], v6 offset:544
  s_waitcnt lgkmcnt(10)
  v_mfma_f32_32x32x16_bf16 v[72:87], v[32:35], v[116:119], v[72:87]
  ds_read_b64_tr_b16 v[32:33], v6 offset:128
  ds_read_b64_tr_b16 v[34:35], v6 offset:608
  s_waitcnt lgkmcnt(10)
  v_mfma_f32_32x32x16_bf16 v[88:103], v[36:39], v[116:119], v[88:103]
  ds_read_b64_tr_b16 v[36:37], v6 offset:192
  ds_read_b64_tr_b16 v[38:39], v6 offset:672
  s_waitcnt lgkmcnt(6)
  v_mfma_f32_32x32x16_bf16 v[40:55], v[24:27], v[120:123], v[40:55]
  ds_read_b64_tr_b16 v[24:25], v6 offset:7680
  ds_read_b64_tr_b16 v[26:27], v6 offset:8160
  s_waitcnt lgkmcnt(6)
  v_mfma_f32_32x32x16_bf16 v[56:71], v[28:31], v[120:123], v[56:71]
  ds_read_b64_tr_b16 v[28:29], v6 offset:7744
  ds_read_b64_tr_b16 v[30:31], v6 offset:8224
  s_waitcnt lgkmcnt(6)
  v_mfma_f32_32x32x16_bf16 v[72:87], v[32:35], v[120:123], v[72:87]
  ds_read_b64_tr_b16 v[32:33], v6 offset:7808
  ds_read_b64_tr_b16 v[34:35], v6 offset:8288
  s_waitcnt lgkmcnt(6)
  v_mfma_f32_32x32x16_bf16 v[88:103], v[36:39], v[120:123], v[88:103]
  s_mov_b32 s50, 1228800
  s_add_u32 m0, s45, 61440
  s_nop 0
  buffer_load_dwordx4 v4, s[24:27], s50 offen lds
  s_add_u32 m0, s45, 62464
  s_mov_b32 exec_hi, 0xffffff
  buffer_load_dwordx4 v5, s[24:27], s50 offen lds
  s_mov_b64 exec, -1
  s_add_u32 s50, s49, 640
  s_add_u32 m0, s47, 124928
  s_nop 0
  buffer_load_dwordx4 v8, s[20:23], s50 offen lds
  s_add_u32 m0, s47, 125952
  s_nop 0
  buffer_load_dwordx4 v9, s[20:23], s50 offen lds
  ds_read_b64_tr_b16 v[36:37], v6 offset:7872
  ds_read_b64_tr_b16 v[38:39], v6 offset:8352
  s_waitcnt lgkmcnt(6)
  v_mfma_f32_32x32x16_bf16 v[40:55], v[24:27], v[124:127], v[40:55]
  ds_read_b64_tr_b16 v[24:25], v6 offset:15360
  ds_read_b64_tr_b16 v[26:27], v6 offset:15840
  s_waitcnt lgkmcnt(6)
  v_mfma_f32_32x32x16_bf16 v[56:71], v[28:31], v[124:127], v[56:71]
  ds_read_b64_tr_b16 v[28:29], v6 offset:15424
  ds_read_b64_tr_b16 v[30:31], v6 offset:15904
  s_waitcnt lgkmcnt(6)
  v_mfma_f32_32x32x16_bf16 v[72:87], v[32:35], v[124:127], v[72:87]
  ds_read_b64_tr_b16 v[32:33], v6 offset:15488
  ds_read_b64_tr_b16 v[34:35], v6 offset:15968
  s_waitcnt lgkmcnt(6)
  v_mfma_f32_32x32x16_bf16 v[88:103], v[36:39], v[124:127], v[88:103]
  ds_read_b64_tr_b16 v[36:37], v6 offset:15552
  ds_read_b64_tr_b16 v[38:39], v6 offset:16032
  s_waitcnt lgkmcnt(6)
  v_mfma_f32_32x32x16_bf16 v[40:55], v[24:27], v[128:131], v[40:55]
  s_waitcnt vmcnt(6)
  ds_write_b64 v192, v[184:185]
  ds_write_b64 v193, v[186:187]
  ds_write_b64 v194, v[188:189]
  ds_read_b64_tr_b16 v[24:25], v6 offset:23040
  ds_read_b64_tr_b16 v[26:27], v6 offset:23520
  s_waitcnt lgkmcnt(9)
  v_mfma_f32_32x32x16_bf16 v[56:71], v[28:31], v[128:131], v[56:71]
  v_cmp_gt_u32 vcc, 384, v0
  s_nop 0
  s_and_saveexec_b64 s[52:53], vcc
  ds_write_b64 v195, v[190:191]
  s_mov_b64 exec, -1
  ds_read_b64_tr_b16 v[28:29], v6 offset:23104
  ds_read_b64_tr_b16 v[30:31], v6 offset:23584
  s_waitcnt lgkmcnt(10)
  v_mfma_f32_32x32x16_bf16 v[72:87], v[32:35], v[128:131], v[72:87]
  ds_read_b64_tr_b16 v[32:33], v6 offset:23168
  ds_read_b64_tr_b16 v[34:35], v6 offset:23648
  s_waitcnt lgkmcnt(10)
  v_mfma_f32_32x32x16_bf16 v[88:103], v[36:39], v[128:131], v[88:103]
  ds_read_b64_tr_b16 v[36:37], v6 offset:23232
  ds_read_b64_tr_b16 v[38:39], v6 offset:23712
  s_waitcnt lgkmcnt(7)
  v_mfma_f32_32x32x16_bf16 v[40:55], v[24:27], v[132:135], v[40:55]
  s_waitcnt vmcnt(4) lgkmcnt(6)
  s_barrier
  ds_read_b128 v[104:107], v10 offset:16384
  ds_read_b128 v[108:111], v11 offset:16384
  ds_read_b128 v[112:115], v12 offset:16384
  ds_read_b128 v[116:119], v13 offset:16384
  s_mov_b32 s50, 1351680
  s_add_u32 m0, s45, 76800
  s_nop 0
  buffer_load_dwordx4 v4, s[24:27], s50 offen lds
  s_add_u32 m0, s45, 77824
  s_mov_b32 exec_hi, 0xffffff
  buffer_load_dwordx4 v5, s[24:27], s50 offen lds
  s_mov_b64 exec, -1
  ds_read_b64_tr_b16 v[24:25], v6 offset:30720
  ds_read_b64_tr_b16 v[26:27], v6 offset:31200
  s_waitcnt lgkmcnt(10)
  v_mfma_f32_32x32x16_bf16 v[56:71], v[28:31], v[132:135], v[56:71]
  ds_read_b64_tr_b16 v[28:29], v6 offset:30784
  ds_read_b64_tr_b16 v[30:31], v6 offset:31264
  s_waitcnt lgkmcnt(10)
  v_mfma_f32_32x32x16_bf16 v[72:87], v[32:35], v[132:135], v[72:87]
  ds_read_b64_tr_b16 v[32:33], v6 offset:30848
  ds_read_b64_tr_b16 v[34:35], v6 offset:31328
  s_waitcnt lgkmcnt(10)
  v_mfma_f32_32x32x16_bf16 v[88:103], v[36:39], v[132:135], v[88:103]
  ds_read_b64_tr_b16 v[36:37], v6 offset:30912
  ds_read_b64_tr_b16 v[38:39], v6 offset:31392
  s_waitcnt lgkmcnt(6)
  v_mfma_f32_32x32x16_bf16 v[40:55], v[24:27], v[104:107], v[40:55]
  ds_read_b64_tr_b16 v[24:25], v6 offset:38400
  ds_read_b64_tr_b16 v[26:27], v6 offset:38880
  s_waitcnt lgkmcnt(6)
  v_mfma_f32_32x32x16_bf16 v[56:71], v[28:31], v[104:107], v[56:71]
  ds_read_b64_tr_b16 v[28:29], v6 offset:38464
  ds_read_b64_tr_b16 v[30:31], v6 offset:38944
  s_waitcnt lgkmcnt(6)
  v_mfma_f32_32x32x16_bf16 v[72:87], v[32:35], v[104:107], v[72:87]
  ds_read_b64_tr_b16 v[32:33], v6 offset:38528
  ds_read_b64_tr_b16 v[34:35], v6 offset:39008
  s_waitcnt lgkmcnt(6)
  v_mfma_f32_32x32x16_bf16 v[88:103], v[36:39], v[104:107], v[88:103]
  s_mov_b32 s50, 1474560
  s_add_u32 m0, s45, 0
  s_nop 0
  buffer_load_dwordx4 v4, s[24:27], s50 offen lds
  s_add_u32 m0, s45, 1024
  s_mov_b32 exec_hi, 0xffffff
  buffer_load_dwordx4 v5, s[24:27], s50 offen lds
  s_mov_b64 exec, -1
  s_add_u32 s50, s49, 768
  s_add_u32 m0, s47, 92160
  s_nop 0
  buffer_load_dwordx4 v8, s[20:23], s50 offen lds
  s_add_u32 m0, s47, 93184
  s_nop 0
  buffer_load_dwordx4 v9, s[20:23], s50 offen lds
  ds_read_b64_tr_b16 v[36:37], v6 offset:38592
  ds_read_b64_tr_b16 v[38:39], v6 offset:39072
  s_waitcnt lgkmcnt(6)
  v_mfma_f32_32x32x16_bf16 v[40:55], v[24:27], v[108:111], v[40:55]
  ds_read_b64_tr_b16 v[24:25], v7 offset:0
  ds_read_b64_tr_b16 v[26:27], v7 offset:480
  s_waitcnt lgkmcnt(6)
  v_mfma_f32_32x32x16_bf16 v[56:71], v[28:31], v[108:111], v[56:71]
  ds_read_b64_tr_b16 v[28:29], v7 offset:64
  ds_read_b64_tr_b16 v[30:31], v7 offset:544
  s_waitcnt lgkmcnt(6)
  v_mfma_f32_32x32x16_bf16 v[72:87], v[32:35], v[108:111], v[72:87]
  ds_read_b64_tr_b16 v[32:33], v7 offset:128
  ds_read_b64_tr_b16 v[34:35], v7 offset:608
  s_waitcnt lgkmcnt(6)
  v_mfma_f32_32x32x16_bf16 v[88:103], v[36:39], v[108:111], v[88:103]
  ds_read_b64_tr_b16 v[36:37], v7 offset:192
  ds_read_b64_tr_b16 v[38:39], v7 offset:672
  s_waitcnt lgkmcnt(6)
  v_mfma_f32_32x32x16_bf16 v[40:55], v[24:27], v[112:115], v[40:55]
  ds_read_b64_tr_b16 v[24:25], v7 offset:7680
  ds_read_b64_tr_b16 v[26:27], v7 offset:8160
  s_waitcnt lgkmcnt(6)
  v_mfma_f32_32x32x16_bf16 v[56:71], v[28:31], v[112:115], v[56:71]
  ds_read_b64_tr_b16 v[28:29], v7 offset:7744
  ds_read_b64_tr_b16 v[30:31], v7 offset:8224
  s_waitcnt lgkmcnt(6)
  v_mfma_f32_32x32x16_bf16 v[72:87], v[32:35], v[112:115], v[72:87]
  ds_read_b64_tr_b16 v[32:33], v7 offset:7808
  ds_read_b64_tr_b16 v[34:35], v7 offset:8288
  s_waitcnt lgkmcnt(6)
  v_mfma_f32_32x32x16_bf16 v[88:103], v[36:39], v[112:115], v[88:103]
  ds_read_b64_tr_b16 v[36:37], v7 offset:7872
  ds_read_b64_tr_b16 v[38:39], v7 offset:8352
  s_waitcnt lgkmcnt(6)
  v_mfma_f32_32x32x16_bf16 v[40:55], v[24:27], v[116:119], v[40:55]
  s_waitcnt vmcnt(4)
  s_barrier
  ds_read_b128 v[120:123], v10 offset:32768
  ds_read_b128 v[124:127], v11 offset:32768
  ds_read_b128 v[128:131], v12 offset:32768
  ds_read_b128 v[132:135], v13 offset:32768
  s_mov_b32 s50, 1597440
  s_add_u32 m0, s45, 15360
  s_nop 0
  buffer_load_dwordx4 v4, s[24:27], s50 offen lds
  s_add_u32 m0, s45, 16384
  s_mov_b32 exec_hi, 0xffffff
  buffer_load_dwordx4 v5, s[24:27], s50 offen lds
  s_mov_b64 exec, -1
  ds_read_b64_tr_b16 v[24:25], v7 offset:15360
  ds_read_b64_tr_b16 v[26:27], v7 offset:15840
  s_waitcnt lgkmcnt(10)
  v_mfma_f32_32x32x16_bf16 v[56:71], v[28:31], v[116:119], v[56:71]
  ds_read_b64_tr_b16 v[28:29], v7 offset:15424
  ds_read_b64_tr_b16 v[30:31], v7 offset:15904
  s_waitcnt lgkmcnt(10)
  v_mfma_f32_32x32x16_bf16 v[72:87], v[32:35], v[116:119], v[72:87]
  ds_read_b64_tr_b16 v[32:33], v7 offset:15488
  ds_read_b64_tr_b16 v[34:35], v7 offset:15968
  s_waitcnt lgkmcnt(10)
  v_mfma_f32_32x32x16_bf16 v[88:103], v[36:39], v[116:119], v[88:103]
  ds_read_b64_tr_b16 v[36:37], v7 offset:15552
  ds_read_b64_tr_b16 v[38:39], v7 offset:16032
  s_waitcnt lgkmcnt(6)
  v_mfma_f32_32x32x16_bf16 v[40:55], v[24:27], v[120:123], v[40:55]
  ds_read_b64_tr_b16 v[24:25], v7 offset:23040
  ds_read_b64_tr_b16 v[26:27], v7 offset:23520
  s_waitcnt lgkmcnt(6)
  v_mfma_f32_32x32x16_bf16 v[56:71], v[28:31], v[120:123], v[56:71]
  ds_read_b64_tr_b16 v[28:29], v7 offset:23104
  ds_read_b64_tr_b16 v[30:31], v7 offset:23584
  s_waitcnt lgkmcnt(6)
  v_mfma_f32_32x32x16_bf16 v[72:87], v[32:35], v[120:123], v[72:87]
  ds_read_b64_tr_b16 v[32:33], v7 offset:23168
  ds_read_b64_tr_b16 v[34:35], v7 offset:23648
  s_waitcnt lgkmcnt(6)
  v_mfma_f32_32x32x16_bf16 v[88:103], v[36:39], v[120:123], v[88:103]
  s_mov_b32 s50, 1720320
  s_add_u32 m0, s45, 30720
  s_nop 0
  buffer_load_dwordx4 v4, s[24:27], s50 offen lds
  s_add_u32 m0, s45, 31744
  s_mov_b32 exec_hi, 0xffffff
  buffer_load_dwordx4 v5, s[24:27], s50 offen lds
  s_mov_b64 exec, -1
  s_add_u32 s50, s49, 896
  s_add_u32 m0, s47, 108544
  s_nop 0
  buffer_load_dwordx4 v8, s[20:23], s50 offen lds
  s_add_u32 m0, s47, 109568
  s_nop 0
  buffer_load_dwordx4 v9, s[20:23], s50 offen lds
  ds_read_b64_tr_b16 v[36:37], v7 offset:23232
  ds_read_b64_tr_b16 v[38:39], v7 offset:23712
  s_waitcnt lgkmcnt(6)
  v_mfma_f32_32x32x16_bf16 v[40:55], v[24:27], v[124:127], v[40:55]
  ds_read_b64_tr_b16 v[24:25], v7 offset:30720
  ds_read_b64_tr_b16 v[26:27], v7 offset:31200
  s_waitcnt lgkmcnt(6)
  v_mfma_f32_32x32x16_bf16 v[56:71], v[28:31], v[124:127], v[56:71]
  ds_read_b64_tr_b16 v[28:29], v7 offset:30784
  ds_read_b64_tr_b16 v[30:31], v7 offset:31264
  s_waitcnt lgkmcnt(6)
  v_mfma_f32_32x32x16_bf16 v[72:87], v[32:35], v[124:127], v[72:87]
  ds_read_b64_tr_b16 v[32:33], v7 offset:30848
  ds_read_b64_tr_b16 v[34:35], v7 offset:31328
  s_waitcnt lgkmcnt(6)
  v_mfma_f32_32x32x16_bf16 v[88:103], v[36:39], v[124:127], v[88:103]
  ds_read_b64_tr_b16 v[36:37], v7 offset:30912
  ds_read_b64_tr_b16 v[38:39], v7 offset:31392
  s_waitcnt lgkmcnt(6)
  v_mfma_f32_32x32x16_bf16 v[40:55], v[24:27], v[128:131], v[40:55]
  ds_read_b64_tr_b16 v[24:25], v7 offset:38400
  ds_read_b64_tr_b16 v[26:27], v7 offset:38880
  s_waitcnt lgkmcnt(6)
  v_mfma_f32_32x32x16_bf16 v[56:71], v[28:31], v[128:131], v[56:71]
  ds_read_b64_tr_b16 v[28:29], v7 offset:38464
  ds_read_b64_tr_b16 v[30:31], v7 offset:38944
  s_waitcnt lgkmcnt(6)
  v_mfma_f32_32x32x16_bf16 v[72:87], v[32:35], v[128:131], v[72:87]
  ds_read_b64_tr_b16 v[32:33], v7 offset:38528
  ds_read_b64_tr_b16 v[34:35], v7 offset:39008
  s_waitcnt lgkmcnt(6)
  v_mfma_f32_32x32x16_bf16 v[88:103], v[36:39], v[128:131], v[88:103]
  ds_read_b64_tr_b16 v[36:37], v7 offset:38592
  ds_read_b64_tr_b16 v[38:39], v7 offset:39072
  s_waitcnt lgkmcnt(6)
  v_mfma_f32_32x32x16_bf16 v[40:55], v[24:27], v[132:135], v[40:55]
  s_waitcnt vmcnt(4)
  s_barrier
  ds_read_b128 v[104:107], v10 offset:0
  ds_read_b128 v[108:111], v11 offset:0
  ds_read_b128 v[112:115], v12 offset:0
  ds_read_b128 v[116:119], v13 offset:0
  s_mov_b32 s50, 1843200
  s_add_u32 m0, s45, 46080
  s_nop 0
  buffer_load_dwordx4 v4, s[24:27], s50 offen lds
  s_add_u32 m0, s45, 47104
  s_mov_b32 exec_hi, 0xffffff
  buffer_load_dwordx4 v5, s[24:27], s50 offen lds
  s_mov_b64 exec, -1
  ds_read_b64_tr_b16 v[24:25], v6 offset:0
  ds_read_b64_tr_b16 v[26:27], v6 offset:480
  s_waitcnt lgkmcnt(10)
  v_mfma_f32_32x32x16_bf16 v[56:71], v[28:31], v[132:135], v[56:71]
  ds_read_b64_tr_b16 v[28:29], v6 offset:64
  ds_read_b64_tr_b16 v[30:31], v6 offset:544
  s_waitcnt lgkmcnt(10)
  v_mfma_f32_32x32x16_bf16 v[72:87], v[32:35], v[132:135], v[72:87]
  ds_read_b64_tr_b16 v[32:33], v6 offset:128
  ds_read_b64_tr_b16 v[34:35], v6 offset:608
  s_waitcnt lgkmcnt(10)
  v_mfma_f32_32x32x16_bf16 v[88:103], v[36:39], v[132:135], v[88:103]
  ds_read_b64_tr_b16 v[36:37], v6 offset:192
  ds_read_b64_tr_b16 v[38:39], v6 offset:672
  s_waitcnt lgkmcnt(6)
  v_mfma_f32_32x32x16_bf16 v[40:55], v[24:27], v[104:107], v[40:55]
  ds_read_b64_tr_b16 v[24:25], v6 offset:7680
  ds_read_b64_tr_b16 v[26:27], v6 offset:8160
  s_waitcnt lgkmcnt(6)
  v_mfma_f32_32x32x16_bf16 v[56:71], v[28:31], v[104:107], v[56:71]
  ds_read_b64_tr_b16 v[28:29], v6 offset:7744
  ds_read_b64_tr_b16 v[30:31], v6 offset:8224
  s_waitcnt lgkmcnt(6)
  v_mfma_f32_32x32x16_bf16 v[72:87], v[32:35], v[104:107], v[72:87]
  ds_read_b64_tr_b16 v[32:33], v6 offset:7808
  ds_read_b64_tr_b16 v[34:35], v6 offset:8288
  s_waitcnt lgkmcnt(6)
  v_mfma_f32_32x32x16_bf16 v[88:103], v[36:39], v[104:107], v[88:103]
  s_mov_b32 s50, 1966080
  s_add_u32 m0, s45, 61440
  s_nop 0
  buffer_load_dwordx4 v4, s[24:27], s50 offen lds
  s_add_u32 m0, s45, 62464
  s_mov_b32 exec_hi, 0xffffff
  buffer_load_dwordx4 v5, s[24:27], s50 offen lds
  s_mov_b64 exec, -1
  s_add_u32 s50, s49, 1024
  s_add_u32 m0, s47, 124928
  s_nop 0
  buffer_load_dwordx4 v8, s[20:23], s50 offen lds
  s_add_u32 m0, s47, 125952
  s_nop 0
  buffer_load_dwordx4 v9, s[20:23], s50 offen lds
  ds_read_b64_tr_b16 v[36:37], v6 offset:7872
  ds_read_b64_tr_b16 v[38:39], v6 offset:8352
  s_waitcnt lgkmcnt(6)
  v_mfma_f32_32x32x16_bf16 v[40:55], v[24:27], v[108:111], v[40:55]
  ds_read_b64_tr_b16 v[24:25], v6 offset:15360
  ds_read_b64_tr_b16 v[26:27], v6 offset:15840
  s_waitcnt lgkmcnt(6)
  v_mfma_f32_32x32x16_bf16 v[56:71], v[28:31], v[108:111], v[56:71]
  ds_read_b64_tr_b16 v[28:29], v6 offset:15424
  ds_read_b64_tr_b16 v[30:31], v6 offset:15904
  s_waitcnt lgkmcnt(6)
  v_mfma_f32_32x32x16_bf16 v[72:87], v[32:35], v[108:111], v[72:87]
  ds_read_b64_tr_b16 v[32:33], v6 offset:15488
  ds_read_b64_tr_b16 v[34:35], v6 offset:15968
  s_waitcnt lgkmcnt(6)
  v_mfma_f32_32x32x16_bf16 v[88:103], v[36:39], v[108:111], v[88:103]
  ds_read_b64_tr_b16 v[36:37], v6 offset:15552
  ds_read_b64_tr_b16 v[38:39], v6 offset:16032
  s_waitcnt lgkmcnt(6)
  v_mfma_f32_32x32x16_bf16 v[40:55], v[24:27], v[112:115], v[40:55]
  ds_read_b64_tr_b16 v[24:25], v6 offset:23040
  ds_read_b64_tr_b16 v[26:27], v6 offset:23520
  s_waitcnt lgkmcnt(6)
  v_mfma_f32_32x32x16_bf16 v[56:71], v[28:31], v[112:115], v[56:71]
  ds_read_b64_tr_b16 v[28:29], v6 offset:23104
  ds_read_b64_tr_b16 v[30:31], v6 offset:23584
  s_waitcnt lgkmcnt(6)
  v_mfma_f32_32x32x16_bf16 v[72:87], v[32:35], v[112:115], v[72:87]
  ds_read_b64_tr_b16 v[32:33], v6 offset:23168
  ds_read_b64_tr_b16 v[34:35], v6 offset:23648
  s_waitcnt lgkmcnt(6)
  v_mfma_f32_32x32x16_bf16 v[88:103], v[36:39], v[112:115], v[88:103]
  ds_read_b64_tr_b16 v[36:37], v6 offset:23232
  ds_read_b64_tr_b16 v[38:39], v6 offset:23712
  s_waitcnt lgkmcnt(6)
  v_mfma_f32_32x32x16_bf16 v[40:55], v[24:27], v[116:119], v[40:55]
  s_waitcnt vmcnt(4)
  s_barrier
  ds_read_b128 v[120:123], v10 offset:16384
  ds_read_b128 v[124:127], v11 offset:16384
  ds_read_b128 v[128:131], v12 offset:16384
  ds_read_b128 v[132:135], v13 offset:16384
  s_mov_b32 s50, 2088960
  s_add_u32 m0, s45, 76800
  s_nop 0
  buffer_load_dwordx4 v4, s[24:27], s50 offen lds
  s_add_u32 m0, s45, 77824
  s_mov_b32 exec_hi, 0xffffff
  buffer_load_dwordx4 v5, s[24:27], s50 offen lds
  s_mov_b64 exec, -1
  ds_read_b64_tr_b16 v[24:25], v6 offset:30720
  ds_read_b64_tr_b16 v[26:27], v6 offset:31200
  s_waitcnt lgkmcnt(10)
  v_mfma_f32_32x32x16_bf16 v[56:71], v[28:31], v[116:119], v[56:71]
  ds_read_b64_tr_b16 v[28:29], v6 offset:30784
  ds_read_b64_tr_b16 v[30:31], v6 offset:31264
  s_waitcnt lgkmcnt(10)
  v_mfma_f32_32x32x16_bf16 v[72:87], v[32:35], v[116:119], v[72:87]
  ds_read_b64_tr_b16 v[32:33], v6 offset:30848
  ds_read_b64_tr_b16 v[34:35], v6 offset:31328
  s_waitcnt lgkmcnt(10)
  v_mfma_f32_32x32x16_bf16 v[88:103], v[36:39], v[116:119], v[88:103]
  ds_read_b64_tr_b16 v[36:37], v6 offset:30912
  ds_read_b64_tr_b16 v[38:39], v6 offset:31392
  s_waitcnt lgkmcnt(6)
  v_mfma_f32_32x32x16_bf16 v[40:55], v[24:27], v[120:123], v[40:55]
  ds_read_b64_tr_b16 v[24:25], v6 offset:38400
  ds_read_b64_tr_b16 v[26:27], v6 offset:38880
  s_waitcnt lgkmcnt(6)
  v_mfma_f32_32x32x16_bf16 v[56:71], v[28:31], v[120:123], v[56:71]
  ds_read_b64_tr_b16 v[28:29], v6 offset:38464
  ds_read_b64_tr_b16 v[30:31], v6 offset:38944
  s_waitcnt lgkmcnt(6)
  v_mfma_f32_32x32x16_bf16 v[72:87], v[32:35], v[120:123], v[72:87]
  ds_read_b64_tr_b16 v[32:33], v6 offset:38528
  ds_read_b64_tr_b16 v[34:35], v6 offset:39008
  s_waitcnt lgkmcnt(6)
  v_mfma_f32_32x32x16_bf16 v[88:103], v[36:39], v[120:123], v[88:103]
  s_mov_b32 s50, 2211840
  s_add_u32 m0, s45, 0
  s_nop 0
  buffer_load_dwordx4 v4, s[24:27], s50 offen lds
  s_add_u32 m0, s45, 1024
  s_mov_b32 exec_hi, 0xffffff
  buffer_load_dwordx4 v5, s[24:27], s50 offen lds
  s_mov_b64 exec, -1
  s_add_u32 s50, s49, 1152
  s_add_u32 m0, s47, 92160
  s_nop 0
  buffer_load_dwordx4 v8, s[20:23], s50 offen lds
  s_add_u32 m0, s47, 93184
  s_nop 0
  buffer_load_dwordx4 v9, s[20:23], s50 offen lds
  ds_read_b64_tr_b16 v[36:37], v6 offset:38592
  ds_read_b64_tr_b16 v[38:39], v6 offset:39072
  s_waitcnt lgkmcnt(6)
  v_mfma_f32_32x32x16_bf16 v[40:55], v[24:27], v[124:127], v[40:55]
  ds_read_b64_tr_b16 v[24:25], v7 offset:0
  ds_read_b64_tr_b16 v[26:27], v7 offset:480
  s_waitcnt lgkmcnt(6)
  v_mfma_f32_32x32x16_bf16 v[56:71], v[28:31], v[124:127], v[56:71]
  ds_read_b64_tr_b16 v[28:29], v7 offset:64
  ds_read_b64_tr_b16 v[30:31], v7 offset:544
  s_waitcnt lgkmcnt(6)
  v_mfma_f32_32x32x16_bf16 v[72:87], v[32:35], v[124:127], v[72:87]
  ds_read_b64_tr_b16 v[32:33], v7 offset:128
  ds_read_b64_tr_b16 v[34:35], v7 offset:608
  s_waitcnt lgkmcnt(6)
  v_mfma_f32_32x32x16_bf16 v[88:103], v[36:39], v[124:127], v[88:103]
  ds_read_b64_tr_b16 v[36:37], v7 offset:192
  ds_read_b64_tr_b16 v[38:39], v7 offset:672
  s_waitcnt lgkmcnt(6)
  v_mfma_f32_32x32x16_bf16 v[40:55], v[24:27], v[128:131], v[40:55]
  ds_read_b64_tr_b16 v[24:25], v7 offset:7680
  ds_read_b64_tr_b16 v[26:27], v7 offset:8160
  s_waitcnt lgkmcnt(6)
  v_mfma_f32_32x32x16_bf16 v[56:71], v[28:31], v[128:131], v[56:71]
  ds_read_b64_tr_b16 v[28:29], v7 offset:7744
  ds_read_b64_tr_b16 v[30:31], v7 offset:8224
  s_waitcnt lgkmcnt(6)
  v_mfma_f32_32x32x16_bf16 v[72:87], v[32:35], v[128:131], v[72:87]
  ds_read_b64_tr_b16 v[32:33], v7 offset:7808
  ds_read_b64_tr_b16 v[34:35], v7 offset:8288
  s_waitcnt lgkmcnt(6)
  v_mfma_f32_32x32x16_bf16 v[88:103], v[36:39], v[128:131], v[88:103]
  ds_read_b64_tr_b16 v[36:37], v7 offset:7872
  ds_read_b64_tr_b16 v[38:39], v7 offset:8352
  s_waitcnt lgkmcnt(6)
  v_mfma_f32_32x32x16_bf16 v[40:55], v[24:27], v[132:135], v[40:55]
  s_waitcnt vmcnt(4)
  s_barrier
  ds_read_b128 v[104:107], v10 offset:32768
  ds_read_b128 v[108:111], v11 offset:32768
  ds_read_b128 v[112:115], v12 offset:32768
  ds_read_b128 v[116:119], v13 offset:32768
  s_mov_b32 s50, 2334720
  s_add_u32 m0, s45, 15360
  s_nop 0
  buffer_load_dwordx4 v4, s[24:27], s50 offen lds
  s_add_u32 m0, s45, 16384
  s_mov_b32 exec_hi, 0xffffff
  buffer_load_dwordx4 v5, s[24:27], s50 offen lds
  s_mov_b64 exec, -1
  ds_read_b64_tr_b16 v[24:25], v7 offset:15360
  ds_read_b64_tr_b16 v[26:27], v7 offset:15840
  s_waitcnt lgkmcnt(10)
  v_mfma_f32_32x32x16_bf16 v[56:71], v[28:31], v[132:135], v[56:71]
  ds_read_b64_tr_b16 v[28:29], v7 offset:15424
  ds_read_b64_tr_b16 v[30:31], v7 offset:15904
  s_waitcnt lgkmcnt(10)
  v_mfma_f32_32x32x16_bf16 v[72:87], v[32:35], v[132:135], v[72:87]
  ds_read_b64_tr_b16 v[32:33], v7 offset:15488
  ds_read_b64_tr_b16 v[34:35], v7 offset:15968
  s_waitcnt lgkmcnt(10)
  v_mfma_f32_32x32x16_bf16 v[88:103], v[36:39], v[132:135], v[88:103]
  ds_read_b64_tr_b16 v[36:37], v7 offset:15552
  ds_read_b64_tr_b16 v[38:39], v7 offset:16032
  s_waitcnt lgkmcnt(6)
  v_mfma_f32_32x32x16_bf16 v[40:55], v[24:27], v[104:107], v[40:55]
  ds_read_b64_tr_b16 v[24:25], v7 offset:23040
  ds_read_b64_tr_b16 v[26:27], v7 offset:23520
  s_waitcnt lgkmcnt(6)
  v_mfma_f32_32x32x16_bf16 v[56:71], v[28:31], v[104:107], v[56:71]
  ds_read_b64_tr_b16 v[28:29], v7 offset:23104
  ds_read_b64_tr_b16 v[30:31], v7 offset:23584
  s_waitcnt lgkmcnt(6)
  v_mfma_f32_32x32x16_bf16 v[72:87], v[32:35], v[104:107], v[72:87]
  ds_read_b64_tr_b16 v[32:33], v7 offset:23168
  ds_read_b64_tr_b16 v[34:35], v7 offset:23648
  s_waitcnt lgkmcnt(6)
  v_mfma_f32_32x32x16_bf16 v[88:103], v[36:39], v[104:107], v[88:103]
  ds_read_b64_tr_b16 v[36:37], v7 offset:23232
  ds_read_b64_tr_b16 v[38:39], v7 offset:23712
  s_waitcnt lgkmcnt(6)
  v_mfma_f32_32x32x16_bf16 v[40:55], v[24:27], v[108:111], v[40:55]
  ds_read_b64_tr_b16 v[24:25], v7 offset:30720
  ds_read_b64_tr_b16 v[26:27], v7 offset:31200
  s_waitcnt lgkmcnt(6)
  v_mfma_f32_32x32x16_bf16 v[56:71], v[28:31], v[108:111], v[56:71]
  ds_read_b64_tr_b16 v[28:29], v7 offset:30784
  ds_read_b64_tr_b16 v[30:31], v7 offset:31264
  s_waitcnt lgkmcnt(6)
  v_mfma_f32_32x32x16_bf16 v[72:87], v[32:35], v[108:111], v[72:87]
  ds_read_b64_tr_b16 v[32:33], v7 offset:30848
  ds_read_b64_tr_b16 v[34:35], v7 offset:31328
  s_waitcnt lgkmcnt(6)
  v_mfma_f32_32x32x16_bf16 v[88:103], v[36:39], v[108:111], v[88:103]
  ds_read_b64_tr_b16 v[36:37], v7 offset:30912
  ds_read_b64_tr_b16 v[38:39], v7 offset:31392
  s_waitcnt lgkmcnt(6)
  v_mfma_f32_32x32x16_bf16 v[40:55], v[24:27], v[112:115], v[40:55]
  ds_read_b64_tr_b16 v[24:25], v7 offset:38400
  ds_read_b64_tr_b16 v[26:27], v7 offset:38880
  s_waitcnt lgkmcnt(6)
  v_mfma_f32_32x32x16_bf16 v[56:71], v[28:31], v[112:115], v[56:71]
  ds_read_b64_tr_b16 v[28:29], v7 offset:38464
  ds_read_b64_tr_b16 v[30:31], v7 offset:38944
  s_waitcnt lgkmcnt(6)
  v_mfma_f32_32x32x16_bf16 v[72:87], v[32:35], v[112:115], v[72:87]
  ds_read_b64_tr_b16 v[32:33], v7 offset:38528
  ds_read_b64_tr_b16 v[34:35], v7 offset:39008
  s_waitcnt lgkmcnt(6)
  v_mfma_f32_32x32x16_bf16 v[88:103], v[36:39], v[112:115], v[88:103]
  ds_read_b64_tr_b16 v[36:37], v7 offset:38592
  ds_read_b64_tr_b16 v[38:39], v7 offset:39072
  s_waitcnt lgkmcnt(6)
  v_mfma_f32_32x32x16_bf16 v[40:55], v[24:27], v[116:119], v[40:55]
  s_waitcnt vmcnt(0)
  s_barrier
  ds_read_b128 v[120:123], v10 offset:0
  ds_read_b128 v[124:127], v11 offset:0
  ds_read_b128 v[128:131], v12 offset:0
  ds_read_b128 v[132:135], v13 offset:0
  ds_read_b64_tr_b16 v[24:25], v6 offset:0
  ds_read_b64_tr_b16 v[26:27], v6 offset:480
  s_waitcnt lgkmcnt(10)
  v_mfma_f32_32x32x16_bf16 v[56:71], v[28:31], v[116:119], v[56:71]
  ds_read_b64_tr_b16 v[28:29], v6 offset:64
  ds_read_b64_tr_b16 v[30:31], v6 offset:544
  s_waitcnt lgkmcnt(10)
  v_mfma_f32_32x32x16_bf16 v[72:87], v[32:35], v[116:119], v[72:87]
  ds_read_b64_tr_b16 v[32:33], v6 offset:128
  ds_read_b64_tr_b16 v[34:35], v6 offset:608
  s_waitcnt lgkmcnt(10)
  v_mfma_f32_32x32x16_bf16 v[88:103], v[36:39], v[116:119], v[88:103]
  s_lshl_b32 s46, s40, 10
  s_lshl_b32 s54, s43, 8
  s_add_u32 s46, s46, s54
  s_add_u32 s46, s46, 12644352
  v_lshlrev_b32 v22, 3, v16
  buffer_load_dwordx2 v[14:15], v22, s[28:31], s46 offen sc1
  ds_read_b64_tr_b16 v[36:37], v6 offset:192
  ds_read_b64_tr_b16 v[38:39], v6 offset:672
  s_waitcnt lgkmcnt(6)
  v_mfma_f32_32x32x16_bf16 v[40:55], v[24:27], v[120:123], v[40:55]
  ds_read_b64_tr_b16 v[24:25], v6 offset:7680
  ds_read_b64_tr_b16 v[26:27], v6 offset:8160
  s_waitcnt lgkmcnt(6)
  v_mfma_f32_32x32x16_bf16 v[56:71], v[28:31], v[120:123], v[56:71]
  ds_read_b64_tr_b16 v[28:29], v6 offset:7744
  ds_read_b64_tr_b16 v[30:31], v6 offset:8224
  s_waitcnt lgkmcnt(6)
  v_mfma_f32_32x32x16_bf16 v[72:87], v[32:35], v[120:123], v[72:87]
  ds_read_b64_tr_b16 v[32:33], v6 offset:7808
  ds_read_b64_tr_b16 v[34:35], v6 offset:8288
  s_waitcnt lgkmcnt(6)
  v_mfma_f32_32x32x16_bf16 v[88:103], v[36:39], v[120:123], v[88:103]
  ds_read_b64_tr_b16 v[36:37], v6 offset:7872
  ds_read_b64_tr_b16 v[38:39], v6 offset:8352
  s_waitcnt lgkmcnt(6)
  v_mfma_f32_32x32x16_bf16 v[40:55], v[24:27], v[124:127], v[40:55]
  ds_read_b64_tr_b16 v[24:25], v6 offset:15360
  ds_read_b64_tr_b16 v[26:27], v6 offset:15840
  s_waitcnt lgkmcnt(6)
  v_mfma_f32_32x32x16_bf16 v[56:71], v[28:31], v[124:127], v[56:71]
  ds_read_b64_tr_b16 v[28:29], v6 offset:15424
  ds_read_b64_tr_b16 v[30:31], v6 offset:15904
  s_waitcnt lgkmcnt(6)
  v_mfma_f32_32x32x16_bf16 v[72:87], v[32:35], v[124:127], v[72:87]
  ds_read_b64_tr_b16 v[32:33], v6 offset:15488
  ds_read_b64_tr_b16 v[34:35], v6 offset:15968
  s_waitcnt lgkmcnt(6)
  v_mfma_f32_32x32x16_bf16 v[88:103], v[36:39], v[124:127], v[88:103]
  ds_read_b64_tr_b16 v[36:37], v6 offset:15552
  ds_read_b64_tr_b16 v[38:39], v6 offset:16032
  s_waitcnt lgkmcnt(6)
  v_mfma_f32_32x32x16_bf16 v[40:55], v[24:27], v[128:131], v[40:55]
  ds_read_b64_tr_b16 v[24:25], v6 offset:23040
  ds_read_b64_tr_b16 v[26:27], v6 offset:23520
  s_waitcnt lgkmcnt(6)
  v_mfma_f32_32x32x16_bf16 v[56:71], v[28:31], v[128:131], v[56:71]
  ds_read_b64_tr_b16 v[28:29], v6 offset:23104
  ds_read_b64_tr_b16 v[30:31], v6 offset:23584
  s_waitcnt lgkmcnt(6)
  v_mfma_f32_32x32x16_bf16 v[72:87], v[32:35], v[128:131], v[72:87]
  ds_read_b64_tr_b16 v[32:33], v6 offset:23168
  ds_read_b64_tr_b16 v[34:35], v6 offset:23648
  s_waitcnt lgkmcnt(6)
  v_mfma_f32_32x32x16_bf16 v[88:103], v[36:39], v[128:131], v[88:103]
  ds_read_b64_tr_b16 v[36:37], v6 offset:23232
  ds_read_b64_tr_b16 v[38:39], v6 offset:23712
  s_waitcnt lgkmcnt(6)
  v_mfma_f32_32x32x16_bf16 v[40:55], v[24:27], v[132:135], v[40:55]
  s_waitcnt lgkmcnt(4)
  v_mfma_f32_32x32x16_bf16 v[56:71], v[28:31], v[132:135], v[56:71]
  s_waitcnt lgkmcnt(2)
  v_mfma_f32_32x32x16_bf16 v[72:87], v[32:35], v[132:135], v[72:87]
  s_waitcnt lgkmcnt(0)
  v_mfma_f32_32x32x16_bf16 v[88:103], v[36:39], v[132:135], v[88:103]
  s_waitcnt vmcnt(0)
  v_bfe_u32 v247, v1, 2, 2
  v_lshl_add_u32 v247, v17, 2, v247
  v_mul_u32_u24 v247, 192, v247
  v_and_b32 v228, 1, v3
  v_lshl_add_u32 v247, v228, 5, v247
  v_and_b32 v228, 3, v1
  v_lshl_add_u32 v247, v228, 3, v247
  v_add_u32 v247, 141312, v247
  ds_read_b64_tr_b16 v[168:169], v247 offset:0
  ds_read_b64_tr_b16 v[170:171], v247 offset:1536
  ds_read_b64_tr_b16 v[172:173], v247 offset:3072
  ds_read_b64_tr_b16 v[174:175], v247 offset:4608
  ds_read_b64_tr_b16 v[176:177], v247 offset:6144
  ds_read_b64_tr_b16 v[178:179], v247 offset:7680
  ds_read_b64_tr_b16 v[180:181], v247 offset:9216
  ds_read_b64_tr_b16 v[182:183], v247 offset:10752
  ds_read_b64_tr_b16 v[184:185], v247 offset:12288
  ds_read_b64_tr_b16 v[186:187], v247 offset:13824
  ds_read_b64_tr_b16 v[188:189], v247 offset:64
  ds_read_b64_tr_b16 v[190:191], v247 offset:1600
  ds_read_b64_tr_b16 v[192:193], v247 offset:3136
  ds_read_b64_tr_b16 v[194:195], v247 offset:4672
  ds_read_b64_tr_b16 v[196:197], v247 offset:6208
  ds_read_b64_tr_b16 v[198:199], v247 offset:7744
  ds_read_b64_tr_b16 v[200:201], v247 offset:9280
  ds_read_b64_tr_b16 v[202:203], v247 offset:10816
  ds_read_b64_tr_b16 v[204:205], v247 offset:12352
  ds_read_b64_tr_b16 v[206:207], v247 offset:13888
  ds_read_b64_tr_b16 v[208:209], v247 offset:128
  ds_read_b64_tr_b16 v[210:211], v247 offset:1664
  ds_read_b64_tr_b16 v[212:213], v247 offset:3200
  ds_read_b64_tr_b16 v[214:215], v247 offset:4736
  ds_read_b64_tr_b16 v[216:217], v247 offset:6272
  ds_read_b64_tr_b16 v[218:219], v247 offset:7808
  ds_read_b64_tr_b16 v[220:221], v247 offset:9344
  ds_read_b64_tr_b16 v[222:223], v247 offset:10880
  ds_read_b64_tr_b16 v[224:225], v247 offset:12416
  ds_read_b64_tr_b16 v[226:227], v247 offset:13952
  v_mul_f32 v246, s48, v15
  s_barrier
  v_lshlrev_b32 v229, 4, v17
  v_add_u32 v229, 157184, v229
  ds_read_b128 v[104:107], v229 offset:0
  ds_read_b128 v[108:111], v229 offset:32
  ds_read_b128 v[112:115], v229 offset:64
  ds_read_b128 v[116:119], v229 offset:96
  ds_read_b128 v[120:123], v229 offset:128
  ds_read_b128 v[124:127], v229 offset:160
  ds_read_b128 v[128:131], v229 offset:192
  ds_read_b128 v[132:135], v229 offset:224
  ds_read_b128 v[136:139], v229 offset:256
  ds_read_b128 v[140:143], v229 offset:288
  ds_read_b128 v[144:147], v229 offset:320
  ds_read_b128 v[148:151], v229 offset:352
  ds_read_b128 v[152:155], v229 offset:384
  ds_read_b128 v[156:159], v229 offset:416
  ds_read_b128 v[160:163], v229 offset:448
  ds_read_b128 v[164:167], v229 offset:480
  s_mul_i32 s46, s43, 5120
  s_add_u32 s46, s46, 45056
  v_mul_u32_u24 v228, 160, v16
  v_lshl_add_u32 v228, v17, 3, v228
  v_add_u32 v228, s46, v228
  s_waitcnt lgkmcnt(12)
  v_fma_f32 v40, v104, v14, v40
  v_fma_f32 v41, v105, v14, v41
  v_fma_f32 v42, v106, v14, v42
  v_fma_f32 v43, v107, v14, v43
  v_mul_f32 v40, v40, v15
  v_mul_f32 v41, v41, v15
  v_mul_f32 v42, v42, v15
  v_mul_f32 v43, v43, v15
  v_cvt_pk_bf16_f32 v40, v40, v41
  v_cvt_pk_bf16_f32 v41, v42, v43
  ds_write_b64 v228, v[40:41] offset:96
  v_fma_f32 v44, v108, v14, v44
  v_fma_f32 v45, v109, v14, v45
  v_fma_f32 v46, v110, v14, v46
  v_fma_f32 v47, v111, v14, v47
  v_mul_f32 v44, v44, v15
  v_mul_f32 v45, v45, v15
  v_mul_f32 v46, v46, v15
  v_mul_f32 v47, v47, v15
  v_cvt_pk_bf16_f32 v44, v44, v45
  v_cvt_pk_bf16_f32 v45, v46, v47
  ds_write_b64 v228, v[44:45] offset:112
  v_fma_f32 v48, v112, v14, v48
  v_fma_f32 v49, v113, v14, v49
  v_fma_f32 v50, v114, v14, v50
  v_fma_f32 v51, v115, v14, v51
  v_mul_f32 v48, v48, v15
  v_mul_f32 v49, v49, v15
  v_mul_f32 v50, v50, v15
  v_mul_f32 v51, v51, v15
  v_cvt_pk_bf16_f32 v48, v48, v49
  v_cvt_pk_bf16_f32 v49, v50, v51
  ds_write_b64 v228, v[48:49] offset:128
  v_fma_f32 v52, v116, v14, v52
  v_fma_f32 v53, v117, v14, v53
  v_fma_f32 v54, v118, v14, v54
  v_fma_f32 v55, v119, v14, v55
  v_mul_f32 v52, v52, v15
  v_mul_f32 v53, v53, v15
  v_mul_f32 v54, v54, v15
  v_mul_f32 v55, v55, v15
  v_cvt_pk_bf16_f32 v52, v52, v53
  v_cvt_pk_bf16_f32 v53, v54, v55
  ds_write_b64 v228, v[52:53] offset:144
  s_waitcnt lgkmcnt(12)
  v_fma_f32 v56, v120, v14, v56
  v_fma_f32 v57, v121, v14, v57
  v_fma_f32 v58, v122, v14, v58
  v_fma_f32 v59, v123, v14, v59
  v_fma_f32 v60, v124, v14, v60
  v_fma_f32 v61, v125, v14, v61
  v_fma_f32 v62, v126, v14, v62
  v_fma_f32 v63, v127, v14, v63
  v_cvt_pk_bf16_f32 v24, v56, v57
  v_cvt_pk_bf16_f32 v25, v58, v59
  v_cvt_pk_bf16_f32 v26, v60, v61
  v_cvt_pk_bf16_f32 v27, v62, v63
  v_fma_f32 v64, v128, v14, v64
  v_fma_f32 v65, v129, v14, v65
  v_fma_f32 v66, v130, v14, v66
  v_fma_f32 v67, v131, v14, v67
  v_fma_f32 v68, v132, v14, v68
  v_fma_f32 v69, v133, v14, v69
  v_fma_f32 v70, v134, v14, v70
  v_fma_f32 v71, v135, v14, v71
  v_cvt_pk_bf16_f32 v28, v64, v65
  v_cvt_pk_bf16_f32 v29, v66, v67
  v_cvt_pk_bf16_f32 v30, v68, v69
  v_cvt_pk_bf16_f32 v31, v70, v71
  s_waitcnt lgkmcnt(8)
  v_fma_f32 v72, v136, v14, v72
  v_fma_f32 v73, v137, v14, v73
  v_fma_f32 v74, v138, v14, v74
  v_fma_f32 v75, v139, v14, v75
  v_fma_f32 v76, v140, v14, v76
  v_fma_f32 v77, v141, v14, v77
  v_fma_f32 v78, v142, v14, v78
  v_fma_f32 v79, v143, v14, v79
  v_cvt_pk_bf16_f32 v32, v72, v73
  v_cvt_pk_bf16_f32 v33, v74, v75
  v_cvt_pk_bf16_f32 v34, v76, v77
  v_cvt_pk_bf16_f32 v35, v78, v79
  v_fma_f32 v80, v144, v14, v80
  v_fma_f32 v81, v145, v14, v81
  v_fma_f32 v82, v146, v14, v82
  v_fma_f32 v83, v147, v14, v83
  v_fma_f32 v84, v148, v14, v84
  v_fma_f32 v85, v149, v14, v85
  v_fma_f32 v86, v150, v14, v86
  v_fma_f32 v87, v151, v14, v87
  v_cvt_pk_bf16_f32 v36, v80, v81
  v_cvt_pk_bf16_f32 v37, v82, v83
  v_cvt_pk_bf16_f32 v38, v84, v85
  v_cvt_pk_bf16_f32 v39, v86, v87
  s_waitcnt lgkmcnt(4)
  v_fma_f32 v88, v152, v14, v88
  v_fma_f32 v89, v153, v14, v89
  v_fma_f32 v90, v154, v14, v90
  v_fma_f32 v91, v155, v14, v91
  v_fma_f32 v92, v156, v14, v92
  v_fma_f32 v93, v157, v14, v93
  v_fma_f32 v94, v158, v14, v94
  v_fma_f32 v95, v159, v14, v95
  v_cvt_pk_bf16_f32 v248, v88, v89
  v_cvt_pk_bf16_f32 v249, v90, v91
  v_cvt_pk_bf16_f32 v250, v92, v93
  v_cvt_pk_bf16_f32 v251, v94, v95
  v_mfma_f32_32x32x16_bf16 v[104:119], v[168:171], v[24:27], 0
  v_mfma_f32_32x32x16_bf16 v[120:135], v[188:191], v[24:27], 0
  v_mfma_f32_32x32x16_bf16 v[136:151], v[208:211], v[24:27], 0
  v_mfma_f32_32x32x16_bf16 v[104:119], v[172:175], v[28:31], v[104:119]
  v_mfma_f32_32x32x16_bf16 v[120:135], v[192:195], v[28:31], v[120:135]
  v_mfma_f32_32x32x16_bf16 v[136:151], v[212:215], v[28:31], v[136:151]
  v_mfma_f32_32x32x16_bf16 v[104:119], v[176:179], v[32:35], v[104:119]
  v_mfma_f32_32x32x16_bf16 v[120:135], v[196:199], v[32:35], v[120:135]
  v_mfma_f32_32x32x16_bf16 v[136:151], v[216:219], v[32:35], v[136:151]
  v_mfma_f32_32x32x16_bf16 v[104:119], v[180:183], v[36:39], v[104:119]
  v_mfma_f32_32x32x16_bf16 v[120:135], v[200:203], v[36:39], v[120:135]
  v_mfma_f32_32x32x16_bf16 v[136:151], v[220:223], v[36:39], v[136:151]
  v_mfma_f32_32x32x16_bf16 v[104:119], v[184:187], v[248:251], v[104:119]
  v_mfma_f32_32x32x16_bf16 v[120:135], v[204:207], v[248:251], v[120:135]
  v_mfma_f32_32x32x16_bf16 v[136:151], v[224:227], v[248:251], v[136:151]
  s_waitcnt lgkmcnt(0)
  v_mov_b32 v234, 157696
  v_mov_b32 v235, 1
  s_mov_b64 exec, 1
  ds_add_u32 v234, v235
  s_mov_b64 exec, -1
  s_lshl_b32 s46, s40, 3
  s_lshl_b32 s54, s43, 1
  s_add_u32 s46, s46, s54
  s_lshl_b32 s46, s46, 3
  s_add_u32 s46, s46, s41
  s_mul_i32 s46, s46, 5120
  s_add_u32 s46, s46, 7077888
  s_add_u32 s54, s46, 4096
  v_and_b32 v230, 1, v3
  v_mul_u32_u24 v230, 40960, v230
  v_lshl_add_u32 v230, v2, 4, v230
  v_lshl_add_u32 v231, v17, 9, v230
  v_lshl_add_u32 v230, v17, 11, v230
  v_max3_f32 v238, v104, v105, v106
  v_min3_f32 v239, v104, v105, v106
  v_max3_f32 v238, v238, v107, v108
  v_min3_f32 v239, v239, v107, v108
  v_max3_f32 v238, v238, v109, v110
  v_min3_f32 v239, v239, v109, v110
  v_max3_f32 v238, v238, v111, v112
  v_min3_f32 v239, v239, v111, v112
  v_max3_f32 v238, v238, v113, v114
  v_min3_f32 v239, v239, v113, v114
  v_max3_f32 v238, v238, v115, v116
  v_min3_f32 v239, v239, v115, v116
  v_max3_f32 v238, v238, v117, v118
  v_min3_f32 v239, v239, v117, v118
  v_max3_f32 v238, v238, v119, v120
  v_min3_f32 v239, v239, v119, v120
  v_max3_f32 v238, v238, v121, v122
  v_min3_f32 v239, v239, v121, v122
  v_max_f32 v238, v238, v123
  v_min_f32 v239, v239, v123
  v_mul_f32 v238, v238, v246
  v_mul_f32 v239, v239, v246
  v_fma_f32 v40, v104, v246, -v238
  v_fma_f32 v41, v105, v246, -v238
  v_fma_f32 v60, -v104, v246, v239
  v_fma_f32 v61, -v105, v246, v239
  v_fma_f32 v42, v106, v246, -v238
  v_fma_f32 v43, v107, v246, -v238
  v_fma_f32 v62, -v106, v246, v239
  v_fma_f32 v63, -v107, v246, v239
  v_fma_f32 v44, v108, v246, -v238
  v_fma_f32 v45, v109, v246, -v238
  v_fma_f32 v64, -v108, v246, v239
  v_fma_f32 v65, -v109, v246, v239
  v_fma_f32 v46, v110, v246, -v238
  v_fma_f32 v47, v111, v246, -v238
  v_fma_f32 v66, -v110, v246, v239
  v_fma_f32 v67, -v111, v246, v239
  v_fma_f32 v48, v112, v246, -v238
  v_fma_f32 v49, v113, v246, -v238
  v_fma_f32 v68, -v112, v246, v239
  v_fma_f32 v69, -v113, v246, v239
  v_fma_f32 v50, v114, v246, -v238
  v_fma_f32 v51, v115, v246, -v238
  v_fma_f32 v70, -v114, v246, v239
  v_fma_f32 v71, -v115, v246, v239
  v_fma_f32 v52, v116, v246, -v238
  v_fma_f32 v53, v117, v246, -v238
  v_fma_f32 v72, -v116, v246, v239
  v_fma_f32 v73, -v117, v246, v239
  v_fma_f32 v54, v118, v246, -v238
  v_fma_f32 v55, v119, v246, -v238
  v_fma_f32 v74, -v118, v246, v239
  v_fma_f32 v75, -v119, v246, v239
  v_fma_f32 v56, v120, v246, -v238
  v_fma_f32 v57, v121, v246, -v238
  v_fma_f32 v76, -v120, v246, v239
  v_fma_f32 v77, -v121, v246, v239
  v_fma_f32 v58, v122, v246, -v238
  v_fma_f32 v59, v123, v246, -v238
  v_fma_f32 v78, -v122, v246, v239
  v_fma_f32 v79, -v123, v246, v239
  v_exp_f32 v40, v40
  v_exp_f32 v60, v60
  v_exp_f32 v41, v41
  v_exp_f32 v61, v61
  v_exp_f32 v42, v42
  v_exp_f32 v62, v62
  v_exp_f32 v43, v43
  v_exp_f32 v63, v63
  v_exp_f32 v44, v44
  v_exp_f32 v64, v64
  v_exp_f32 v45, v45
  v_exp_f32 v65, v65
  v_exp_f32 v46, v46
  v_exp_f32 v66, v66
  v_exp_f32 v47, v47
  v_exp_f32 v67, v67
  v_exp_f32 v48, v48
  v_exp_f32 v68, v68
  v_exp_f32 v49, v49
  v_exp_f32 v69, v69
  v_exp_f32 v50, v50
  v_exp_f32 v70, v70
  v_exp_f32 v51, v51
  v_exp_f32 v71, v71
  v_exp_f32 v52, v52
  v_exp_f32 v72, v72
  v_exp_f32 v53, v53
  v_exp_f32 v73, v73
  v_exp_f32 v54, v54
  v_exp_f32 v74, v74
  v_exp_f32 v55, v55
  v_exp_f32 v75, v75
  v_exp_f32 v56, v56
  v_exp_f32 v76, v76
  v_exp_f32 v57, v57
  v_exp_f32 v77, v77
  v_exp_f32 v58, v58
  v_exp_f32 v78, v78
  v_exp_f32 v59, v59
  v_exp_f32 v79, v79
  v_add_f32 v240, v40, v42
  v_add_f32 v241, v41, v43
  v_add_f32 v242, v60, v62
  v_add_f32 v243, v61, v63
  v_add_f32 v240, v240, v44
  v_add_f32 v241, v241, v45
  v_add_f32 v242, v242, v64
  v_add_f32 v243, v243, v65
  v_add_f32 v240, v240, v46
  v_add_f32 v241, v241, v47
  v_add_f32 v242, v242, v66
  v_add_f32 v243, v243, v67
  v_add_f32 v240, v240, v48
  v_add_f32 v241, v241, v49
  v_add_f32 v242, v242, v68
  v_add_f32 v243, v243, v69
  v_add_f32 v240, v240, v50
  v_add_f32 v241, v241, v51
  v_add_f32 v242, v242, v70
  v_add_f32 v243, v243, v71
  v_add_f32 v240, v240, v52
  v_add_f32 v241, v241, v53
  v_add_f32 v242, v242, v72
  v_add_f32 v243, v243, v73
  v_add_f32 v240, v240, v54
  v_add_f32 v241, v241, v55
  v_add_f32 v242, v242, v74
  v_add_f32 v243, v243, v75
  v_add_f32 v240, v240, v56
  v_add_f32 v241, v241, v57
  v_add_f32 v242, v242, v76
  v_add_f32 v243, v243, v77
  v_add_f32 v240, v240, v58
  v_add_f32 v241, v241, v59
  v_add_f32 v242, v242, v78
  v_add_f32 v243, v243, v79
  v_add_f32 v244, v240, v241
  v_add_f32 v245, v242, v243
  v_rcp_f32 v244, v244
  v_rcp_f32 v245, v245
  v_mul_f32 v40, v40, v244
  v_mul_f32 v41, v41, v244
  v_mul_f32 v60, v60, v245
  v_mul_f32 v61, v61, v245
  v_mul_f32 v42, v42, v244
  v_mul_f32 v43, v43, v244
  v_mul_f32 v62, v62, v245
  v_mul_f32 v63, v63, v245
  v_mul_f32 v44, v44, v244
  v_mul_f32 v45, v45, v244
  v_mul_f32 v64, v64, v245
  v_mul_f32 v65, v65, v245
  v_mul_f32 v46, v46, v244
  v_mul_f32 v47, v47, v244
  v_mul_f32 v66, v66, v245
  v_mul_f32 v67, v67, v245
  v_mul_f32 v48, v48, v244
  v_mul_f32 v49, v49, v244
  v_mul_f32 v68, v68, v245
  v_mul_f32 v69, v69, v245
  v_mul_f32 v50, v50, v244
  v_mul_f32 v51, v51, v244
  v_mul_f32 v70, v70, v245
  v_mul_f32 v71, v71, v245
  v_mul_f32 v52, v52, v244
  v_mul_f32 v53, v53, v244
  v_mul_f32 v72, v72, v245
  v_mul_f32 v73, v73, v245
  v_mul_f32 v54, v54, v244
  v_mul_f32 v55, v55, v244
  v_mul_f32 v74, v74, v245
  v_mul_f32 v75, v75, v245
  v_mul_f32 v56, v56, v244
  v_mul_f32 v57, v57, v244
  v_mul_f32 v76, v76, v245
  v_mul_f32 v77, v77, v245
  v_mul_f32 v58, v58, v244
  v_mul_f32 v59, v59, v244
  v_mul_f32 v78, v78, v245
  v_mul_f32 v79, v79, v245
  v_cvt_pk_bf16_f32 v104, v40, v41
  v_cvt_pk_bf16_f32 v114, v60, v61
  v_cvt_pk_bf16_f32 v105, v42, v43
  v_cvt_pk_bf16_f32 v115, v62, v63
  v_cvt_pk_bf16_f32 v106, v44, v45
  v_cvt_pk_bf16_f32 v116, v64, v65
  v_cvt_pk_bf16_f32 v107, v46, v47
  v_cvt_pk_bf16_f32 v117, v66, v67
  v_cvt_pk_bf16_f32 v108, v48, v49
  v_cvt_pk_bf16_f32 v118, v68, v69
  v_cvt_pk_bf16_f32 v109, v50, v51
  v_cvt_pk_bf16_f32 v119, v70, v71
  v_cvt_pk_bf16_f32 v110, v52, v53
  v_cvt_pk_bf16_f32 v120, v72, v73
  v_cvt_pk_bf16_f32 v111, v54, v55
  v_cvt_pk_bf16_f32 v121, v74, v75
  v_cvt_pk_bf16_f32 v112, v56, v57
  v_cvt_pk_bf16_f32 v122, v76, v77
  v_cvt_pk_bf16_f32 v113, v58, v59
  v_cvt_pk_bf16_f32 v123, v78, v79
  buffer_store_dwordx4 v[104:107], v230, s[28:31], s46 offen offset:0 sc1
  buffer_store_dwordx4 v[108:111], v230, s[28:31], s46 offen offset:256 sc1
  buffer_store_dwordx4 v[112:115], v230, s[28:31], s46 offen offset:512 sc1
  buffer_store_dwordx4 v[116:119], v230, s[28:31], s46 offen offset:768 sc1
  buffer_store_dwordx4 v[120:123], v231, s[28:31], s54 offen offset:0 sc1
  v_max3_f32 v238, v124, v125, v126
  v_min3_f32 v239, v124, v125, v126
  v_max3_f32 v238, v238, v127, v128
  v_min3_f32 v239, v239, v127, v128
  v_max3_f32 v238, v238, v129, v130
  v_min3_f32 v239, v239, v129, v130
  v_max3_f32 v238, v238, v131, v132
  v_min3_f32 v239, v239, v131, v132
  v_max3_f32 v238, v238, v133, v134
  v_min3_f32 v239, v239, v133, v134
  v_max3_f32 v238, v238, v135, v136
  v_min3_f32 v239, v239, v135, v136
  v_max3_f32 v238, v238, v137, v138
  v_min3_f32 v239, v239, v137, v138
  v_max3_f32 v238, v238, v139, v140
  v_min3_f32 v239, v239, v139, v140
  v_max3_f32 v238, v238, v141, v142
  v_min3_f32 v239, v239, v141, v142
  v_max_f32 v238, v238, v143
  v_min_f32 v239, v239, v143
  v_mul_f32 v238, v238, v246
  v_mul_f32 v239, v239, v246
  v_fma_f32 v40, v124, v246, -v238
  v_fma_f32 v41, v125, v246, -v238
  v_fma_f32 v60, -v124, v246, v239
  v_fma_f32 v61, -v125, v246, v239
  v_fma_f32 v42, v126, v246, -v238
  v_fma_f32 v43, v127, v246, -v238
  v_fma_f32 v62, -v126, v246, v239
  v_fma_f32 v63, -v127, v246, v239
  v_fma_f32 v44, v128, v246, -v238
  v_fma_f32 v45, v129, v246, -v238
  v_fma_f32 v64, -v128, v246, v239
  v_fma_f32 v65, -v129, v246, v239
  v_fma_f32 v46, v130, v246, -v238
  v_fma_f32 v47, v131, v246, -v238
  v_fma_f32 v66, -v130, v246, v239
  v_fma_f32 v67, -v131, v246, v239
  v_fma_f32 v48, v132, v246, -v238
  v_fma_f32 v49, v133, v246, -v238
  v_fma_f32 v68, -v132, v246, v239
  v_fma_f32 v69, -v133, v246, v239
  v_fma_f32 v50, v134, v246, -v238
  v_fma_f32 v51, v135, v246, -v238
  v_fma_f32 v70, -v134, v246, v239
  v_fma_f32 v71, -v135, v246, v239
  v_fma_f32 v52, v136, v246, -v238
  v_fma_f32 v53, v137, v246, -v238
  v_fma_f32 v72, -v136, v246, v239
  v_fma_f32 v73, -v137, v246, v239
  v_fma_f32 v54, v138, v246, -v238
  v_fma_f32 v55, v139, v246, -v238
  v_fma_f32 v74, -v138, v246, v239
  v_fma_f32 v75, -v139, v246, v239
  v_fma_f32 v56, v140, v246, -v238
  v_fma_f32 v57, v141, v246, -v238
  v_fma_f32 v76, -v140, v246, v239
  v_fma_f32 v77, -v141, v246, v239
  v_fma_f32 v58, v142, v246, -v238
  v_fma_f32 v59, v143, v246, -v238
  v_fma_f32 v78, -v142, v246, v239
  v_fma_f32 v79, -v143, v246, v239
  v_exp_f32 v40, v40
  v_exp_f32 v60, v60
  v_exp_f32 v41, v41
  v_exp_f32 v61, v61
  v_exp_f32 v42, v42
  v_exp_f32 v62, v62
  v_exp_f32 v43, v43
  v_exp_f32 v63, v63
  v_exp_f32 v44, v44
  v_exp_f32 v64, v64
  v_exp_f32 v45, v45
  v_exp_f32 v65, v65
  v_exp_f32 v46, v46
  v_exp_f32 v66, v66
  v_exp_f32 v47, v47
  v_exp_f32 v67, v67
  v_exp_f32 v48, v48
  v_exp_f32 v68, v68
  v_exp_f32 v49, v49
  v_exp_f32 v69, v69
  v_exp_f32 v50, v50
  v_exp_f32 v70, v70
  v_exp_f32 v51, v51
  v_exp_f32 v71, v71
  v_exp_f32 v52, v52
  v_exp_f32 v72, v72
  v_exp_f32 v53, v53
  v_exp_f32 v73, v73
  v_exp_f32 v54, v54
  v_exp_f32 v74, v74
  v_exp_f32 v55, v55
  v_exp_f32 v75, v75
  v_exp_f32 v56, v56
  v_exp_f32 v76, v76
  v_exp_f32 v57, v57
  v_exp_f32 v77, v77
  v_exp_f32 v58, v58
  v_exp_f32 v78, v78
  v_exp_f32 v59, v59
  v_exp_f32 v79, v79
  v_add_f32 v240, v40, v42
  v_add_f32 v241, v41, v43
  v_add_f32 v242, v60, v62
  v_add_f32 v243, v61, v63
  v_add_f32 v240, v240, v44
  v_add_f32 v241, v241, v45
  v_add_f32 v242, v242, v64
  v_add_f32 v243, v243, v65
  v_add_f32 v240, v240, v46
  v_add_f32 v241, v241, v47
  v_add_f32 v242, v242, v66
  v_add_f32 v243, v243, v67
  v_add_f32 v240, v240, v48
  v_add_f32 v241, v241, v49
  v_add_f32 v242, v242, v68
  v_add_f32 v243, v243, v69
  v_add_f32 v240, v240, v50
  v_add_f32 v241, v241, v51
  v_add_f32 v242, v242, v70
  v_add_f32 v243, v243, v71
  v_add_f32 v240, v240, v52
  v_add_f32 v241, v241, v53
  v_add_f32 v242, v242, v72
  v_add_f32 v243, v243, v73
  v_add_f32 v240, v240, v54
  v_add_f32 v241, v241, v55
  v_add_f32 v242, v242, v74
  v_add_f32 v243, v243, v75
  v_add_f32 v240, v240, v56
  v_add_f32 v241, v241, v57
  v_add_f32 v242, v242, v76
  v_add_f32 v243, v243, v77
  v_add_f32 v240, v240, v58
  v_add_f32 v241, v241, v59
  v_add_f32 v242, v242, v78
  v_add_f32 v243, v243, v79
  v_add_f32 v244, v240, v241
  v_add_f32 v245, v242, v243
  v_rcp_f32 v244, v244
  v_rcp_f32 v245, v245
  v_mul_f32 v40, v40, v244
  v_mul_f32 v41, v41, v244
  v_mul_f32 v60, v60, v245
  v_mul_f32 v61, v61, v245
  v_mul_f32 v42, v42, v244
  v_mul_f32 v43, v43, v244
  v_mul_f32 v62, v62, v245
  v_mul_f32 v63, v63, v245
  v_mul_f32 v44, v44, v244
  v_mul_f32 v45, v45, v244
  v_mul_f32 v64, v64, v245
  v_mul_f32 v65, v65, v245
  v_mul_f32 v46, v46, v244
  v_mul_f32 v47, v47, v244
  v_mul_f32 v66, v66, v245
  v_mul_f32 v67, v67, v245
  v_mul_f32 v48, v48, v244
  v_mul_f32 v49, v49, v244
  v_mul_f32 v68, v68, v245
  v_mul_f32 v69, v69, v245
  v_mul_f32 v50, v50, v244
  v_mul_f32 v51, v51, v244
  v_mul_f32 v70, v70, v245
  v_mul_f32 v71, v71, v245
  v_mul_f32 v52, v52, v244
  v_mul_f32 v53, v53, v244
  v_mul_f32 v72, v72, v245
  v_mul_f32 v73, v73, v245
  v_mul_f32 v54, v54, v244
  v_mul_f32 v55, v55, v244
  v_mul_f32 v74, v74, v245
  v_mul_f32 v75, v75, v245
  v_mul_f32 v56, v56, v244
  v_mul_f32 v57, v57, v244
  v_mul_f32 v76, v76, v245
  v_mul_f32 v77, v77, v245
  v_mul_f32 v58, v58, v244
  v_mul_f32 v59, v59, v244
  v_mul_f32 v78, v78, v245
  v_mul_f32 v79, v79, v245
  v_cvt_pk_bf16_f32 v124, v40, v41
  v_cvt_pk_bf16_f32 v134, v60, v61
  v_cvt_pk_bf16_f32 v125, v42, v43
  v_cvt_pk_bf16_f32 v135, v62, v63
  v_cvt_pk_bf16_f32 v126, v44, v45
  v_cvt_pk_bf16_f32 v136, v64, v65
  v_cvt_pk_bf16_f32 v127, v46, v47
  v_cvt_pk_bf16_f32 v137, v66, v67
  v_cvt_pk_bf16_f32 v128, v48, v49
  v_cvt_pk_bf16_f32 v138, v68, v69
  v_cvt_pk_bf16_f32 v129, v50, v51
  v_cvt_pk_bf16_f32 v139, v70, v71
  v_cvt_pk_bf16_f32 v130, v52, v53
  v_cvt_pk_bf16_f32 v140, v72, v73
  v_cvt_pk_bf16_f32 v131, v54, v55
  v_cvt_pk_bf16_f32 v141, v74, v75
  v_cvt_pk_bf16_f32 v132, v56, v57
  v_cvt_pk_bf16_f32 v142, v76, v77
  v_cvt_pk_bf16_f32 v133, v58, v59
  v_cvt_pk_bf16_f32 v143, v78, v79
  buffer_store_dwordx4 v[124:127], v230, s[28:31], s46 offen offset:1024 sc1
  buffer_store_dwordx4 v[128:131], v230, s[28:31], s46 offen offset:1280 sc1
  buffer_store_dwordx4 v[132:135], v230, s[28:31], s46 offen offset:1536 sc1
  buffer_store_dwordx4 v[136:139], v230, s[28:31], s46 offen offset:1792 sc1
  buffer_store_dwordx4 v[140:143], v231, s[28:31], s54 offen offset:256 sc1
  s_waitcnt vmcnt(0)
  s_endpgm
L_k1_ffn:
  s_mov_b32 s24, s12
  s_and_b32 s25, s13, 0xffff
  s_mov_b32 s26, 0x21c000
  s_mov_b32 s27, 0x20000
  s_sub_u32 s56, s41, 8
  s_mul_i32 s56, s56, 7
  s_min_u32 s56, s56, 47
  s_lshl_b32 s46, s40, 7
  s_lshl_b32 s54, s41, 4
  s_add_u32 s46, s46, s54
  s_add_u32 s46, s46, s42
  s_sub_u32 s46, s46, 128
  s_mul_i32 s46, s46, 1280
  v_lshlrev_b32 v234, 4, v1
  v_mov_b32 v235, 0x7ffffff0
  v_cmp_gt_u32 vcc, 16, v1
  s_nop 1
  v_cndmask_b32 v235, v235, v234, vcc
  buffer_load_dwordx4 v[196:199], v234, s[20:23], s46 offen
  buffer_load_dwordx4 v[200:203], v235, s[20:23], s46 offen offset:1024
  s_add_u32 s46, s46, 10240
  buffer_load_dwordx4 v[204:207], v234, s[20:23], s46 offen
  buffer_load_dwordx4 v[208:211], v235, s[20:23], s46 offen offset:1024
  s_lshl_b32 s54, s56, 6
  v_lshlrev_b32 v236, 3, v1
  v_add_u32 v236, s54, v236
  v_mov_b32 v237, 0x7ffffff0
  v_cmp_gt_u32 vcc, 56, v1
  s_nop 1
  v_cndmask_b32 v236, v237, v236, vcc
  s_mul_i32 s46, s40, 40
  s_mul_i32 s54, s42, 5
  s_add_u32 s46, s46, s54
  s_mul_i32 s46, s46, 3456
  buffer_load_dwordx2 v[224:225], v236, s[24:27], s46 offen
  s_add_u32 s46, s46, 3456
  buffer_load_dwordx2 v[226:227], v236, s[24:27], s46 offen
  s_add_u32 s46, s46, 3456
  buffer_load_dwordx2 v[228:229], v236, s[24:27], s46 offen
  s_add_u32 s46, s46, 3456
  buffer_load_dwordx2 v[230:231], v236, s[24:27], s46 offen
  s_add_u32 s46, s46, 3456
  buffer_load_dwordx2 v[232:233], v236, s[24:27], s46 offen
  s_lshl_b32 s46, s42, 7
  v_add_u32 v152, s46, v1
  v_lshrrev_b32 v153, 3, v152
  v_bfe_u32 v154, v152, 4, 3
  v_and_b32 v152, 7, v152
  v_xor_b32 v152, v152, v154
  v_mul_u32_u24 v153, 1280, v153
  v_lshl_add_u32 v8, v152, 4, v153
  v_add_u32 v152, s46, v1
  v_add_u32 v152, 64, v152
  v_lshrrev_b32 v153, 3, v152
  v_bfe_u32 v154, v152, 4, 3
  v_and_b32 v152, 7, v152
  v_xor_b32 v152, v152, v154
  v_mul_u32_u24 v153, 1280, v153
  v_lshl_add_u32 v9, v152, 4, v153
  s_mul_i32 s49, s40, 163840
  s_lshl_b32 s47, s42, 11
  v_bfe_u32 v152, v16, 1, 3
  v_xor_b32 v152, v152, v17
  v_lshlrev_b32 v152, 4, v152
  v_lshl_add_u32 v152, v16, 7, v152
  s_lshl_b32 s46, s43, 12
  s_add_u32 s46, s46, 92160
  v_xor_b32 v153, 0, v152
  v_add_u32 v10, s46, v153
  v_xor_b32 v153, 32, v152
  v_add_u32 v11, s46, v153
  v_xor_b32 v153, 64, v152
  v_add_u32 v12, s46, v153
  v_xor_b32 v153, 96, v152
  v_add_u32 v13, s46, v153
  s_add_u32 s50, s49, 0
  s_add_u32 m0, s47, 92160
  s_nop 0
  buffer_load_dwordx4 v8, s[20:23], s50 offen lds
  s_add_u32 m0, s47, 93184
  s_nop 0
  buffer_load_dwordx4 v9, s[20:23], s50 offen lds
  s_mul_i32 s46, s42, 112
  s_lshl_b32 s54, s56, 6
  v_add_u32 v152, s46, v1
  v_mul_u32_u24 v153, 2341, v152
  v_lshrrev_b32 v153, 16, v153
  v_mul_u32_u24 v154, 28, v153
  v_sub_u32 v154, v152, v154
  v_mul_u32_u24 v155, 3456, v153
  v_lshl_add_u32 v155, v154, 4, v155
  v_add_u32 v4, s54, v155
  v_add_u32 v152, s46, v1
  v_add_u32 v152, 64, v152
  v_mul_u32_u24 v153, 2341, v152
  v_lshrrev_b32 v153, 16, v153
  v_mul_u32_u24 v154, 28, v153
  v_sub_u32 v154, v152, v154
  v_mul_u32_u24 v155, 3456, v153
  v_lshl_add_u32 v155, v154, 4, v155
  v_add_u32 v5, s54, v155
  s_mul_i32 s45, s42, 1792
  s_mov_b32 s50, 0
  s_add_u32 m0, s45, 0
  s_nop 0
  buffer_load_dwordx4 v4, s[24:27], s50 offen lds
  s_add_u32 m0, s45, 1024
  s_mov_b32 exec_hi, 0xffff
  buffer_load_dwordx4 v5, s[24:27], s50 offen lds
  s_mov_b64 exec, -1
  s_mov_b32 s50, 110592
  s_add_u32 m0, s45, 15360
  s_nop 0
  buffer_load_dwordx4 v4, s[24:27], s50 offen lds
  s_add_u32 m0, s45, 16384
  s_mov_b32 exec_hi, 0xffff
  buffer_load_dwordx4 v5, s[24:27], s50 offen lds
  s_mov_b64 exec, -1
  s_add_u32 s50, s49, 128
  s_add_u32 m0, s47, 108544
  s_nop 0
  buffer_load_dwordx4 v8, s[20:23], s50 offen lds
  s_add_u32 m0, s47, 109568
  s_nop 0
  buffer_load_dwordx4 v9, s[20:23], s50 offen lds
  s_mov_b32 s32, s14
  s_and_b32 s33, s15, 0xffff
  s_mov_b32 s34, 0xd80
  s_mov_b32 s35, 0x20000
  s_mov_b32 s50, 221184
  s_add_u32 m0, s45, 30720
  s_nop 0
  buffer_load_dwordx4 v4, s[24:27], s50 offen lds
  s_add_u32 m0, s45, 31744
  s_mov_b32 exec_hi, 0xffff
  buffer_load_dwordx4 v5, s[24:27], s50 offen lds
  s_mov_b64 exec, -1
  v_bfe_u32 v152, v1, 2, 2
  v_lshl_add_u32 v152, v17, 3, v152
  v_mul_u32_u24 v152, 448, v152
  v_and_b32 v153, 1, v3
  v_lshl_add_u32 v152, v153, 5, v152
  v_and_b32 v153, 3, v1
  v_lshl_add_u32 v6, v153, 3, v152
  s_lshl_b32 s46, s44, 8
  v_add_u32 v6, s46, v6
  v_add_u32 v7, 46080, v6
  s_cmp_eq_u32 s44, 1
  s_cbranch_scc1 L_ffn_B
  s_waitcnt vmcnt(4)
  s_barrier
  ds_read_b128 v[104:107], v10 offset:0
  ds_read_b128 v[108:111], v11 offset:0
  ds_read_b128 v[112:115], v12 offset:0
  ds_read_b128 v[116:119], v13 offset:0
  s_mov_b32 s50, 331776
  s_add_u32 m0, s45, 46080
  s_nop 0
  buffer_load_dwordx4 v4, s[24:27], s50 offen lds
  s_add_u32 m0, s45, 47104
  s_mov_b32 exec_hi, 0xffff
  buffer_load_dwordx4 v5, s[24:27], s50 offen lds
  s_mov_b64 exec, -1
  ds_read_b64_tr_b16 v[24:25], v6 offset:0
  ds_read_b64_tr_b16 v[26:27], v6 offset:1792
  ds_read_b64_tr_b16 v[28:29], v6 offset:64
  ds_read_b64_tr_b16 v[30:31], v6 offset:1856
  ds_read_b64_tr_b16 v[32:33], v6 offset:128
  ds_read_b64_tr_b16 v[34:35], v6 offset:1920
  ds_read_b64_tr_b16 v[36:37], v6 offset:192
  ds_read_b64_tr_b16 v[38:39], v6 offset:1984
  s_waitcnt lgkmcnt(6)
  v_mfma_f32_32x32x16_bf16 v[40:55], v[24:27], v[104:107], 0
  v_mov_b32 v216, 0
  v_mov_b32 v217, 0
  v_mov_b32 v218, 0
  v_mov_b32 v219, 0
  v_lshlrev_b32 v240, 16, v196
  v_and_b32 v241, 0xffff0000, v196
  v_add_f32 v216, v216, v240
  v_fmac_f32 v217, v240, v240
  v_add_f32 v216, v216, v241
  v_fmac_f32 v217, v241, v241
  v_lshlrev_b32 v240, 16, v197
  v_and_b32 v241, 0xffff0000, v197
  v_add_f32 v216, v216, v240
  ds_read_b64_tr_b16 v[24:25], v6 offset:7168
  ds_read_b64_tr_b16 v[26:27], v6 offset:8960
  s_waitcnt lgkmcnt(6)
  v_mfma_f32_32x32x16_bf16 v[56:71], v[28:31], v[104:107], 0
  s_mov_b32 s50, 442368
  s_add_u32 m0, s45, 61440
  s_nop 0
  buffer_load_dwordx4 v4, s[24:27], s50 offen lds
  s_add_u32 m0, s45, 62464
  s_mov_b32 exec_hi, 0xffff
  buffer_load_dwordx4 v5, s[24:27], s50 offen lds
  s_mov_b64 exec, -1
  s_add_u32 s50, s49, 256
  s_add_u32 m0, s47, 124928
  s_nop 0
  buffer_load_dwordx4 v8, s[20:23], s50 offen lds
  s_add_u32 m0, s47, 125952
  s_nop 0
  buffer_load_dwordx4 v9, s[20:23], s50 offen lds
  v_fmac_f32 v217, v240, v240
  v_add_f32 v216, v216, v241
  v_fmac_f32 v217, v241, v241
  v_lshlrev_b32 v240, 16, v198
  v_and_b32 v241, 0xffff0000, v198
  v_add_f32 v216, v216, v240
  v_fmac_f32 v217, v240, v240
  v_add_f32 v216, v216, v241
  v_fmac_f32 v217, v241, v241
  v_lshlrev_b32 v240, 16, v199
  v_and_b32 v241, 0xffff0000, v199
  v_add_f32 v216, v216, v240
  v_fmac_f32 v217, v240, v240
  v_add_f32 v216, v216, v241
  ds_read_b64_tr_b16 v[28:29], v6 offset:7232
  ds_read_b64_tr_b16 v[30:31], v6 offset:9024
  s_waitcnt lgkmcnt(6)
  v_mfma_f32_32x32x16_bf16 v[72:87], v[32:35], v[104:107], 0
  v_fmac_f32 v217, v241, v241
  v_lshlrev_b32 v240, 16, v200
  v_and_b32 v241, 0xffff0000, v200
  v_add_f32 v216, v216, v240
  v_fmac_f32 v217, v240, v240
  v_add_f32 v216, v216, v241
  v_fmac_f32 v217, v241, v241
  v_lshlrev_b32 v240, 16, v201
  v_and_b32 v241, 0xffff0000, v201
  v_add_f32 v216, v216, v240
  v_fmac_f32 v217, v240, v240
  v_add_f32 v216, v216, v241
  v_fmac_f32 v217, v241, v241
  v_lshlrev_b32 v240, 16, v202
  ds_read_b64_tr_b16 v[32:33], v6 offset:7296
  ds_read_b64_tr_b16 v[34:35], v6 offset:9088
  s_waitcnt lgkmcnt(6)
  v_mfma_f32_32x32x16_bf16 v[88:103], v[36:39], v[104:107], 0
  v_and_b32 v241, 0xffff0000, v202
  v_add_f32 v216, v216, v240
  v_fmac_f32 v217, v240, v240
  v_add_f32 v216, v216, v241
  v_fmac_f32 v217, v241, v241
  v_lshlrev_b32 v240, 16, v203
  v_and_b32 v241, 0xffff0000, v203
  v_add_f32 v216, v216, v240
  v_fmac_f32 v217, v240, v240
  v_add_f32 v216, v216, v241
  v_fmac_f32 v217, v241, v241
  v_lshlrev_b32 v240, 16, v204
  v_and_b32 v241, 0xffff0000, v204
  v_add_f32 v218, v218, v240
  ds_read_b64_tr_b16 v[36:37], v6 offset:7360
  ds_read_b64_tr_b16 v[38:39], v6 offset:9152
  s_waitcnt lgkmcnt(6)
  v_mfma_f32_32x32x16_bf16 v[40:55], v[24:27], v[108:111], v[40:55]
  v_fmac_f32 v219, v240, v240
  v_add_f32 v218, v218, v241
  v_fmac_f32 v219, v241, v241
  v_lshlrev_b32 v240, 16, v205
  v_and_b32 v241, 0xffff0000, v205
  v_add_f32 v218, v218, v240
  v_fmac_f32 v219, v240, v240
  v_add_f32 v218, v218, v241
  v_fmac_f32 v219, v241, v241
  v_lshlrev_b32 v240, 16, v206
  v_and_b32 v241, 0xffff0000, v206
  v_add_f32 v218, v218, v240
  v_fmac_f32 v219, v240, v240
  v_add_f32 v218, v218, v241
  ds_read_b64_tr_b16 v[24:25], v6 offset:15360
  ds_read_b64_tr_b16 v[26:27], v6 offset:17152
  s_waitcnt lgkmcnt(6)
  v_mfma_f32_32x32x16_bf16 v[56:71], v[28:31], v[108:111], v[56:71]
  v_fmac_f32 v219, v241, v241
  v_lshlrev_b32 v240, 16, v207
  v_and_b32 v241, 0xffff0000, v207
  v_add_f32 v218, v218, v240
  v_fmac_f32 v219, v240, v240
  v_add_f32 v218, v218, v241
  v_fmac_f32 v219, v241, v241
  v_lshlrev_b32 v240, 16, v208
  v_and_b32 v241, 0xffff0000, v208
  v_add_f32 v218, v218, v240
  v_fmac_f32 v219, v240, v240
  v_add_f32 v218, v218, v241
  v_fmac_f32 v219, v241, v241
  v_lshlrev_b32 v240, 16, v209
  ds_read_b64_tr_b16 v[28:29], v6 offset:15424
  ds_read_b64_tr_b16 v[30:31], v6 offset:17216
  s_waitcnt lgkmcnt(6)
  v_mfma_f32_32x32x16_bf16 v[72:87], v[32:35], v[108:111], v[72:87]
  v_and_b32 v241, 0xffff0000, v209
  v_add_f32 v218, v218, v240
  v_fmac_f32 v219, v240, v240
  v_add_f32 v218, v218, v241
  v_fmac_f32 v219, v241, v241
  v_lshlrev_b32 v240, 16, v210
  v_and_b32 v241, 0xffff0000, v210
  v_add_f32 v218, v218, v240
  v_fmac_f32 v219, v240, v240
  v_add_f32 v218, v218, v241
  v_fmac_f32 v219, v241, v241
  v_lshlrev_b32 v240, 16, v211
  v_and_b32 v241, 0xffff0000, v211
  v_add_f32 v218, v218, v240
  ds_read_b64_tr_b16 v[32:33], v6 offset:15488
  ds_read_b64_tr_b16 v[34:35], v6 offset:17280
  s_waitcnt lgkmcnt(6)
  v_mfma_f32_32x32x16_bf16 v[88:103], v[36:39], v[108:111], v[88:103]
  v_fmac_f32 v219, v240, v240
  v_add_f32 v218, v218, v241
  v_fmac_f32 v219, v241, v241
  s_nop 1
  v_add_f32_dpp v216, v216, v216 quad_perm:[1,0,3,2] row_mask:0xf bank_mask:0xf
  v_add_f32_dpp v217, v217, v217 quad_perm:[1,0,3,2] row_mask:0xf bank_mask:0xf
  v_add_f32_dpp v218, v218, v218 quad_perm:[1,0,3,2] row_mask:0xf bank_mask:0xf
  v_add_f32_dpp v219, v219, v219 quad_perm:[1,0,3,2] row_mask:0xf bank_mask:0xf
  s_nop 1
  v_add_f32_dpp v216, v216, v216 quad_perm:[2,3,0,1] row_mask:0xf bank_mask:0xf
  v_add_f32_dpp v217, v217, v217 quad_perm:[2,3,0,1] row_mask:0xf bank_mask:0xf
  v_add_f32_dpp v218, v218, v218 quad_perm:[2,3,0,1] row_mask:0xf bank_mask:0xf
  v_add_f32_dpp v219, v219, v219 quad_perm:[2,3,0,1] row_mask:0xf bank_mask:0xf
  s_nop 1
  ds_read_b64_tr_b16 v[36:37], v6 offset:15552
  ds_read_b64_tr_b16 v[38:39], v6 offset:17344
  s_waitcnt lgkmcnt(6)
  v_mfma_f32_32x32x16_bf16 v[40:55], v[24:27], v[112:115], v[40:55]
  v_add_f32_dpp v216, v216, v216 row_half_mirror row_mask:0xf bank_mask:0xf
  v_add_f32_dpp v217, v217, v217 row_half_mirror row_mask:0xf bank_mask:0xf
  v_add_f32_dpp v218, v218, v218 row_half_mirror row_mask:0xf bank_mask:0xf
  v_add_f32_dpp v219, v219, v219 row_half_mirror row_mask:0xf bank_mask:0xf
  s_nop 1
  v_add_f32_dpp v216, v216, v216 row_mirror row_mask:0xf bank_mask:0xf
  v_add_f32_dpp v217, v217, v217 row_mirror row_mask:0xf bank_mask:0xf
  v_add_f32_dpp v218, v218, v218 row_mirror row_mask:0xf bank_mask:0xf
  v_add_f32_dpp v219, v219, v219 row_mirror row_mask:0xf bank_mask:0xf
  v_mov_b32 v220, v216
  v_mov_b32 v221, v217
  v_mov_b32 v222, v218
  v_mov_b32 v223, v219
  v_permlane16_swap_b32 v216, v220
  ds_read_b64_tr_b16 v[24:25], v6 offset:22528
  ds_read_b64_tr_b16 v[26:27], v6 offset:24320
  s_waitcnt lgkmcnt(6)
  v_mfma_f32_32x32x16_bf16 v[56:71], v[28:31], v[112:115], v[56:71]
  v_permlane16_swap_b32 v217, v221
  v_permlane16_swap_b32 v218, v222
  v_permlane16_swap_b32 v219, v223
  v_add_f32 v216, v216, v220
  v_add_f32 v217, v217, v221
  v_add_f32 v218, v218, v222
  v_add_f32 v219, v219, v223
  v_mov_b32 v220, v216
  v_mov_b32 v221, v217
  v_mov_b32 v222, v218
  v_mov_b32 v223, v219
  v_permlane32_swap_b32 v216, v220
  v_permlane32_swap_b32 v217, v221
  v_permlane32_swap_b32 v218, v222
  ds_read_b64_tr_b16 v[28:29], v6 offset:22592
  ds_read_b64_tr_b16 v[30:31], v6 offset:24384
  s_waitcnt lgkmcnt(6)
  v_mfma_f32_32x32x16_bf16 v[72:87], v[32:35], v[112:115], v[72:87]
  v_permlane32_swap_b32 v219, v223
  v_add_f32 v216, v216, v220
  v_add_f32 v217, v217, v221
  v_add_f32 v218, v218, v222
  v_add_f32 v219, v219, v223
  v_mul_f32 v216, 0x3acccccd, v216
  v_mul_f32 v217, 0x3acccccd, v217
  v_fma_f32 v217, -v216, v216, v217
  v_max_f32 v217, 0, v217
  v_cvt_pk_bf16_f32 v240, v216, v217
  v_lshlrev_b32 v212, 16, v240
  v_xor_b32 v212, 0x80000000, v212
  v_and_b32 v240, 0xffff0000, v240
  v_add_f32 v240, 0x3727c5ac, v240
  ds_read_b64_tr_b16 v[32:33], v6 offset:22656
  ds_read_b64_tr_b16 v[34:35], v6 offset:24448
  s_waitcnt lgkmcnt(6)
  v_mfma_f32_32x32x16_bf16 v[88:103], v[36:39], v[112:115], v[88:103]
  v_cvt_pk_bf16_f32 v240, v240, v240
  v_and_b32 v240, 0xffff0000, v240
  v_sqrt_f32 v240, v240
  s_nop 0
  v_cvt_pk_bf16_f32 v240, v240, v240
  v_and_b32 v240, 0xffff0000, v240
  v_rcp_f32 v213, v240
  v_mul_f32 v218, 0x3acccccd, v218
  v_mul_f32 v219, 0x3acccccd, v219
  v_fma_f32 v219, -v218, v218, v219
  v_max_f32 v219, 0, v219
  v_cvt_pk_bf16_f32 v240, v218, v219
  v_lshlrev_b32 v214, 16, v240
  v_xor_b32 v214, 0x80000000, v214
  v_and_b32 v240, 0xffff0000, v240
  ds_read_b64_tr_b16 v[36:37], v6 offset:22720
  ds_read_b64_tr_b16 v[38:39], v6 offset:24512
  s_waitcnt lgkmcnt(6)
  v_mfma_f32_32x32x16_bf16 v[40:55], v[24:27], v[116:119], v[40:55]
  v_add_f32 v240, 0x3727c5ac, v240
  v_cvt_pk_bf16_f32 v240, v240, v240
  v_and_b32 v240, 0xffff0000, v240
  v_sqrt_f32 v240, v240
  s_nop 0
  v_cvt_pk_bf16_f32 v240, v240, v240
  v_and_b32 v240, 0xffff0000, v240
  v_rcp_f32 v215, v240
  v_mov_b32 v240, 0
  v_mov_b32 v241, 0
  v_lshlrev_b32 v242, 3, v0
  v_mov_b32 v248, 0x7ffffff0
  v_cmp_gt_u32 vcc, 320, v0
  s_nop 1
  v_cndmask_b32 v242, v248, v242, vcc
  s_lshl_b32 s63, s40, 3
  s_waitcnt vmcnt(4)
  s_barrier
  ds_read_b128 v[120:123], v10 offset:16384
  ds_read_b128 v[124:127], v11 offset:16384
  ds_read_b128 v[128:131], v12 offset:16384
  ds_read_b128 v[132:135], v13 offset:16384
  s_mov_b32 s50, 552960
  s_add_u32 m0, s45, 76800
  s_nop 0
  buffer_load_dwordx4 v4, s[24:27], s50 offen lds
  s_add_u32 m0, s45, 77824
  s_mov_b32 exec_hi, 0xffff
  buffer_load_dwordx4 v5, s[24:27], s50 offen lds
  s_mov_b64 exec, -1
  ds_read_b64_tr_b16 v[24:25], v6 offset:30720
  ds_read_b64_tr_b16 v[26:27], v6 offset:32512
  s_waitcnt lgkmcnt(10)
  v_mfma_f32_32x32x16_bf16 v[56:71], v[28:31], v[116:119], v[56:71]
  s_add_u32 s63, s63, s41
  s_sub_u32 s63, s63, 8
  s_mul_i32 s62, s63, 2560
  s_add_u32 s62, s62, 12320768
  s_cmp_lt_u32 s63, 126
  s_cselect_b32 s62, s62, 0x7ffffff0
  buffer_store_dwordx2 v[240:241], v242, s[28:31], s62 offen sc1
  v_cmp_eq_u32 vcc, 0, v0
  s_nop 1
  v_cndmask_b32 v242, v248, 0, vcc
  s_lshl_b32 s62, s63, 8
  s_add_u32 s62, s62, 18591744
  buffer_store_dword v240, v242, s[28:31], s62 offen
  v_lshlrev_b32 v244, 16, v224
  ds_read_b64_tr_b16 v[28:29], v6 offset:30784
  ds_read_b64_tr_b16 v[30:31], v6 offset:32576
  s_waitcnt lgkmcnt(10)
  v_mfma_f32_32x32x16_bf16 v[72:87], v[32:35], v[116:119], v[72:87]
  v_and_b32 v245, 0xffff0000, v224
  v_lshlrev_b32 v246, 16, v225
  v_and_b32 v247, 0xffff0000, v225
  v_lshlrev_b32 v238, 16, v226
  v_and_b32 v239, 0xffff0000, v226
  v_add_f32 v244, v244, v238
  v_add_f32 v245, v245, v239
  v_lshlrev_b32 v238, 16, v227
  v_and_b32 v239, 0xffff0000, v227
  v_add_f32 v246, v246, v238
  v_add_f32 v247, v247, v239
  v_lshlrev_b32 v238, 16, v228
  v_and_b32 v239, 0xffff0000, v228
  v_add_f32 v244, v244, v238
  ds_read_b64_tr_b16 v[32:33], v6 offset:30848
  ds_read_b64_tr_b16 v[34:35], v6 offset:32640
  s_waitcnt lgkmcnt(10)
  v_mfma_f32_32x32x16_bf16 v[88:103], v[36:39], v[116:119], v[88:103]
  v_add_f32 v245, v245, v239
  v_lshlrev_b32 v238, 16, v229
  v_and_b32 v239, 0xffff0000, v229
  v_add_f32 v246, v246, v238
  v_add_f32 v247, v247, v239
  v_lshlrev_b32 v238, 16, v230
  v_and_b32 v239, 0xffff0000, v230
  v_add_f32 v244, v244, v238
  v_add_f32 v245, v245, v239
  v_lshlrev_b32 v238, 16, v231
  v_and_b32 v239, 0xffff0000, v231
  v_add_f32 v246, v246, v238
  v_add_f32 v247, v247, v239
  v_lshlrev_b32 v238, 16, v232
  ds_read_b64_tr_b16 v[36:37], v6 offset:30912
  ds_read_b64_tr_b16 v[38:39], v6 offset:32704
  s_waitcnt lgkmcnt(6)
  v_mfma_f32_32x32x16_bf16 v[40:55], v[24:27], v[120:123], v[40:55]
  v_and_b32 v239, 0xffff0000, v232
  v_add_f32 v244, v244, v238
  v_add_f32 v245, v245, v239
  v_lshlrev_b32 v238, 16, v233
  v_and_b32 v239, 0xffff0000, v233
  v_add_f32 v246, v246, v238
  v_add_f32 v247, v247, v239
  s_lshl_b32 s62, s42, 10
  s_add_u32 s62, s62, 143360
  v_lshlrev_b32 v238, 4, v1
  v_add_u32 v238, s62, v238
  ds_write_b128 v238, v[244:247]
  v_mov_b32 v238, s62
  ds_write_b128 v238, v[212:215] offset:1008
  ds_read_b64_tr_b16 v[24:25], v6 offset:37888
  ds_read_b64_tr_b16 v[26:27], v6 offset:39680
  s_waitcnt lgkmcnt(8)
  v_mfma_f32_32x32x16_bf16 v[56:71], v[28:31], v[120:123], v[56:71]
  s_mov_b32 s50, 663552
  s_add_u32 m0, s45, 0
  s_nop 0
  buffer_load_dwordx4 v4, s[24:27], s50 offen lds
  s_add_u32 m0, s45, 1024
  s_mov_b32 exec_hi, 0xffff
  buffer_load_dwordx4 v5, s[24:27], s50 offen lds
  s_mov_b64 exec, -1
  s_add_u32 s50, s49, 384
  s_add_u32 m0, s47, 92160
  s_nop 0
  buffer_load_dwordx4 v8, s[20:23], s50 offen lds
  s_add_u32 m0, s47, 93184
  s_nop 0
  buffer_load_dwordx4 v9, s[20:23], s50 offen lds
  s_lshl_b32 s92, s40, 3
  s_add_u32 s92, s92, s41
  s_sub_u32 s92, s92, 8
  s_lshl_b32 s92, s92, 3
  s_add_u32 s92, s92, s42
  s_cmp_lt_u32 s92, 640
  s_cselect_b32 s96, s88, s90
  s_cselect_b32 s97, s89, s91
  s_cselect_b32 s93, 0, 640
  s_and_b32 s97, s97, 0xffff
  s_mov_b32 s98, 2211840
  s_mov_b32 s99, 0x20000
  s_sub_u32 s93, s92, s93
  s_mul_i32 s93, s93, 1280
  ds_read_b64_tr_b16 v[28:29], v6 offset:37952
  ds_read_b64_tr_b16 v[30:31], v6 offset:39744
  s_waitcnt lgkmcnt(8)
  v_mfma_f32_32x32x16_bf16 v[72:87], v[32:35], v[120:123], v[72:87]
  v_lshlrev_b32 v176, 4, v1
  v_mov_b32 v177, 0x7ffffff0
  v_cmp_gt_u32 vcc, 16, v1
  s_nop 1
  v_cndmask_b32 v177, v177, v176, vcc
  buffer_load_dwordx4 v[160:163], v176, s[96:99], s93 offen
  buffer_load_dwordx4 v[164:167], v177, s[96:99], s93 offen offset:1024
  s_mov_b32 s96, s90
  s_and_b32 s97, s91, 0xffff
  s_add_u32 s93, s92, 1408
  s_mul_i32 s93, s93, 1280
  buffer_load_dwordx4 v[168:171], v176, s[96:99], s93 offen
  buffer_load_dwordx4 v[172:175], v177, s[96:99], s93 offen offset:1024
  s_add_u32 s93, s92, 384
  s_mul_i32 s93, s93, 1280
  ds_read_b64_tr_b16 v[32:33], v6 offset:38016
  ds_read_b64_tr_b16 v[34:35], v6 offset:39808
  s_waitcnt lgkmcnt(8)
  v_mfma_f32_32x32x16_bf16 v[88:103], v[36:39], v[120:123], v[88:103]
  buffer_load_dwordx4 v[184:187], v176, s[96:99], s93 offen
  buffer_load_dwordx4 v[188:191], v177, s[96:99], s93 offen offset:1024
  s_lshl_b32 s85, s56, 6
  v_lshlrev_b32 v194, 1, v0
  buffer_load_ushort v195, v194, s[32:35], s85 offen
  v_add_u32 v178, 0, v1
  v_mul_u32_u24 v179, 6554, v178
  v_lshrrev_b32 v179, 16, v179
  v_mul_u32_u24 v180, 10, v179
  v_sub_u32 v180, v178, v180
  s_mov_b32 s94, 378880
  v_mul_lo_u32 v179, v179, s94
  v_lshl_add_u32 v176, v180, 4, v179
  v_add_u32 v178, 64, v1
  ds_read_b64_tr_b16 v[36:37], v6 offset:38080
  ds_read_b64_tr_b16 v[38:39], v6 offset:39872
  s_waitcnt lgkmcnt(6)
  v_mfma_f32_32x32x16_bf16 v[40:55], v[24:27], v[124:127], v[40:55]
  v_mul_u32_u24 v179, 6554, v178
  v_lshrrev_b32 v179, 16, v179
  v_mul_u32_u24 v180, 10, v179
  v_sub_u32 v180, v178, v180
  s_mov_b32 s94, 378880
  v_mul_lo_u32 v179, v179, s94
  v_lshl_add_u32 v177, v180, 4, v179
  v_mov_b32 v178, 0x7ffffff0
  v_cmp_gt_u32 vcc, 16, v1
  s_nop 1
  v_cndmask_b32 v177, v178, v177, vcc
  s_sub_u32 s93, s92, 640
  s_lshr_b32 s94, s93, 5
  s_mul_i32 s95, s94, 5120
  s_and_b32 s94, s93, 7
  ds_read_b64_tr_b16 v[24:25], v7 offset:0
  ds_read_b64_tr_b16 v[26:27], v7 offset:1792
  s_waitcnt lgkmcnt(6)
  v_mfma_f32_32x32x16_bf16 v[56:71], v[28:31], v[124:127], v[56:71]
  s_and_b32 s101, s93, 8
  s_lshl_b32 s101, s101, 1
  s_or_b32 s94, s94, s101
  s_and_b32 s101, s93, 16
  s_lshr_b32 s101, s101, 1
  s_or_b32 s94, s94, s101
  s_mul_i32 s94, s94, 160
  s_add_u32 s95, s95, s94
  s_mov_b32 s100, s95
  s_mul_i32 s93, s92, 3277
  s_lshr_b32 s93, s93, 16
  s_mul_i32 s94, s93, 20
  s_sub_u32 s94, s92, s94
  s_lshr_b32 s95, s93, 3
  ds_read_b64_tr_b16 v[28:29], v7 offset:64
  ds_read_b64_tr_b16 v[30:31], v7 offset:1856
  s_waitcnt lgkmcnt(6)
  v_mfma_f32_32x32x16_bf16 v[72:87], v[32:35], v[124:127], v[72:87]
  s_mul_i32 s95, s95, 25600
  s_add_u32 s95, s95, 276480
  s_and_b32 s93, s93, 7
  s_lshr_b32 s96, s93, 1
  s_mul_i32 s96, s96, 5120
  s_and_b32 s97, s93, 1
  s_lshl_b32 s97, s97, 4
  s_add_u32 s97, s97, s94
  s_mul_i32 s97, s97, 160
  s_add_u32 s96, s96, s97
  s_lshr_b32 s97, s93, 2
  s_lshl_b32 s97, s97, 4
  s_and_b32 s98, s93, 3
  s_add_u32 s97, s97, s98
  ds_read_b64_tr_b16 v[32:33], v7 offset:128
  ds_read_b64_tr_b16 v[34:35], v7 offset:1920
  s_waitcnt lgkmcnt(6)
  v_mfma_f32_32x32x16_bf16 v[88:103], v[36:39], v[124:127], v[88:103]
  s_sub_u32 s98, s94, 16
  s_lshl_b32 s98, s98, 2
  s_add_u32 s97, s97, s98
  s_mul_i32 s97, s97, 160
  s_add_u32 s97, s97, 20480
  s_cmp_lt_u32 s94, 16
  s_cselect_b32 s96, s96, s97
  s_add_u32 s95, s95, s96
  s_cmp_lt_u32 s92, 640
  s_cselect_b32 s95, s95, s100
  s_add_u32 s100, s95, 12939264
  s_waitcnt vmcnt(1)
  buffer_store_dwordx4 v[160:163], v176, s[28:31], s100 offen sc1
  buffer_store_dwordx4 v[164:167], v177, s[28:31], s100 offen sc1
  ds_read_b64_tr_b16 v[36:37], v7 offset:192
  ds_read_b64_tr_b16 v[38:39], v7 offset:1984
  s_waitcnt lgkmcnt(6)
  v_mfma_f32_32x32x16_bf16 v[40:55], v[24:27], v[128:131], v[40:55]
  s_add_u32 s93, s92, 1408
  s_lshr_b32 s94, s93, 5
  s_mul_i32 s95, s94, 5120
  s_and_b32 s94, s93, 7
  ds_read_b64_tr_b16 v[24:25], v7 offset:7168
  ds_read_b64_tr_b16 v[26:27], v7 offset:8960
  s_waitcnt lgkmcnt(6)
  v_mfma_f32_32x32x16_bf16 v[56:71], v[28:31], v[128:131], v[56:71]
  s_and_b32 s101, s93, 8
  s_lshl_b32 s101, s101, 1
  s_or_b32 s94, s94, s101
  s_and_b32 s101, s93, 16
  ds_read_b64_tr_b16 v[28:29], v7 offset:7232
  ds_read_b64_tr_b16 v[30:31], v7 offset:9024
  s_waitcnt lgkmcnt(6)
  v_mfma_f32_32x32x16_bf16 v[72:87], v[32:35], v[128:131], v[72:87]
  s_lshr_b32 s101, s101, 1
  s_or_b32 s94, s94, s101
  s_mul_i32 s94, s94, 160
  s_add_u32 s95, s95, s94
  ds_read_b64_tr_b16 v[32:33], v7 offset:7296
  ds_read_b64_tr_b16 v[34:35], v7 offset:9088
  s_waitcnt lgkmcnt(6)
  v_mfma_f32_32x32x16_bf16 v[88:103], v[36:39], v[128:131], v[88:103]
  s_add_u32 s95, s95, 12939264
  s_cmp_lt_u32 s92, 320
  s_cselect_b32 s95, s95, 0x7ffffff0
  buffer_store_dwordx4 v[168:171], v176, s[28:31], s95 offen sc1
  ds_read_b64_tr_b16 v[36:37], v7 offset:7360
  ds_read_b64_tr_b16 v[38:39], v7 offset:9152
  s_waitcnt lgkmcnt(6)
  v_mfma_f32_32x32x16_bf16 v[40:55], v[24:27], v[132:135], v[40:55]
  buffer_store_dwordx4 v[172:175], v177, s[28:31], s95 offen sc1
  s_add_u32 s93, s92, 384
  s_lshr_b32 s94, s93, 5
  s_mul_i32 s95, s94, 5120
  s_barrier
  ds_read_b128 v[104:107], v10 offset:32768
  ds_read_b128 v[108:111], v11 offset:32768
  ds_read_b128 v[112:115], v12 offset:32768
  ds_read_b128 v[116:119], v13 offset:32768
  s_mov_b32 s50, 774144
  s_add_u32 m0, s45, 15360
  s_nop 0
  buffer_load_dwordx4 v4, s[24:27], s50 offen lds
  s_add_u32 m0, s45, 16384
  s_mov_b32 exec_hi, 0xffff
  buffer_load_dwordx4 v5, s[24:27], s50 offen lds
  s_mov_b64 exec, -1
  ds_read_b64_tr_b16 v[24:25], v7 offset:15360
  ds_read_b64_tr_b16 v[26:27], v7 offset:17152
  s_waitcnt lgkmcnt(10)
  v_mfma_f32_32x32x16_bf16 v[56:71], v[28:31], v[132:135], v[56:71]
  s_and_b32 s94, s93, 7
  s_and_b32 s101, s93, 8
  s_lshl_b32 s101, s101, 1
  s_or_b32 s94, s94, s101
  ds_read_b64_tr_b16 v[28:29], v7 offset:15424
  ds_read_b64_tr_b16 v[30:31], v7 offset:17216
  s_waitcnt lgkmcnt(10)
  v_mfma_f32_32x32x16_bf16 v[72:87], v[32:35], v[132:135], v[72:87]
  s_and_b32 s101, s93, 16
  s_lshr_b32 s101, s101, 1
  s_or_b32 s94, s94, s101
  s_mul_i32 s94, s94, 160
  ds_read_b64_tr_b16 v[32:33], v7 offset:15488
  ds_read_b64_tr_b16 v[34:35], v7 offset:17280
  s_waitcnt lgkmcnt(10)
  v_mfma_f32_32x32x16_bf16 v[88:103], v[36:39], v[132:135], v[88:103]
  s_add_u32 s95, s95, s94
  s_add_u32 s95, s95, 12939264
  buffer_store_dwordx4 v[184:187], v176, s[28:31], s95 offen sc1
  buffer_store_dwordx4 v[188:191], v177, s[28:31], s95 offen sc1
  s_lshl_b32 s46, s43, 8
  s_add_u32 s46, s46, 143360
  v_lshlrev_b32 v144, 2, v1
  v_add_u32 v145, s46, v144
  ds_read_b32 v136, v145 offset:0
  ds_read_b32 v137, v145 offset:1024
  ds_read_b32 v138, v145 offset:2048
  ds_read_b32 v139, v145 offset:3072
  ds_read_b32 v140, v145 offset:4096
  ds_read_b32 v141, v145 offset:5120
  ds_read_b32 v142, v145 offset:6144
  ds_read_b32 v143, v145 offset:7168
  v_and_b32 v145, 7, v1
  v_lshlrev_b32 v145, 10, v145
  v_and_b32 v146, 8, v1
  v_add3_u32 v145, v145, v146, 0
  v_add_u32 v145, 144368, v145
  ds_read_b64 v[146:147], v145
  ds_read_b64_tr_b16 v[36:37], v7 offset:15552
  ds_read_b64_tr_b16 v[38:39], v7 offset:17344
  s_waitcnt lgkmcnt(15)
  v_mfma_f32_32x32x16_bf16 v[40:55], v[24:27], v[104:107], v[40:55]
  s_waitcnt vmcnt(8)
  v_lshlrev_b32 v195, 16, v195
  v_lshlrev_b32 v194, 2, v0
  v_add_u32 v194, 142336, v194
  ds_read_b64_tr_b16 v[24:25], v7 offset:22528
  ds_read_b64_tr_b16 v[26:27], v7 offset:24320
  s_waitcnt lgkmcnt(15)
  v_mfma_f32_32x32x16_bf16 v[56:71], v[28:31], v[104:107], v[56:71]
  s_mov_b32 s50, 884736
  s_add_u32 m0, s45, 30720
  s_nop 0
  buffer_load_dwordx4 v4, s[24:27], s50 offen lds
  s_add_u32 m0, s45, 31744
  s_mov_b32 exec_hi, 0xffff
  buffer_load_dwordx4 v5, s[24:27], s50 offen lds
  s_mov_b64 exec, -1
  s_add_u32 s50, s49, 512
  s_add_u32 m0, s47, 108544
  s_nop 0
  buffer_load_dwordx4 v8, s[20:23], s50 offen lds
  s_add_u32 m0, s47, 109568
  s_nop 0
  buffer_load_dwordx4 v9, s[20:23], s50 offen lds
  ds_write_b32 v194, v195
  ds_read_b64_tr_b16 v[28:29], v7 offset:22592
  ds_read_b64_tr_b16 v[30:31], v7 offset:24384
  s_waitcnt lgkmcnt(15)
  v_mfma_f32_32x32x16_bf16 v[72:87], v[32:35], v[104:107], v[72:87]
  ds_read_b64_tr_b16 v[32:33], v7 offset:22656
  ds_read_b64_tr_b16 v[34:35], v7 offset:24448
  s_waitcnt lgkmcnt(7)
  v_mfma_f32_32x32x16_bf16 v[88:103], v[36:39], v[104:107], v[88:103]
  ds_read_b64_tr_b16 v[36:37], v7 offset:22720
  ds_read_b64_tr_b16 v[38:39], v7 offset:24512
  s_waitcnt lgkmcnt(7)
  v_mfma_f32_32x32x16_bf16 v[40:55], v[24:27], v[108:111], v[40:55]
  ds_read_b64_tr_b16 v[24:25], v7 offset:30720
  ds_read_b64_tr_b16 v[26:27], v7 offset:32512
  s_waitcnt lgkmcnt(6)
  v_mfma_f32_32x32x16_bf16 v[56:71], v[28:31], v[108:111], v[56:71]
  ds_read_b64_tr_b16 v[28:29], v7 offset:30784
  ds_read_b64_tr_b16 v[30:31], v7 offset:32576
  s_waitcnt lgkmcnt(6)
  v_mfma_f32_32x32x16_bf16 v[72:87], v[32:35], v[108:111], v[72:87]
  ds_read_b64_tr_b16 v[32:33], v7 offset:30848
  ds_read_b64_tr_b16 v[34:35], v7 offset:32640
  s_waitcnt lgkmcnt(6)
  v_mfma_f32_32x32x16_bf16 v[88:103], v[36:39], v[108:111], v[88:103]
  v_add_f32 v136, v136, v137
  v_add_f32 v136, v136, v138
  v_add_f32 v136, v136, v139
  v_add_f32 v136, v136, v140
  v_add_f32 v136, v136, v141
  v_add_f32 v136, v136, v142
  v_add_f32 v136, v136, v143
  s_lshl_b32 s46, s41, 4
  s_add_u32 s46, s46, s40
  s_lshl_b32 s46, s46, 10
  s_lshl_b32 s54, s43, 8
  s_add_u32 s46, s46, s54
  s_add_u32 s46, s46, 12677120
  buffer_store_dword v136, v144, s[28:31], s46 offen sc1
  s_lshl_b32 s46, s40, 3
  s_add_u32 s46, s46, s41
  s_lshl_b32 s46, s46, 7
  s_add_u32 s46, s46, 12643328
  s_cmp_eq_u32 s43, 0
  s_cselect_b32 s46, s46, 0x7ffffff0
  v_lshlrev_b32 v145, 3, v1
  s_mov_b64 exec, 0xffff
  buffer_store_dwordx2 v[146:147], v145, s[28:31], s46 offen sc1
  s_mov_b64 exec, -1
  ds_read_b64_tr_b16 v[36:37], v7 offset:30912
  ds_read_b64_tr_b16 v[38:39], v7 offset:32704
  s_waitcnt lgkmcnt(6)
  v_mfma_f32_32x32x16_bf16 v[40:55], v[24:27], v[112:115], v[40:55]
  ds_read_b64_tr_b16 v[24:25], v7 offset:37888
  ds_read_b64_tr_b16 v[26:27], v7 offset:39680
  s_waitcnt lgkmcnt(6)
  v_mfma_f32_32x32x16_bf16 v[56:71], v[28:31], v[112:115], v[56:71]
  ds_read_b64_tr_b16 v[28:29], v7 offset:37952
  ds_read_b64_tr_b16 v[30:31], v7 offset:39744
  s_waitcnt lgkmcnt(6)
  v_mfma_f32_32x32x16_bf16 v[72:87], v[32:35], v[112:115], v[72:87]
  ds_read_b64_tr_b16 v[32:33], v7 offset:38016
  ds_read_b64_tr_b16 v[34:35], v7 offset:39808
  s_waitcnt lgkmcnt(6)
  v_mfma_f32_32x32x16_bf16 v[88:103], v[36:39], v[112:115], v[88:103]
  ds_read_b64_tr_b16 v[36:37], v7 offset:38080
  ds_read_b64_tr_b16 v[38:39], v7 offset:39872
  s_waitcnt lgkmcnt(6)
  v_mfma_f32_32x32x16_bf16 v[40:55], v[24:27], v[116:119], v[40:55]
  s_waitcnt vmcnt(8)
  s_barrier
  ds_read_b128 v[120:123], v10 offset:0
  ds_read_b128 v[124:127], v11 offset:0
  ds_read_b128 v[128:131], v12 offset:0
  ds_read_b128 v[132:135], v13 offset:0
  s_mov_b32 s50, 995328
  s_add_u32 m0, s45, 46080
  s_nop 0
  buffer_load_dwordx4 v4, s[24:27], s50 offen lds
  s_add_u32 m0, s45, 47104
  s_mov_b32 exec_hi, 0xffff
  buffer_load_dwordx4 v5, s[24:27], s50 offen lds
  s_mov_b64 exec, -1
  ds_read_b64_tr_b16 v[24:25], v6 offset:0
  ds_read_b64_tr_b16 v[26:27], v6 offset:1792
  s_waitcnt lgkmcnt(10)
  v_mfma_f32_32x32x16_bf16 v[56:71], v[28:31], v[116:119], v[56:71]
  ds_read_b64_tr_b16 v[28:29], v6 offset:64
  ds_read_b64_tr_b16 v[30:31], v6 offset:1856
  s_waitcnt lgkmcnt(10)
  v_mfma_f32_32x32x16_bf16 v[72:87], v[32:35], v[116:119], v[72:87]
  ds_read_b64_tr_b16 v[32:33], v6 offset:128
  ds_read_b64_tr_b16 v[34:35], v6 offset:1920
  s_waitcnt lgkmcnt(10)
  v_mfma_f32_32x32x16_bf16 v[88:103], v[36:39], v[116:119], v[88:103]
  ds_read_b64_tr_b16 v[36:37], v6 offset:192
  ds_read_b64_tr_b16 v[38:39], v6 offset:1984
  s_waitcnt lgkmcnt(6)
  v_mfma_f32_32x32x16_bf16 v[40:55], v[24:27], v[120:123], v[40:55]
  ds_read_b64_tr_b16 v[24:25], v6 offset:7168
  ds_read_b64_tr_b16 v[26:27], v6 offset:8960
  s_waitcnt lgkmcnt(6)
  v_mfma_f32_32x32x16_bf16 v[56:71], v[28:31], v[120:123], v[56:71]
  s_mov_b32 s50, 1105920
  s_add_u32 m0, s45, 61440
  s_nop 0
  buffer_load_dwordx4 v4, s[24:27], s50 offen lds
  s_add_u32 m0, s45, 62464
  s_mov_b32 exec_hi, 0xffff
  buffer_load_dwordx4 v5, s[24:27], s50 offen lds
  s_mov_b64 exec, -1
  s_add_u32 s50, s49, 640
  s_add_u32 m0, s47, 124928
  s_nop 0
  buffer_load_dwordx4 v8, s[20:23], s50 offen lds
  s_add_u32 m0, s47, 125952
  s_nop 0
  buffer_load_dwordx4 v9, s[20:23], s50 offen lds
  ds_read_b64_tr_b16 v[28:29], v6 offset:7232
  ds_read_b64_tr_b16 v[30:31], v6 offset:9024
  s_waitcnt lgkmcnt(6)
  v_mfma_f32_32x32x16_bf16 v[72:87], v[32:35], v[120:123], v[72:87]
  ds_read_b64_tr_b16 v[32:33], v6 offset:7296
  ds_read_b64_tr_b16 v[34:35], v6 offset:9088
  s_waitcnt lgkmcnt(6)
  v_mfma_f32_32x32x16_bf16 v[88:103], v[36:39], v[120:123], v[88:103]
  ds_read_b64_tr_b16 v[36:37], v6 offset:7360
  ds_read_b64_tr_b16 v[38:39], v6 offset:9152
  s_waitcnt lgkmcnt(6)
  v_mfma_f32_32x32x16_bf16 v[40:55], v[24:27], v[124:127], v[40:55]
  ds_read_b64_tr_b16 v[24:25], v6 offset:15360
  ds_read_b64_tr_b16 v[26:27], v6 offset:17152
  s_waitcnt lgkmcnt(6)
  v_mfma_f32_32x32x16_bf16 v[56:71], v[28:31], v[124:127], v[56:71]
  ds_read_b64_tr_b16 v[28:29], v6 offset:15424
  ds_read_b64_tr_b16 v[30:31], v6 offset:17216
  s_waitcnt lgkmcnt(6)
  v_mfma_f32_32x32x16_bf16 v[72:87], v[32:35], v[124:127], v[72:87]
  ds_read_b64_tr_b16 v[32:33], v6 offset:15488
  ds_read_b64_tr_b16 v[34:35], v6 offset:17280
  s_waitcnt lgkmcnt(6)
  v_mfma_f32_32x32x16_bf16 v[88:103], v[36:39], v[124:127], v[88:103]
  s_waitcnt vmcnt(6)
  ds_read_b64_tr_b16 v[36:37], v6 offset:15552
  ds_read_b64_tr_b16 v[38:39], v6 offset:17344
  s_waitcnt lgkmcnt(6)
  v_mfma_f32_32x32x16_bf16 v[40:55], v[24:27], v[128:131], v[40:55]
  ds_read_b64_tr_b16 v[24:25], v6 offset:22528
  ds_read_b64_tr_b16 v[26:27], v6 offset:24320
  s_waitcnt lgkmcnt(6)
  v_mfma_f32_32x32x16_bf16 v[56:71], v[28:31], v[128:131], v[56:71]
  ds_read_b64_tr_b16 v[28:29], v6 offset:22592
  ds_read_b64_tr_b16 v[30:31], v6 offset:24384
  s_waitcnt lgkmcnt(6)
  v_mfma_f32_32x32x16_bf16 v[72:87], v[32:35], v[128:131], v[72:87]
  ds_read_b64_tr_b16 v[32:33], v6 offset:22656
  ds_read_b64_tr_b16 v[34:35], v6 offset:24448
  s_waitcnt lgkmcnt(6)
  v_mfma_f32_32x32x16_bf16 v[88:103], v[36:39], v[128:131], v[88:103]
  ds_read_b64_tr_b16 v[36:37], v6 offset:22720
  ds_read_b64_tr_b16 v[38:39], v6 offset:24512
  s_waitcnt lgkmcnt(6)
  v_mfma_f32_32x32x16_bf16 v[40:55], v[24:27], v[132:135], v[40:55]
  s_waitcnt vmcnt(4)
  s_barrier
  ds_read_b128 v[104:107], v10 offset:16384
  ds_read_b128 v[108:111], v11 offset:16384
  ds_read_b128 v[112:115], v12 offset:16384
  ds_read_b128 v[116:119], v13 offset:16384
  s_mov_b32 s50, 1216512
  s_add_u32 m0, s45, 76800
  s_nop 0
  buffer_load_dwordx4 v4, s[24:27], s50 offen lds
  s_add_u32 m0, s45, 77824
  s_mov_b32 exec_hi, 0xffff
  buffer_load_dwordx4 v5, s[24:27], s50 offen lds
  s_mov_b64 exec, -1
  ds_read_b64_tr_b16 v[24:25], v6 offset:30720
  ds_read_b64_tr_b16 v[26:27], v6 offset:32512
  s_waitcnt lgkmcnt(10)
  v_mfma_f32_32x32x16_bf16 v[56:71], v[28:31], v[132:135], v[56:71]
  ds_read_b64_tr_b16 v[28:29], v6 offset:30784
  ds_read_b64_tr_b16 v[30:31], v6 offset:32576
  s_waitcnt lgkmcnt(10)
  v_mfma_f32_32x32x16_bf16 v[72:87], v[32:35], v[132:135], v[72:87]
  ds_read_b64_tr_b16 v[32:33], v6 offset:30848
  ds_read_b64_tr_b16 v[34:35], v6 offset:32640
  s_waitcnt lgkmcnt(10)
  v_mfma_f32_32x32x16_bf16 v[88:103], v[36:39], v[132:135], v[88:103]
  v_mov_b32 v146, 1
  s_and_b32 s46, s2, 1
  s_lshl_b32 s46, s46, 7
  v_mov_b32 v147, s46
  v_lshlrev_b32 v19, 7, v1
  v_and_b32 v19, 128, v19
  s_cmp_lg_u32 s43, 0
  s_cbranch_scc1 L_ffn0_nosig
  s_mov_b64 exec, 1
  buffer_atomic_add v146, v147, s[36:39], 0 offen sc1
  s_mov_b64 exec, -1
L_ffn0_nosig:
  ds_read_b64_tr_b16 v[36:37], v6 offset:30912
  ds_read_b64_tr_b16 v[38:39], v6 offset:32704
  s_waitcnt lgkmcnt(6)
  v_mfma_f32_32x32x16_bf16 v[40:55], v[24:27], v[104:107], v[40:55]
  ds_read_b64_tr_b16 v[24:25], v6 offset:37888
  ds_read_b64_tr_b16 v[26:27], v6 offset:39680
  s_waitcnt lgkmcnt(6)
  v_mfma_f32_32x32x16_bf16 v[56:71], v[28:31], v[104:107], v[56:71]
  s_mov_b32 s50, 1327104
  s_add_u32 m0, s45, 0
  s_nop 0
  buffer_load_dwordx4 v4, s[24:27], s50 offen lds
  s_add_u32 m0, s45, 1024
  s_mov_b32 exec_hi, 0xffff
  buffer_load_dwordx4 v5, s[24:27], s50 offen lds
  s_mov_b64 exec, -1
  s_add_u32 s50, s49, 768
  s_add_u32 m0, s47, 92160
  s_nop 0
  buffer_load_dwordx4 v8, s[20:23], s50 offen lds
  s_add_u32 m0, s47, 93184
  s_nop 0
  buffer_load_dwordx4 v9, s[20:23], s50 offen lds
  ds_read_b64_tr_b16 v[28:29], v6 offset:37952
  ds_read_b64_tr_b16 v[30:31], v6 offset:39744
  s_waitcnt lgkmcnt(6)
  v_mfma_f32_32x32x16_bf16 v[72:87], v[32:35], v[104:107], v[72:87]
  ds_read_b64_tr_b16 v[32:33], v6 offset:38016
  ds_read_b64_tr_b16 v[34:35], v6 offset:39808
  s_waitcnt lgkmcnt(6)
  v_mfma_f32_32x32x16_bf16 v[88:103], v[36:39], v[104:107], v[88:103]
  ds_read_b64_tr_b16 v[36:37], v6 offset:38080
  ds_read_b64_tr_b16 v[38:39], v6 offset:39872
  s_waitcnt lgkmcnt(6)
  v_mfma_f32_32x32x16_bf16 v[40:55], v[24:27], v[108:111], v[40:55]
  ds_read_b64_tr_b16 v[24:25], v7 offset:0
  ds_read_b64_tr_b16 v[26:27], v7 offset:1792
  s_waitcnt lgkmcnt(6)
  v_mfma_f32_32x32x16_bf16 v[56:71], v[28:31], v[108:111], v[56:71]
  ds_read_b64_tr_b16 v[28:29], v7 offset:64
  ds_read_b64_tr_b16 v[30:31], v7 offset:1856
  s_waitcnt lgkmcnt(6)
  v_mfma_f32_32x32x16_bf16 v[72:87], v[32:35], v[108:111], v[72:87]
  ds_read_b64_tr_b16 v[32:33], v7 offset:128
  ds_read_b64_tr_b16 v[34:35], v7 offset:1920
  s_waitcnt lgkmcnt(6)
  v_mfma_f32_32x32x16_bf16 v[88:103], v[36:39], v[108:111], v[88:103]
  ds_read_b64_tr_b16 v[36:37], v7 offset:192
  ds_read_b64_tr_b16 v[38:39], v7 offset:1984
  s_waitcnt lgkmcnt(6)
  v_mfma_f32_32x32x16_bf16 v[40:55], v[24:27], v[112:115], v[40:55]
  ds_read_b64_tr_b16 v[24:25], v7 offset:7168
  ds_read_b64_tr_b16 v[26:27], v7 offset:8960
  s_waitcnt lgkmcnt(6)
  v_mfma_f32_32x32x16_bf16 v[56:71], v[28:31], v[112:115], v[56:71]
  ds_read_b64_tr_b16 v[28:29], v7 offset:7232
  ds_read_b64_tr_b16 v[30:31], v7 offset:9024
  s_waitcnt lgkmcnt(6)
  v_mfma_f32_32x32x16_bf16 v[72:87], v[32:35], v[112:115], v[72:87]
  ds_read_b64_tr_b16 v[32:33], v7 offset:7296
  ds_read_b64_tr_b16 v[34:35], v7 offset:9088
  s_waitcnt lgkmcnt(6)
  v_mfma_f32_32x32x16_bf16 v[88:103], v[36:39], v[112:115], v[88:103]
  ds_read_b64_tr_b16 v[36:37], v7 offset:7360
  ds_read_b64_tr_b16 v[38:39], v7 offset:9152
  s_waitcnt lgkmcnt(6)
  v_mfma_f32_32x32x16_bf16 v[40:55], v[24:27], v[116:119], v[40:55]
  s_waitcnt vmcnt(4)
  s_barrier
  ds_read_b128 v[120:123], v10 offset:32768
  ds_read_b128 v[124:127], v11 offset:32768
  ds_read_b128 v[128:131], v12 offset:32768
  ds_read_b128 v[132:135], v13 offset:32768
  s_mov_b32 s50, 1437696
  s_add_u32 m0, s45, 15360
  s_nop 0
  buffer_load_dwordx4 v4, s[24:27], s50 offen lds
  s_add_u32 m0, s45, 16384
  s_mov_b32 exec_hi, 0xffff
  buffer_load_dwordx4 v5, s[24:27], s50 offen lds
  s_mov_b64 exec, -1
  ds_read_b64_tr_b16 v[24:25], v7 offset:15360
  ds_read_b64_tr_b16 v[26:27], v7 offset:17152
  s_waitcnt lgkmcnt(10)
  v_mfma_f32_32x32x16_bf16 v[56:71], v[28:31], v[116:119], v[56:71]
  ds_read_b64_tr_b16 v[28:29], v7 offset:15424
  ds_read_b64_tr_b16 v[30:31], v7 offset:17216
  s_waitcnt lgkmcnt(10)
  v_mfma_f32_32x32x16_bf16 v[72:87], v[32:35], v[116:119], v[72:87]
  ds_read_b64_tr_b16 v[32:33], v7 offset:15488
  ds_read_b64_tr_b16 v[34:35], v7 offset:17280
  s_waitcnt lgkmcnt(10)
  v_mfma_f32_32x32x16_bf16 v[88:103], v[36:39], v[116:119], v[88:103]
  ds_read_b64_tr_b16 v[36:37], v7 offset:15552
  ds_read_b64_tr_b16 v[38:39], v7 offset:17344
  s_waitcnt lgkmcnt(6)
  v_mfma_f32_32x32x16_bf16 v[40:55], v[24:27], v[120:123], v[40:55]
  ds_read_b64_tr_b16 v[24:25], v7 offset:22528
  ds_read_b64_tr_b16 v[26:27], v7 offset:24320
  s_waitcnt lgkmcnt(6)
  v_mfma_f32_32x32x16_bf16 v[56:71], v[28:31], v[120:123], v[56:71]
  s_mov_b32 s50, 1548288
  s_add_u32 m0, s45, 30720
  s_nop 0
  buffer_load_dwordx4 v4, s[24:27], s50 offen lds
  s_add_u32 m0, s45, 31744
  s_mov_b32 exec_hi, 0xffff
  buffer_load_dwordx4 v5, s[24:27], s50 offen lds
  s_mov_b64 exec, -1
  s_add_u32 s50, s49, 896
  s_add_u32 m0, s47, 108544
  s_nop 0
  buffer_load_dwordx4 v8, s[20:23], s50 offen lds
  s_add_u32 m0, s47, 109568
  s_nop 0
  buffer_load_dwordx4 v9, s[20:23], s50 offen lds
  ds_read_b64_tr_b16 v[28:29], v7 offset:22592
  ds_read_b64_tr_b16 v[30:31], v7 offset:24384
  s_waitcnt lgkmcnt(6)
  v_mfma_f32_32x32x16_bf16 v[72:87], v[32:35], v[120:123], v[72:87]
  ds_read_b64_tr_b16 v[32:33], v7 offset:22656
  ds_read_b64_tr_b16 v[34:35], v7 offset:24448
  s_waitcnt lgkmcnt(6)
  v_mfma_f32_32x32x16_bf16 v[88:103], v[36:39], v[120:123], v[88:103]
  ds_read_b64_tr_b16 v[36:37], v7 offset:22720
  ds_read_b64_tr_b16 v[38:39], v7 offset:24512
  s_waitcnt lgkmcnt(6)
  v_mfma_f32_32x32x16_bf16 v[40:55], v[24:27], v[124:127], v[40:55]
  ds_read_b64_tr_b16 v[24:25], v7 offset:30720
  ds_read_b64_tr_b16 v[26:27], v7 offset:32512
  s_waitcnt lgkmcnt(6)
  v_mfma_f32_32x32x16_bf16 v[56:71], v[28:31], v[124:127], v[56:71]
  ds_read_b64_tr_b16 v[28:29], v7 offset:30784
  ds_read_b64_tr_b16 v[30:31], v7 offset:32576
  s_waitcnt lgkmcnt(6)
  v_mfma_f32_32x32x16_bf16 v[72:87], v[32:35], v[124:127], v[72:87]
  ds_read_b64_tr_b16 v[32:33], v7 offset:30848
  ds_read_b64_tr_b16 v[34:35], v7 offset:32640
  s_waitcnt lgkmcnt(6)
  v_mfma_f32_32x32x16_bf16 v[88:103], v[36:39], v[124:127], v[88:103]
  ds_read_b64_tr_b16 v[36:37], v7 offset:30912
  ds_read_b64_tr_b16 v[38:39], v7 offset:32704
  s_waitcnt lgkmcnt(6)
  v_mfma_f32_32x32x16_bf16 v[40:55], v[24:27], v[128:131], v[40:55]
  ds_read_b64_tr_b16 v[24:25], v7 offset:37888
  ds_read_b64_tr_b16 v[26:27], v7 offset:39680
  s_waitcnt lgkmcnt(6)
  v_mfma_f32_32x32x16_bf16 v[56:71], v[28:31], v[128:131], v[56:71]
  ds_read_b64_tr_b16 v[28:29], v7 offset:37952
  ds_read_b64_tr_b16 v[30:31], v7 offset:39744
  s_waitcnt lgkmcnt(6)
  v_mfma_f32_32x32x16_bf16 v[72:87], v[32:35], v[128:131], v[72:87]
  ds_read_b64_tr_b16 v[32:33], v7 offset:38016
  ds_read_b64_tr_b16 v[34:35], v7 offset:39808
  s_waitcnt lgkmcnt(6)
  v_mfma_f32_32x32x16_bf16 v[88:103], v[36:39], v[128:131], v[88:103]
  ds_read_b64_tr_b16 v[36:37], v7 offset:38080
  ds_read_b64_tr_b16 v[38:39], v7 offset:39872
  s_waitcnt lgkmcnt(6)
  v_mfma_f32_32x32x16_bf16 v[40:55], v[24:27], v[132:135], v[40:55]
  s_waitcnt vmcnt(4)
  s_barrier
  ds_read_b128 v[104:107], v10 offset:0
  ds_read_b128 v[108:111], v11 offset:0
  ds_read_b128 v[112:115], v12 offset:0
  ds_read_b128 v[116:119], v13 offset:0
  s_mov_b32 s50, 1658880
  s_add_u32 m0, s45, 46080
  s_nop 0
  buffer_load_dwordx4 v4, s[24:27], s50 offen lds
  s_add_u32 m0, s45, 47104
  s_mov_b32 exec_hi, 0xffff
  buffer_load_dwordx4 v5, s[24:27], s50 offen lds
  s_mov_b64 exec, -1
  ds_read_b64_tr_b16 v[24:25], v6 offset:0
  ds_read_b64_tr_b16 v[26:27], v6 offset:1792
  s_waitcnt lgkmcnt(10)
  v_mfma_f32_32x32x16_bf16 v[56:71], v[28:31], v[132:135], v[56:71]
  ds_read_b64_tr_b16 v[28:29], v6 offset:64
  ds_read_b64_tr_b16 v[30:31], v6 offset:1856
  s_waitcnt lgkmcnt(10)
  v_mfma_f32_32x32x16_bf16 v[72:87], v[32:35], v[132:135], v[72:87]
  ds_read_b64_tr_b16 v[32:33], v6 offset:128
  ds_read_b64_tr_b16 v[34:35], v6 offset:1920
  s_waitcnt lgkmcnt(10)
  v_mfma_f32_32x32x16_bf16 v[88:103], v[36:39], v[132:135], v[88:103]
  ds_read_b64_tr_b16 v[36:37], v6 offset:192
  ds_read_b64_tr_b16 v[38:39], v6 offset:1984
  s_waitcnt lgkmcnt(6)
  v_mfma_f32_32x32x16_bf16 v[40:55], v[24:27], v[104:107], v[40:55]
  ds_read_b64_tr_b16 v[24:25], v6 offset:7168
  ds_read_b64_tr_b16 v[26:27], v6 offset:8960
  s_waitcnt lgkmcnt(6)
  v_mfma_f32_32x32x16_bf16 v[56:71], v[28:31], v[104:107], v[56:71]
  s_mov_b32 s50, 1769472
  s_add_u32 m0, s45, 61440
  s_nop 0
  buffer_load_dwordx4 v4, s[24:27], s50 offen lds
  s_add_u32 m0, s45, 62464
  s_mov_b32 exec_hi, 0xffff
  buffer_load_dwordx4 v5, s[24:27], s50 offen lds
  s_mov_b64 exec, -1
  s_add_u32 s50, s49, 1024
  s_add_u32 m0, s47, 124928
  s_nop 0
  buffer_load_dwordx4 v8, s[20:23], s50 offen lds
  s_add_u32 m0, s47, 125952
  s_nop 0
  buffer_load_dwordx4 v9, s[20:23], s50 offen lds
  ds_read_b64_tr_b16 v[28:29], v6 offset:7232
  ds_read_b64_tr_b16 v[30:31], v6 offset:9024
  s_waitcnt lgkmcnt(6)
  v_mfma_f32_32x32x16_bf16 v[72:87], v[32:35], v[104:107], v[72:87]
  ds_read_b64_tr_b16 v[32:33], v6 offset:7296
  ds_read_b64_tr_b16 v[34:35], v6 offset:9088
  s_waitcnt lgkmcnt(6)
  v_mfma_f32_32x32x16_bf16 v[88:103], v[36:39], v[104:107], v[88:103]
  ds_read_b64_tr_b16 v[36:37], v6 offset:7360
  ds_read_b64_tr_b16 v[38:39], v6 offset:9152
  s_waitcnt lgkmcnt(6)
  v_mfma_f32_32x32x16_bf16 v[40:55], v[24:27], v[108:111], v[40:55]
  ds_read_b64_tr_b16 v[24:25], v6 offset:15360
  ds_read_b64_tr_b16 v[26:27], v6 offset:17152
  s_waitcnt lgkmcnt(6)
  v_mfma_f32_32x32x16_bf16 v[56:71], v[28:31], v[108:111], v[56:71]
  ds_read_b64_tr_b16 v[28:29], v6 offset:15424
  ds_read_b64_tr_b16 v[30:31], v6 offset:17216
  s_waitcnt lgkmcnt(6)
  v_mfma_f32_32x32x16_bf16 v[72:87], v[32:35], v[108:111], v[72:87]
  ds_read_b64_tr_b16 v[32:33], v6 offset:15488
  ds_read_b64_tr_b16 v[34:35], v6 offset:17280
  s_waitcnt lgkmcnt(6)
  v_mfma_f32_32x32x16_bf16 v[88:103], v[36:39], v[108:111], v[88:103]
  ds_read_b64_tr_b16 v[36:37], v6 offset:15552
  ds_read_b64_tr_b16 v[38:39], v6 offset:17344
  s_waitcnt lgkmcnt(6)
  v_mfma_f32_32x32x16_bf16 v[40:55], v[24:27], v[112:115], v[40:55]
  ds_read_b64_tr_b16 v[24:25], v6 offset:22528
  ds_read_b64_tr_b16 v[26:27], v6 offset:24320
  s_waitcnt lgkmcnt(6)
  v_mfma_f32_32x32x16_bf16 v[56:71], v[28:31], v[112:115], v[56:71]
  ds_read_b64_tr_b16 v[28:29], v6 offset:22592
  ds_read_b64_tr_b16 v[30:31], v6 offset:24384
  s_waitcnt lgkmcnt(6)
  v_mfma_f32_32x32x16_bf16 v[72:87], v[32:35], v[112:115], v[72:87]
  ds_read_b64_tr_b16 v[32:33], v6 offset:22656
  ds_read_b64_tr_b16 v[34:35], v6 offset:24448
  s_waitcnt lgkmcnt(6)
  v_mfma_f32_32x32x16_bf16 v[88:103], v[36:39], v[112:115], v[88:103]
  ds_read_b64_tr_b16 v[36:37], v6 offset:22720
  ds_read_b64_tr_b16 v[38:39], v6 offset:24512
  s_waitcnt lgkmcnt(6)
  v_mfma_f32_32x32x16_bf16 v[40:55], v[24:27], v[116:119], v[40:55]
  s_waitcnt vmcnt(4)
  s_barrier
  ds_read_b128 v[120:123], v10 offset:16384
  ds_read_b128 v[124:127], v11 offset:16384
  ds_read_b128 v[128:131], v12 offset:16384
  ds_read_b128 v[132:135], v13 offset:16384
  s_mov_b32 s50, 1880064
  s_add_u32 m0, s45, 76800
  s_nop 0
  buffer_load_dwordx4 v4, s[24:27], s50 offen lds
  s_add_u32 m0, s45, 77824
  s_mov_b32 exec_hi, 0xffff
  buffer_load_dwordx4 v5, s[24:27], s50 offen lds
  s_mov_b64 exec, -1
  ds_read_b64_tr_b16 v[24:25], v6 offset:30720
  ds_read_b64_tr_b16 v[26:27], v6 offset:32512
  s_waitcnt lgkmcnt(10)
  v_mfma_f32_32x32x16_bf16 v[56:71], v[28:31], v[116:119], v[56:71]
  ds_read_b64_tr_b16 v[28:29], v6 offset:30784
  ds_read_b64_tr_b16 v[30:31], v6 offset:32576
  s_waitcnt lgkmcnt(10)
  v_mfma_f32_32x32x16_bf16 v[72:87], v[32:35], v[116:119], v[72:87]
  ds_read_b64_tr_b16 v[32:33], v6 offset:30848
  ds_read_b64_tr_b16 v[34:35], v6 offset:32640
  s_waitcnt lgkmcnt(10)
  v_mfma_f32_32x32x16_bf16 v[88:103], v[36:39], v[116:119], v[88:103]
  ds_read_b64_tr_b16 v[36:37], v6 offset:30912
  ds_read_b64_tr_b16 v[38:39], v6 offset:32704
  s_waitcnt lgkmcnt(6)
  v_mfma_f32_32x32x16_bf16 v[40:55], v[24:27], v[120:123], v[40:55]
  ds_read_b64_tr_b16 v[24:25], v6 offset:37888
  ds_read_b64_tr_b16 v[26:27], v6 offset:39680
  s_waitcnt lgkmcnt(6)
  v_mfma_f32_32x32x16_bf16 v[56:71], v[28:31], v[120:123], v[56:71]
  s_mov_b32 s50, 1990656
  s_add_u32 m0, s45, 0
  s_nop 0
  buffer_load_dwordx4 v4, s[24:27], s50 offen lds
  s_add_u32 m0, s45, 1024
  s_mov_b32 exec_hi, 0xffff
  buffer_load_dwordx4 v5, s[24:27], s50 offen lds
  s_mov_b64 exec, -1
  s_add_u32 s50, s49, 1152
  s_add_u32 m0, s47, 92160
  s_nop 0
  buffer_load_dwordx4 v8, s[20:23], s50 offen lds
  s_add_u32 m0, s47, 93184
  s_nop 0
  buffer_load_dwordx4 v9, s[20:23], s50 offen lds
  ds_read_b64_tr_b16 v[28:29], v6 offset:37952
  ds_read_b64_tr_b16 v[30:31], v6 offset:39744
  s_waitcnt lgkmcnt(6)
  v_mfma_f32_32x32x16_bf16 v[72:87], v[32:35], v[120:123], v[72:87]
  ds_read_b64_tr_b16 v[32:33], v6 offset:38016
  ds_read_b64_tr_b16 v[34:35], v6 offset:39808
  s_waitcnt lgkmcnt(6)
  v_mfma_f32_32x32x16_bf16 v[88:103], v[36:39], v[120:123], v[88:103]
  ds_read_b64_tr_b16 v[36:37], v6 offset:38080
  ds_read_b64_tr_b16 v[38:39], v6 offset:39872
  s_waitcnt lgkmcnt(6)
  v_mfma_f32_32x32x16_bf16 v[40:55], v[24:27], v[124:127], v[40:55]
  ds_read_b64_tr_b16 v[24:25], v7 offset:0
  ds_read_b64_tr_b16 v[26:27], v7 offset:1792
  s_waitcnt lgkmcnt(6)
  v_mfma_f32_32x32x16_bf16 v[56:71], v[28:31], v[124:127], v[56:71]
  ds_read_b64_tr_b16 v[28:29], v7 offset:64
  ds_read_b64_tr_b16 v[30:31], v7 offset:1856
  s_waitcnt lgkmcnt(6)
  v_mfma_f32_32x32x16_bf16 v[72:87], v[32:35], v[124:127], v[72:87]
  ds_read_b64_tr_b16 v[32:33], v7 offset:128
  ds_read_b64_tr_b16 v[34:35], v7 offset:1920
  s_waitcnt lgkmcnt(6)
  v_mfma_f32_32x32x16_bf16 v[88:103], v[36:39], v[124:127], v[88:103]
  ds_read_b64_tr_b16 v[36:37], v7 offset:192
  ds_read_b64_tr_b16 v[38:39], v7 offset:1984
  s_waitcnt lgkmcnt(6)
  v_mfma_f32_32x32x16_bf16 v[40:55], v[24:27], v[128:131], v[40:55]
  ds_read_b64_tr_b16 v[24:25], v7 offset:7168
  ds_read_b64_tr_b16 v[26:27], v7 offset:8960
  s_waitcnt lgkmcnt(6)
  v_mfma_f32_32x32x16_bf16 v[56:71], v[28:31], v[128:131], v[56:71]
  ds_read_b64_tr_b16 v[28:29], v7 offset:7232
  ds_read_b64_tr_b16 v[30:31], v7 offset:9024
  s_waitcnt lgkmcnt(6)
  v_mfma_f32_32x32x16_bf16 v[72:87], v[32:35], v[128:131], v[72:87]
  ds_read_b64_tr_b16 v[32:33], v7 offset:7296
  ds_read_b64_tr_b16 v[34:35], v7 offset:9088
  s_waitcnt lgkmcnt(6)
  v_mfma_f32_32x32x16_bf16 v[88:103], v[36:39], v[128:131], v[88:103]
  ds_read_b64_tr_b16 v[36:37], v7 offset:7360
  ds_read_b64_tr_b16 v[38:39], v7 offset:9152
  s_waitcnt lgkmcnt(6)
  v_mfma_f32_32x32x16_bf16 v[40:55], v[24:27], v[132:135], v[40:55]
  s_waitcnt vmcnt(4)
  s_barrier
  ds_read_b128 v[104:107], v10 offset:32768
  ds_read_b128 v[108:111], v11 offset:32768
  ds_read_b128 v[112:115], v12 offset:32768
  ds_read_b128 v[116:119], v13 offset:32768
  s_mov_b32 s50, 2101248
  s_add_u32 m0, s45, 15360
  s_nop 0
  buffer_load_dwordx4 v4, s[24:27], s50 offen lds
  s_add_u32 m0, s45, 16384
  s_mov_b32 exec_hi, 0xffff
  buffer_load_dwordx4 v5, s[24:27], s50 offen lds
  s_mov_b64 exec, -1
  ds_read_b64_tr_b16 v[24:25], v7 offset:15360
  ds_read_b64_tr_b16 v[26:27], v7 offset:17152
  s_waitcnt lgkmcnt(10)
  v_mfma_f32_32x32x16_bf16 v[56:71], v[28:31], v[132:135], v[56:71]
  ds_read_b64_tr_b16 v[28:29], v7 offset:15424
  ds_read_b64_tr_b16 v[30:31], v7 offset:17216
  s_waitcnt lgkmcnt(10)
  v_mfma_f32_32x32x16_bf16 v[72:87], v[32:35], v[132:135], v[72:87]
  ds_read_b64_tr_b16 v[32:33], v7 offset:15488
  ds_read_b64_tr_b16 v[34:35], v7 offset:17280
  s_waitcnt lgkmcnt(10)
  v_mfma_f32_32x32x16_bf16 v[88:103], v[36:39], v[132:135], v[88:103]
  s_mul_i32 s46, s43, 0x1000
  buffer_load_dword v18, v19, s[36:39], s46 offen sc1
  ds_read_b64_tr_b16 v[36:37], v7 offset:15552
  ds_read_b64_tr_b16 v[38:39], v7 offset:17344
  s_waitcnt lgkmcnt(6)
  v_mfma_f32_32x32x16_bf16 v[40:55], v[24:27], v[104:107], v[40:55]
  ds_read_b64_tr_b16 v[24:25], v7 offset:22528
  ds_read_b64_tr_b16 v[26:27], v7 offset:24320
  s_waitcnt lgkmcnt(6)
  v_mfma_f32_32x32x16_bf16 v[56:71], v[28:31], v[104:107], v[56:71]
  ds_read_b64_tr_b16 v[28:29], v7 offset:22592
  ds_read_b64_tr_b16 v[30:31], v7 offset:24384
  s_waitcnt lgkmcnt(6)
  v_mfma_f32_32x32x16_bf16 v[72:87], v[32:35], v[104:107], v[72:87]
  ds_read_b64_tr_b16 v[32:33], v7 offset:22656
  ds_read_b64_tr_b16 v[34:35], v7 offset:24448
  s_waitcnt lgkmcnt(6)
  v_mfma_f32_32x32x16_bf16 v[88:103], v[36:39], v[104:107], v[88:103]
  ds_read_b64_tr_b16 v[36:37], v7 offset:22720
  ds_read_b64_tr_b16 v[38:39], v7 offset:24512
  s_waitcnt lgkmcnt(6)
  v_mfma_f32_32x32x16_bf16 v[40:55], v[24:27], v[108:111], v[40:55]
  ds_read_b64_tr_b16 v[24:25], v7 offset:30720
  ds_read_b64_tr_b16 v[26:27], v7 offset:32512
  s_waitcnt lgkmcnt(6)
  v_mfma_f32_32x32x16_bf16 v[56:71], v[28:31], v[108:111], v[56:71]
  ds_read_b64_tr_b16 v[28:29], v7 offset:30784
  ds_read_b64_tr_b16 v[30:31], v7 offset:32576
  s_waitcnt lgkmcnt(6)
  v_mfma_f32_32x32x16_bf16 v[72:87], v[32:35], v[108:111], v[72:87]
  ds_read_b64_tr_b16 v[32:33], v7 offset:30848
  ds_read_b64_tr_b16 v[34:35], v7 offset:32640
  s_waitcnt lgkmcnt(6)
  v_mfma_f32_32x32x16_bf16 v[88:103], v[36:39], v[108:111], v[88:103]
  s_waitcnt vmcnt(0)
  s_cmp_lg_u32 s43, 0
  s_cbranch_scc1 L_ffn0_pdone
L_ffn0_poll:
  v_readlane_b32 s46, v18, 0
  v_readlane_b32 s54, v18, 1
  s_nop 0
  s_min_u32 s46, s46, s54
  s_cmp_ge_u32 s46, 128
  s_cbranch_scc1 L_ffn0_pdone
  s_sleep 2
  buffer_load_dword v18, v19, s[36:39], 0 offen sc1
  s_waitcnt vmcnt(0)
  s_branch L_ffn0_poll
L_ffn0_pdone:
  s_nop 3
  ds_read_b64_tr_b16 v[36:37], v7 offset:30912
  ds_read_b64_tr_b16 v[38:39], v7 offset:32704
  s_waitcnt lgkmcnt(6)
  v_mfma_f32_32x32x16_bf16 v[40:55], v[24:27], v[112:115], v[40:55]
  ds_read_b64_tr_b16 v[24:25], v7 offset:37888
  ds_read_b64_tr_b16 v[26:27], v7 offset:39680
  s_waitcnt lgkmcnt(6)
  v_mfma_f32_32x32x16_bf16 v[56:71], v[28:31], v[112:115], v[56:71]
  ds_read_b64_tr_b16 v[28:29], v7 offset:37952
  ds_read_b64_tr_b16 v[30:31], v7 offset:39744
  s_waitcnt lgkmcnt(6)
  v_mfma_f32_32x32x16_bf16 v[72:87], v[32:35], v[112:115], v[72:87]
  ds_read_b64_tr_b16 v[32:33], v7 offset:38016
  ds_read_b64_tr_b16 v[34:35], v7 offset:39808
  s_waitcnt lgkmcnt(6)
  v_mfma_f32_32x32x16_bf16 v[88:103], v[36:39], v[112:115], v[88:103]
  ds_read_b64_tr_b16 v[36:37], v7 offset:38080
  ds_read_b64_tr_b16 v[38:39], v7 offset:39872
  s_waitcnt lgkmcnt(6)
  v_mfma_f32_32x32x16_bf16 v[40:55], v[24:27], v[116:119], v[40:55]
  s_barrier
  ds_read_b128 v[120:123], v10 offset:0
  ds_read_b128 v[124:127], v11 offset:0
  ds_read_b128 v[128:131], v12 offset:0
  ds_read_b128 v[132:135], v13 offset:0
  ds_read_b64_tr_b16 v[24:25], v6 offset:0
  ds_read_b64_tr_b16 v[26:27], v6 offset:1792
  s_waitcnt lgkmcnt(10)
  v_mfma_f32_32x32x16_bf16 v[56:71], v[28:31], v[116:119], v[56:71]
  ds_read_b64_tr_b16 v[28:29], v6 offset:64
  ds_read_b64_tr_b16 v[30:31], v6 offset:1856
  s_waitcnt lgkmcnt(10)
  v_mfma_f32_32x32x16_bf16 v[72:87], v[32:35], v[116:119], v[72:87]
  ds_read_b64_tr_b16 v[32:33], v6 offset:128
  ds_read_b64_tr_b16 v[34:35], v6 offset:1920
  s_waitcnt lgkmcnt(10)
  v_mfma_f32_32x32x16_bf16 v[88:103], v[36:39], v[116:119], v[88:103]
  s_lshl_b32 s46, s40, 10
  s_lshl_b32 s54, s43, 8
  s_add_u32 s46, s46, s54
  s_add_u32 s46, s46, 12644352
  v_lshlrev_b32 v22, 3, v16
  buffer_load_dwordx2 v[14:15], v22, s[28:31], s46 offen sc1
  s_lshl_b32 s46, s41, 14
  s_lshl_b32 s54, s43, 8
  s_add_u32 s46, s46, s54
  s_add_u32 s46, s46, 12677120
  v_lshlrev_b32 v23, 2, v1
  buffer_load_dword v136, v23, s[28:31], s46 offen offset:0 sc1
  buffer_load_dword v137, v23, s[28:31], s46 offen offset:1024 sc1
  buffer_load_dword v138, v23, s[28:31], s46 offen offset:2048 sc1
  buffer_load_dword v139, v23, s[28:31], s46 offen offset:3072 sc1
  s_add_u32 s46, s46, 4096
  buffer_load_dword v140, v23, s[28:31], s46 offen offset:0 sc1
  buffer_load_dword v141, v23, s[28:31], s46 offen offset:1024 sc1
  buffer_load_dword v142, v23, s[28:31], s46 offen offset:2048 sc1
  buffer_load_dword v143, v23, s[28:31], s46 offen offset:3072 sc1
  s_add_u32 s46, s46, 4096
  buffer_load_dword v144, v23, s[28:31], s46 offen offset:0 sc1
  buffer_load_dword v145, v23, s[28:31], s46 offen offset:1024 sc1
  buffer_load_dword v146, v23, s[28:31], s46 offen offset:2048 sc1
  buffer_load_dword v147, v23, s[28:31], s46 offen offset:3072 sc1
  s_add_u32 s46, s46, 4096
  buffer_load_dword v148, v23, s[28:31], s46 offen offset:0 sc1
  buffer_load_dword v149, v23, s[28:31], s46 offen offset:1024 sc1
  buffer_load_dword v150, v23, s[28:31], s46 offen offset:2048 sc1
  buffer_load_dword v151, v23, s[28:31], s46 offen offset:3072 sc1
  ds_read_b64_tr_b16 v[36:37], v6 offset:192
  ds_read_b64_tr_b16 v[38:39], v6 offset:1984
  s_waitcnt lgkmcnt(6)
  v_mfma_f32_32x32x16_bf16 v[40:55], v[24:27], v[120:123], v[40:55]
  ds_read_b64_tr_b16 v[24:25], v6 offset:7168
  ds_read_b64_tr_b16 v[26:27], v6 offset:8960
  s_waitcnt lgkmcnt(6)
  v_mfma_f32_32x32x16_bf16 v[56:71], v[28:31], v[120:123], v[56:71]
  ds_read_b64_tr_b16 v[28:29], v6 offset:7232
  ds_read_b64_tr_b16 v[30:31], v6 offset:9024
  s_waitcnt lgkmcnt(6)
  v_mfma_f32_32x32x16_bf16 v[72:87], v[32:35], v[120:123], v[72:87]
  ds_read_b64_tr_b16 v[32:33], v6 offset:7296
  ds_read_b64_tr_b16 v[34:35], v6 offset:9088
  s_waitcnt lgkmcnt(6)
  v_mfma_f32_32x32x16_bf16 v[88:103], v[36:39], v[120:123], v[88:103]
  ds_read_b64_tr_b16 v[36:37], v6 offset:7360
  ds_read_b64_tr_b16 v[38:39], v6 offset:9152
  s_waitcnt lgkmcnt(6)
  v_mfma_f32_32x32x16_bf16 v[40:55], v[24:27], v[124:127], v[40:55]
  ds_read_b64_tr_b16 v[24:25], v6 offset:15360
  ds_read_b64_tr_b16 v[26:27], v6 offset:17152
  s_waitcnt lgkmcnt(6)
  v_mfma_f32_32x32x16_bf16 v[56:71], v[28:31], v[124:127], v[56:71]
  ds_read_b64_tr_b16 v[28:29], v6 offset:15424
  ds_read_b64_tr_b16 v[30:31], v6 offset:17216
  s_waitcnt lgkmcnt(6)
  v_mfma_f32_32x32x16_bf16 v[72:87], v[32:35], v[124:127], v[72:87]
  ds_read_b64_tr_b16 v[32:33], v6 offset:15488
  ds_read_b64_tr_b16 v[34:35], v6 offset:17280
  s_waitcnt lgkmcnt(6)
  v_mfma_f32_32x32x16_bf16 v[88:103], v[36:39], v[124:127], v[88:103]
  ds_read_b64_tr_b16 v[36:37], v6 offset:15552
  ds_read_b64_tr_b16 v[38:39], v6 offset:17344
  s_waitcnt lgkmcnt(6)
  v_mfma_f32_32x32x16_bf16 v[40:55], v[24:27], v[128:131], v[40:55]
  ds_read_b64_tr_b16 v[24:25], v6 offset:22528
  ds_read_b64_tr_b16 v[26:27], v6 offset:24320
  s_waitcnt lgkmcnt(6)
  v_mfma_f32_32x32x16_bf16 v[56:71], v[28:31], v[128:131], v[56:71]
  ds_read_b64_tr_b16 v[28:29], v6 offset:22592
  ds_read_b64_tr_b16 v[30:31], v6 offset:24384
  s_waitcnt lgkmcnt(6)
  v_mfma_f32_32x32x16_bf16 v[72:87], v[32:35], v[128:131], v[72:87]
  ds_read_b64_tr_b16 v[32:33], v6 offset:22656
  ds_read_b64_tr_b16 v[34:35], v6 offset:24448
  s_waitcnt lgkmcnt(6)
  v_mfma_f32_32x32x16_bf16 v[88:103], v[36:39], v[128:131], v[88:103]
  ds_read_b64_tr_b16 v[36:37], v6 offset:22720
  ds_read_b64_tr_b16 v[38:39], v6 offset:24512
  s_waitcnt lgkmcnt(6)
  v_mfma_f32_32x32x16_bf16 v[40:55], v[24:27], v[132:135], v[40:55]
  s_waitcnt lgkmcnt(4)
  v_mfma_f32_32x32x16_bf16 v[56:71], v[28:31], v[132:135], v[56:71]
  s_waitcnt lgkmcnt(2)
  v_mfma_f32_32x32x16_bf16 v[72:87], v[32:35], v[132:135], v[72:87]
  s_waitcnt lgkmcnt(0)
  v_mfma_f32_32x32x16_bf16 v[88:103], v[36:39], v[132:135], v[88:103]
  s_waitcnt vmcnt(0)
  v_add_f32 v136, v136, v144
  v_add_f32 v137, v137, v145
  v_add_f32 v138, v138, v146
  v_add_f32 v139, v139, v147
  v_add_f32 v140, v140, v148
  v_add_f32 v141, v141, v149
  v_add_f32 v142, v142, v150
  v_add_f32 v143, v143, v151
  v_add_f32 v136, v136, v140
  v_add_f32 v137, v137, v141
  v_add_f32 v138, v138, v142
  v_add_f32 v139, v139, v143
  v_add_f32 v136, v136, v138
  v_add_f32 v137, v137, v139
  v_add_f32 v136, v136, v137
  s_lshl_b32 s46, s43, 8
  s_add_u32 s46, s46, 141312
  v_add_u32 v23, s46, v23
  ds_write_b32 v23, v136
  s_waitcnt lgkmcnt(0)
  s_barrier
  v_lshlrev_b32 v253, 4, v17
  v_add_u32 v253, 141312, v253
  v_mov_b32 v248, 2.0
  v_mov_b32 v249, s48
  v_mov_b32 v250, -2.0
  v_mov_b32 v251, 1.0
  ds_read_b128 v[152:155], v253 offset:0
  ds_read_b128 v[156:159], v253 offset:32
  ds_read_b128 v[160:163], v253 offset:64
  ds_read_b128 v[164:167], v253 offset:96
  ds_read_b128 v[168:171], v253 offset:1024
  ds_read_b128 v[172:175], v253 offset:1056
  ds_read_b128 v[176:179], v253 offset:1088
  ds_read_b128 v[180:183], v253 offset:1120
  s_lshl_b32 s46, s40, 3
  s_lshl_b32 s54, s43, 1
  s_add_u32 s46, s46, s54
  s_mul_i32 s46, s46, 54
  s_add_u32 s46, s46, s56
  s_lshl_b32 s46, s46, 10
  s_add_u32 s46, s46, 0
  v_and_b32 v252, 1, v3
  v_mul_u32_u24 v252, 55296, v252
  v_lshl_add_u32 v252, v2, 4, v252
  v_lshl_add_u32 v252, v17, 8, v252
  ds_read_b128 v[184:187], v253 offset:128
  ds_read_b128 v[188:191], v253 offset:160
  ds_read_b128 v[192:195], v253 offset:192
  ds_read_b128 v[196:199], v253 offset:224
  ds_read_b128 v[200:203], v253 offset:1152
  ds_read_b128 v[204:207], v253 offset:1184
  ds_read_b128 v[208:211], v253 offset:1216
  ds_read_b128 v[212:215], v253 offset:1248
  s_waitcnt lgkmcnt(8)
  v_fma_f32 v40, v152, v14, v40
  v_fma_f32 v41, v153, v14, v41
  v_fma_f32 v42, v154, v14, v42
  v_fma_f32 v43, v155, v14, v43
  v_fma_f32 v44, v156, v14, v44
  v_fma_f32 v45, v157, v14, v45
  v_fma_f32 v46, v158, v14, v46
  v_fma_f32 v47, v159, v14, v47
  v_fma_f32 v40, v40, v15, v168
  v_fma_f32 v41, v41, v15, v169
  v_fma_f32 v42, v42, v15, v170
  v_fma_f32 v43, v43, v15, v171
  v_fma_f32 v44, v44, v15, v172
  v_fma_f32 v45, v45, v15, v173
  v_fma_f32 v46, v46, v15, v174
  v_fma_f32 v47, v47, v15, v175
  v_mul_f32 v216, v40, v249
  v_mul_f32 v217, v41, v249
  v_mul_f32 v218, v42, v249
  v_mul_f32 v219, v43, v249
  v_mul_f32 v220, v44, v249
  v_mul_f32 v221, v45, v249
  v_mul_f32 v222, v46, v249
  v_mul_f32 v223, v47, v249
  v_exp_f32 v216, v216
  v_exp_f32 v217, v217
  v_exp_f32 v218, v218
  v_exp_f32 v219, v219
  v_exp_f32 v220, v220
  v_exp_f32 v221, v221
  v_exp_f32 v222, v222
  v_exp_f32 v223, v223
  v_add_f32 v224, v216, v248
  v_add_f32 v225, v217, v248
  v_add_f32 v226, v218, v248
  v_add_f32 v227, v219, v248
  v_add_f32 v228, v220, v248
  v_add_f32 v229, v221, v248
  v_add_f32 v230, v222, v248
  v_add_f32 v231, v223, v248
  v_fma_f32 v224, v216, v224, v248
  v_fma_f32 v225, v217, v225, v248
  v_fma_f32 v226, v218, v226, v248
  v_fma_f32 v227, v219, v227, v248
  v_fma_f32 v228, v220, v228, v248
  v_fma_f32 v229, v221, v229, v248
  v_fma_f32 v230, v222, v230, v248
  v_fma_f32 v231, v223, v231, v248
  v_rcp_f32 v224, v224
  v_rcp_f32 v225, v225
  v_rcp_f32 v226, v226
  v_rcp_f32 v227, v227
  v_rcp_f32 v228, v228
  v_rcp_f32 v229, v229
  v_rcp_f32 v230, v230
  v_rcp_f32 v231, v231
  v_fma_f32 v224, v224, v250, v251
  v_fma_f32 v225, v225, v250, v251
  v_fma_f32 v226, v226, v250, v251
  v_fma_f32 v227, v227, v250, v251
  v_fma_f32 v228, v228, v250, v251
  v_fma_f32 v229, v229, v250, v251
  v_fma_f32 v230, v230, v250, v251
  v_fma_f32 v231, v231, v250, v251
  v_mul_f32 v40, v40, v224
  v_mul_f32 v41, v41, v225
  v_mul_f32 v42, v42, v226
  v_mul_f32 v43, v43, v227
  v_mul_f32 v44, v44, v228
  v_mul_f32 v45, v45, v229
  v_mul_f32 v46, v46, v230
  v_mul_f32 v47, v47, v231
  v_cvt_pk_bf16_f32 v232, v40, v41
  v_cvt_pk_bf16_f32 v233, v42, v43
  v_cvt_pk_bf16_f32 v234, v44, v45
  v_cvt_pk_bf16_f32 v235, v46, v47
  buffer_store_dwordx4 v[232:235], v252, s[28:31], s46 offen offset:0 sc1
  v_fma_f32 v48, v160, v14, v48
  v_fma_f32 v49, v161, v14, v49
  v_fma_f32 v50, v162, v14, v50
  v_fma_f32 v51, v163, v14, v51
  v_fma_f32 v52, v164, v14, v52
  v_fma_f32 v53, v165, v14, v53
  v_fma_f32 v54, v166, v14, v54
  v_fma_f32 v55, v167, v14, v55
  v_fma_f32 v48, v48, v15, v176
  v_fma_f32 v49, v49, v15, v177
  v_fma_f32 v50, v50, v15, v178
  v_fma_f32 v51, v51, v15, v179
  v_fma_f32 v52, v52, v15, v180
  v_fma_f32 v53, v53, v15, v181
  v_fma_f32 v54, v54, v15, v182
  v_fma_f32 v55, v55, v15, v183
  v_mul_f32 v216, v48, v249
  v_mul_f32 v217, v49, v249
  v_mul_f32 v218, v50, v249
  v_mul_f32 v219, v51, v249
  v_mul_f32 v220, v52, v249
  v_mul_f32 v221, v53, v249
  v_mul_f32 v222, v54, v249
  v_mul_f32 v223, v55, v249
  v_exp_f32 v216, v216
  v_exp_f32 v217, v217
  v_exp_f32 v218, v218
  v_exp_f32 v219, v219
  v_exp_f32 v220, v220
  v_exp_f32 v221, v221
  v_exp_f32 v222, v222
  v_exp_f32 v223, v223
  v_add_f32 v224, v216, v248
  v_add_f32 v225, v217, v248
  v_add_f32 v226, v218, v248
  v_add_f32 v227, v219, v248
  v_add_f32 v228, v220, v248
  v_add_f32 v229, v221, v248
  v_add_f32 v230, v222, v248
  v_add_f32 v231, v223, v248
  v_fma_f32 v224, v216, v224, v248
  v_fma_f32 v225, v217, v225, v248
  v_fma_f32 v226, v218, v226, v248
  v_fma_f32 v227, v219, v227, v248
  v_fma_f32 v228, v220, v228, v248
  v_fma_f32 v229, v221, v229, v248
  v_fma_f32 v230, v222, v230, v248
  v_fma_f32 v231, v223, v231, v248
  v_rcp_f32 v224, v224
  v_rcp_f32 v225, v225
  v_rcp_f32 v226, v226
  v_rcp_f32 v227, v227
  v_rcp_f32 v228, v228
  v_rcp_f32 v229, v229
  v_rcp_f32 v230, v230
  v_rcp_f32 v231, v231
  v_fma_f32 v224, v224, v250, v251
  v_fma_f32 v225, v225, v250, v251
  v_fma_f32 v226, v226, v250, v251
  v_fma_f32 v227, v227, v250, v251
  v_fma_f32 v228, v228, v250, v251
  v_fma_f32 v229, v229, v250, v251
  v_fma_f32 v230, v230, v250, v251
  v_fma_f32 v231, v231, v250, v251
  v_mul_f32 v48, v48, v224
  v_mul_f32 v49, v49, v225
  v_mul_f32 v50, v50, v226
  v_mul_f32 v51, v51, v227
  v_mul_f32 v52, v52, v228
  v_mul_f32 v53, v53, v229
  v_mul_f32 v54, v54, v230
  v_mul_f32 v55, v55, v231
  v_cvt_pk_bf16_f32 v236, v48, v49
  v_cvt_pk_bf16_f32 v237, v50, v51
  v_cvt_pk_bf16_f32 v238, v52, v53
  v_cvt_pk_bf16_f32 v239, v54, v55
  buffer_store_dwordx4 v[236:239], v252, s[28:31], s46 offen offset:512 sc1
  ds_read_b128 v[152:155], v253 offset:256
  ds_read_b128 v[156:159], v253 offset:288
  ds_read_b128 v[160:163], v253 offset:320
  ds_read_b128 v[164:167], v253 offset:352
  ds_read_b128 v[168:171], v253 offset:1280
  ds_read_b128 v[172:175], v253 offset:1312
  ds_read_b128 v[176:179], v253 offset:1344
  ds_read_b128 v[180:183], v253 offset:1376
  s_waitcnt lgkmcnt(8)
  v_fma_f32 v56, v184, v14, v56
  v_fma_f32 v57, v185, v14, v57
  v_fma_f32 v58, v186, v14, v58
  v_fma_f32 v59, v187, v14, v59
  v_fma_f32 v60, v188, v14, v60
  v_fma_f32 v61, v189, v14, v61
  v_fma_f32 v62, v190, v14, v62
  v_fma_f32 v63, v191, v14, v63
  v_fma_f32 v56, v56, v15, v200
  v_fma_f32 v57, v57, v15, v201
  v_fma_f32 v58, v58, v15, v202
  v_fma_f32 v59, v59, v15, v203
  v_fma_f32 v60, v60, v15, v204
  v_fma_f32 v61, v61, v15, v205
  v_fma_f32 v62, v62, v15, v206
  v_fma_f32 v63, v63, v15, v207
  v_mul_f32 v216, v56, v249
  v_mul_f32 v217, v57, v249
  v_mul_f32 v218, v58, v249
  v_mul_f32 v219, v59, v249
  v_mul_f32 v220, v60, v249
  v_mul_f32 v221, v61, v249
  v_mul_f32 v222, v62, v249
  v_mul_f32 v223, v63, v249
  v_exp_f32 v216, v216
  v_exp_f32 v217, v217
  v_exp_f32 v218, v218
  v_exp_f32 v219, v219
  v_exp_f32 v220, v220
  v_exp_f32 v221, v221
  v_exp_f32 v222, v222
  v_exp_f32 v223, v223
  v_add_f32 v224, v216, v248
  v_add_f32 v225, v217, v248
  v_add_f32 v226, v218, v248
  v_add_f32 v227, v219, v248
  v_add_f32 v228, v220, v248
  v_add_f32 v229, v221, v248
  v_add_f32 v230, v222, v248
  v_add_f32 v231, v223, v248
  v_fma_f32 v224, v216, v224, v248
  v_fma_f32 v225, v217, v225, v248
  v_fma_f32 v226, v218, v226, v248
  v_fma_f32 v227, v219, v227, v248
  v_fma_f32 v228, v220, v228, v248
  v_fma_f32 v229, v221, v229, v248
  v_fma_f32 v230, v222, v230, v248
  v_fma_f32 v231, v223, v231, v248
  v_rcp_f32 v224, v224
  v_rcp_f32 v225, v225
  v_rcp_f32 v226, v226
  v_rcp_f32 v227, v227
  v_rcp_f32 v228, v228
  v_rcp_f32 v229, v229
  v_rcp_f32 v230, v230
  v_rcp_f32 v231, v231
  v_fma_f32 v224, v224, v250, v251
  v_fma_f32 v225, v225, v250, v251
  v_fma_f32 v226, v226, v250, v251
  v_fma_f32 v227, v227, v250, v251
  v_fma_f32 v228, v228, v250, v251
  v_fma_f32 v229, v229, v250, v251
  v_fma_f32 v230, v230, v250, v251
  v_fma_f32 v231, v231, v250, v251
  v_mul_f32 v56, v56, v224
  v_mul_f32 v57, v57, v225
  v_mul_f32 v58, v58, v226
  v_mul_f32 v59, v59, v227
  v_mul_f32 v60, v60, v228
  v_mul_f32 v61, v61, v229
  v_mul_f32 v62, v62, v230
  v_mul_f32 v63, v63, v231
  v_cvt_pk_bf16_f32 v240, v56, v57
  v_cvt_pk_bf16_f32 v241, v58, v59
  v_cvt_pk_bf16_f32 v242, v60, v61
  v_cvt_pk_bf16_f32 v243, v62, v63
  buffer_store_dwordx4 v[240:243], v252, s[28:31], s46 offen offset:1024 sc1
  v_fma_f32 v64, v192, v14, v64
  v_fma_f32 v65, v193, v14, v65
  v_fma_f32 v66, v194, v14, v66
  v_fma_f32 v67, v195, v14, v67
  v_fma_f32 v68, v196, v14, v68
  v_fma_f32 v69, v197, v14, v69
  v_fma_f32 v70, v198, v14, v70
  v_fma_f32 v71, v199, v14, v71
  v_fma_f32 v64, v64, v15, v208
  v_fma_f32 v65, v65, v15, v209
  v_fma_f32 v66, v66, v15, v210
  v_fma_f32 v67, v67, v15, v211
  v_fma_f32 v68, v68, v15, v212
  v_fma_f32 v69, v69, v15, v213
  v_fma_f32 v70, v70, v15, v214
  v_fma_f32 v71, v71, v15, v215
  v_mul_f32 v216, v64, v249
  v_mul_f32 v217, v65, v249
  v_mul_f32 v218, v66, v249
  v_mul_f32 v219, v67, v249
  v_mul_f32 v220, v68, v249
  v_mul_f32 v221, v69, v249
  v_mul_f32 v222, v70, v249
  v_mul_f32 v223, v71, v249
  v_exp_f32 v216, v216
  v_exp_f32 v217, v217
  v_exp_f32 v218, v218
  v_exp_f32 v219, v219
  v_exp_f32 v220, v220
  v_exp_f32 v221, v221
  v_exp_f32 v222, v222
  v_exp_f32 v223, v223
  v_add_f32 v224, v216, v248
  v_add_f32 v225, v217, v248
  v_add_f32 v226, v218, v248
  v_add_f32 v227, v219, v248
  v_add_f32 v228, v220, v248
  v_add_f32 v229, v221, v248
  v_add_f32 v230, v222, v248
  v_add_f32 v231, v223, v248
  v_fma_f32 v224, v216, v224, v248
  v_fma_f32 v225, v217, v225, v248
  v_fma_f32 v226, v218, v226, v248
  v_fma_f32 v227, v219, v227, v248
  v_fma_f32 v228, v220, v228, v248
  v_fma_f32 v229, v221, v229, v248
  v_fma_f32 v230, v222, v230, v248
  v_fma_f32 v231, v223, v231, v248
  v_rcp_f32 v224, v224
  v_rcp_f32 v225, v225
  v_rcp_f32 v226, v226
  v_rcp_f32 v227, v227
  v_rcp_f32 v228, v228
  v_rcp_f32 v229, v229
  v_rcp_f32 v230, v230
  v_rcp_f32 v231, v231
  v_fma_f32 v224, v224, v250, v251
  v_fma_f32 v225, v225, v250, v251
  v_fma_f32 v226, v226, v250, v251
  v_fma_f32 v227, v227, v250, v251
  v_fma_f32 v228, v228, v250, v251
  v_fma_f32 v229, v229, v250, v251
  v_fma_f32 v230, v230, v250, v251
  v_fma_f32 v231, v231, v250, v251
  v_mul_f32 v64, v64, v224
  v_mul_f32 v65, v65, v225
  v_mul_f32 v66, v66, v226
  v_mul_f32 v67, v67, v227
  v_mul_f32 v68, v68, v228
  v_mul_f32 v69, v69, v229
  v_mul_f32 v70, v70, v230
  v_mul_f32 v71, v71, v231
  v_cvt_pk_bf16_f32 v244, v64, v65
  v_cvt_pk_bf16_f32 v245, v66, v67
  v_cvt_pk_bf16_f32 v246, v68, v69
  v_cvt_pk_bf16_f32 v247, v70, v71
  buffer_store_dwordx4 v[244:247], v252, s[28:31], s46 offen offset:1536 sc1
  ds_read_b128 v[184:187], v253 offset:384
  ds_read_b128 v[188:191], v253 offset:416
  ds_read_b128 v[192:195], v253 offset:448
  ds_read_b128 v[196:199], v253 offset:480
  ds_read_b128 v[200:203], v253 offset:1408
  ds_read_b128 v[204:207], v253 offset:1440
  ds_read_b128 v[208:211], v253 offset:1472
  ds_read_b128 v[212:215], v253 offset:1504
  s_waitcnt lgkmcnt(8)
  v_fma_f32 v72, v152, v14, v72
  v_fma_f32 v73, v153, v14, v73
  v_fma_f32 v74, v154, v14, v74
  v_fma_f32 v75, v155, v14, v75
  v_fma_f32 v76, v156, v14, v76
  v_fma_f32 v77, v157, v14, v77
  v_fma_f32 v78, v158, v14, v78
  v_fma_f32 v79, v159, v14, v79
  v_fma_f32 v72, v72, v15, v168
  v_fma_f32 v73, v73, v15, v169
  v_fma_f32 v74, v74, v15, v170
  v_fma_f32 v75, v75, v15, v171
  v_fma_f32 v76, v76, v15, v172
  v_fma_f32 v77, v77, v15, v173
  v_fma_f32 v78, v78, v15, v174
  v_fma_f32 v79, v79, v15, v175
  v_mul_f32 v216, v72, v249
  v_mul_f32 v217, v73, v249
  v_mul_f32 v218, v74, v249
  v_mul_f32 v219, v75, v249
  v_mul_f32 v220, v76, v249
  v_mul_f32 v221, v77, v249
  v_mul_f32 v222, v78, v249
  v_mul_f32 v223, v79, v249
  v_exp_f32 v216, v216
  v_exp_f32 v217, v217
  v_exp_f32 v218, v218
  v_exp_f32 v219, v219
  v_exp_f32 v220, v220
  v_exp_f32 v221, v221
  v_exp_f32 v222, v222
  v_exp_f32 v223, v223
  v_add_f32 v224, v216, v248
  v_add_f32 v225, v217, v248
  v_add_f32 v226, v218, v248
  v_add_f32 v227, v219, v248
  v_add_f32 v228, v220, v248
  v_add_f32 v229, v221, v248
  v_add_f32 v230, v222, v248
  v_add_f32 v231, v223, v248
  v_fma_f32 v224, v216, v224, v248
  v_fma_f32 v225, v217, v225, v248
  v_fma_f32 v226, v218, v226, v248
  v_fma_f32 v227, v219, v227, v248
  v_fma_f32 v228, v220, v228, v248
  v_fma_f32 v229, v221, v229, v248
  v_fma_f32 v230, v222, v230, v248
  v_fma_f32 v231, v223, v231, v248
  v_rcp_f32 v224, v224
  v_rcp_f32 v225, v225
  v_rcp_f32 v226, v226
  v_rcp_f32 v227, v227
  v_rcp_f32 v228, v228
  v_rcp_f32 v229, v229
  v_rcp_f32 v230, v230
  v_rcp_f32 v231, v231
  v_fma_f32 v224, v224, v250, v251
  v_fma_f32 v225, v225, v250, v251
  v_fma_f32 v226, v226, v250, v251
  v_fma_f32 v227, v227, v250, v251
  v_fma_f32 v228, v228, v250, v251
  v_fma_f32 v229, v229, v250, v251
  v_fma_f32 v230, v230, v250, v251
  v_fma_f32 v231, v231, v250, v251
  v_mul_f32 v72, v72, v224
  v_mul_f32 v73, v73, v225
  v_mul_f32 v74, v74, v226
  v_mul_f32 v75, v75, v227
  v_mul_f32 v76, v76, v228
  v_mul_f32 v77, v77, v229
  v_mul_f32 v78, v78, v230
  v_mul_f32 v79, v79, v231
  v_cvt_pk_bf16_f32 v232, v72, v73
  v_cvt_pk_bf16_f32 v233, v74, v75
  v_cvt_pk_bf16_f32 v234, v76, v77
  v_cvt_pk_bf16_f32 v235, v78, v79
  buffer_store_dwordx4 v[232:235], v252, s[28:31], s46 offen offset:2048 sc1
  v_fma_f32 v80, v160, v14, v80
  v_fma_f32 v81, v161, v14, v81
  v_fma_f32 v82, v162, v14, v82
  v_fma_f32 v83, v163, v14, v83
  v_fma_f32 v84, v164, v14, v84
  v_fma_f32 v85, v165, v14, v85
  v_fma_f32 v86, v166, v14, v86
  v_fma_f32 v87, v167, v14, v87
  v_fma_f32 v80, v80, v15, v176
  v_fma_f32 v81, v81, v15, v177
  v_fma_f32 v82, v82, v15, v178
  v_fma_f32 v83, v83, v15, v179
  v_fma_f32 v84, v84, v15, v180
  v_fma_f32 v85, v85, v15, v181
  v_fma_f32 v86, v86, v15, v182
  v_fma_f32 v87, v87, v15, v183
  v_mul_f32 v216, v80, v249
  v_mul_f32 v217, v81, v249
  v_mul_f32 v218, v82, v249
  v_mul_f32 v219, v83, v249
  v_mul_f32 v220, v84, v249
  v_mul_f32 v221, v85, v249
  v_mul_f32 v222, v86, v249
  v_mul_f32 v223, v87, v249
  v_exp_f32 v216, v216
  v_exp_f32 v217, v217
  v_exp_f32 v218, v218
  v_exp_f32 v219, v219
  v_exp_f32 v220, v220
  v_exp_f32 v221, v221
  v_exp_f32 v222, v222
  v_exp_f32 v223, v223
  v_add_f32 v224, v216, v248
  v_add_f32 v225, v217, v248
  v_add_f32 v226, v218, v248
  v_add_f32 v227, v219, v248
  v_add_f32 v228, v220, v248
  v_add_f32 v229, v221, v248
  v_add_f32 v230, v222, v248
  v_add_f32 v231, v223, v248
  v_fma_f32 v224, v216, v224, v248
  v_fma_f32 v225, v217, v225, v248
  v_fma_f32 v226, v218, v226, v248
  v_fma_f32 v227, v219, v227, v248
  v_fma_f32 v228, v220, v228, v248
  v_fma_f32 v229, v221, v229, v248
  v_fma_f32 v230, v222, v230, v248
  v_fma_f32 v231, v223, v231, v248
  v_rcp_f32 v224, v224
  v_rcp_f32 v225, v225
  v_rcp_f32 v226, v226
  v_rcp_f32 v227, v227
  v_rcp_f32 v228, v228
  v_rcp_f32 v229, v229
  v_rcp_f32 v230, v230
  v_rcp_f32 v231, v231
  v_fma_f32 v224, v224, v250, v251
  v_fma_f32 v225, v225, v250, v251
  v_fma_f32 v226, v226, v250, v251
  v_fma_f32 v227, v227, v250, v251
  v_fma_f32 v228, v228, v250, v251
  v_fma_f32 v229, v229, v250, v251
  v_fma_f32 v230, v230, v250, v251
  v_fma_f32 v231, v231, v250, v251
  v_mul_f32 v80, v80, v224
  v_mul_f32 v81, v81, v225
  v_mul_f32 v82, v82, v226
  v_mul_f32 v83, v83, v227
  v_mul_f32 v84, v84, v228
  v_mul_f32 v85, v85, v229
  v_mul_f32 v86, v86, v230
  v_mul_f32 v87, v87, v231
  v_cvt_pk_bf16_f32 v236, v80, v81
  v_cvt_pk_bf16_f32 v237, v82, v83
  v_cvt_pk_bf16_f32 v238, v84, v85
  v_cvt_pk_bf16_f32 v239, v86, v87
  buffer_store_dwordx4 v[236:239], v252, s[28:31], s46 offen offset:2560 sc1
  s_waitcnt lgkmcnt(0)
  v_fma_f32 v88, v184, v14, v88
  v_fma_f32 v89, v185, v14, v89
  v_fma_f32 v90, v186, v14, v90
  v_fma_f32 v91, v187, v14, v91
  v_fma_f32 v92, v188, v14, v92
  v_fma_f32 v93, v189, v14, v93
  v_fma_f32 v94, v190, v14, v94
  v_fma_f32 v95, v191, v14, v95
  v_fma_f32 v88, v88, v15, v200
  v_fma_f32 v89, v89, v15, v201
  v_fma_f32 v90, v90, v15, v202
  v_fma_f32 v91, v91, v15, v203
  v_fma_f32 v92, v92, v15, v204
  v_fma_f32 v93, v93, v15, v205
  v_fma_f32 v94, v94, v15, v206
  v_fma_f32 v95, v95, v15, v207
  v_mul_f32 v216, v88, v249
  v_mul_f32 v217, v89, v249
  v_mul_f32 v218, v90, v249
  v_mul_f32 v219, v91, v249
  v_mul_f32 v220, v92, v249
  v_mul_f32 v221, v93, v249
  v_mul_f32 v222, v94, v249
  v_mul_f32 v223, v95, v249
  v_exp_f32 v216, v216
  v_exp_f32 v217, v217
  v_exp_f32 v218, v218
  v_exp_f32 v219, v219
  v_exp_f32 v220, v220
  v_exp_f32 v221, v221
  v_exp_f32 v222, v222
  v_exp_f32 v223, v223
  v_add_f32 v224, v216, v248
  v_add_f32 v225, v217, v248
  v_add_f32 v226, v218, v248
  v_add_f32 v227, v219, v248
  v_add_f32 v228, v220, v248
  v_add_f32 v229, v221, v248
  v_add_f32 v230, v222, v248
  v_add_f32 v231, v223, v248
  v_fma_f32 v224, v216, v224, v248
  v_fma_f32 v225, v217, v225, v248
  v_fma_f32 v226, v218, v226, v248
  v_fma_f32 v227, v219, v227, v248
  v_fma_f32 v228, v220, v228, v248
  v_fma_f32 v229, v221, v229, v248
  v_fma_f32 v230, v222, v230, v248
  v_fma_f32 v231, v223, v231, v248
  v_rcp_f32 v224, v224
  v_rcp_f32 v225, v225
  v_rcp_f32 v226, v226
  v_rcp_f32 v227, v227
  v_rcp_f32 v228, v228
  v_rcp_f32 v229, v229
  v_rcp_f32 v230, v230
  v_rcp_f32 v231, v231
  v_fma_f32 v224, v224, v250, v251
  v_fma_f32 v225, v225, v250, v251
  v_fma_f32 v226, v226, v250, v251
  v_fma_f32 v227, v227, v250, v251
  v_fma_f32 v228, v228, v250, v251
  v_fma_f32 v229, v229, v250, v251
  v_fma_f32 v230, v230, v250, v251
  v_fma_f32 v231, v231, v250, v251
  v_mul_f32 v88, v88, v224
  v_mul_f32 v89, v89, v225
  v_mul_f32 v90, v90, v226
  v_mul_f32 v91, v91, v227
  v_mul_f32 v92, v92, v228
  v_mul_f32 v93, v93, v229
  v_mul_f32 v94, v94, v230
  v_mul_f32 v95, v95, v231
  v_cvt_pk_bf16_f32 v240, v88, v89
  v_cvt_pk_bf16_f32 v241, v90, v91
  v_cvt_pk_bf16_f32 v242, v92, v93
  v_cvt_pk_bf16_f32 v243, v94, v95
  buffer_store_dwordx4 v[240:243], v252, s[28:31], s46 offen offset:3072 sc1
  v_fma_f32 v96, v192, v14, v96
  v_fma_f32 v97, v193, v14, v97
  v_fma_f32 v98, v194, v14, v98
  v_fma_f32 v99, v195, v14, v99
  v_fma_f32 v100, v196, v14, v100
  v_fma_f32 v101, v197, v14, v101
  v_fma_f32 v102, v198, v14, v102
  v_fma_f32 v103, v199, v14, v103
  v_fma_f32 v96, v96, v15, v208
  v_fma_f32 v97, v97, v15, v209
  v_fma_f32 v98, v98, v15, v210
  v_fma_f32 v99, v99, v15, v211
  v_fma_f32 v100, v100, v15, v212
  v_fma_f32 v101, v101, v15, v213
  v_fma_f32 v102, v102, v15, v214
  v_fma_f32 v103, v103, v15, v215
  v_mul_f32 v216, v96, v249
  v_mul_f32 v217, v97, v249
  v_mul_f32 v218, v98, v249
  v_mul_f32 v219, v99, v249
  v_mul_f32 v220, v100, v249
  v_mul_f32 v221, v101, v249
  v_mul_f32 v222, v102, v249
  v_mul_f32 v223, v103, v249
  v_exp_f32 v216, v216
  v_exp_f32 v217, v217
  v_exp_f32 v218, v218
  v_exp_f32 v219, v219
  v_exp_f32 v220, v220
  v_exp_f32 v221, v221
  v_exp_f32 v222, v222
  v_exp_f32 v223, v223
  v_add_f32 v224, v216, v248
  v_add_f32 v225, v217, v248
  v_add_f32 v226, v218, v248
  v_add_f32 v227, v219, v248
  v_add_f32 v228, v220, v248
  v_add_f32 v229, v221, v248
  v_add_f32 v230, v222, v248
  v_add_f32 v231, v223, v248
  v_fma_f32 v224, v216, v224, v248
  v_fma_f32 v225, v217, v225, v248
  v_fma_f32 v226, v218, v226, v248
  v_fma_f32 v227, v219, v227, v248
  v_fma_f32 v228, v220, v228, v248
  v_fma_f32 v229, v221, v229, v248
  v_fma_f32 v230, v222, v230, v248
  v_fma_f32 v231, v223, v231, v248
  v_rcp_f32 v224, v224
  v_rcp_f32 v225, v225
  v_rcp_f32 v226, v226
  v_rcp_f32 v227, v227
  v_rcp_f32 v228, v228
  v_rcp_f32 v229, v229
  v_rcp_f32 v230, v230
  v_rcp_f32 v231, v231
  v_fma_f32 v224, v224, v250, v251
  v_fma_f32 v225, v225, v250, v251
  v_fma_f32 v226, v226, v250, v251
  v_fma_f32 v227, v227, v250, v251
  v_fma_f32 v228, v228, v250, v251
  v_fma_f32 v229, v229, v250, v251
  v_fma_f32 v230, v230, v250, v251
  v_fma_f32 v231, v231, v250, v251
  v_mul_f32 v96, v96, v224
  v_mul_f32 v97, v97, v225
  v_mul_f32 v98, v98, v226
  v_mul_f32 v99, v99, v227
  v_mul_f32 v100, v100, v228
  v_mul_f32 v101, v101, v229
  v_mul_f32 v102, v102, v230
  v_mul_f32 v103, v103, v231
  v_cvt_pk_bf16_f32 v244, v96, v97
  v_cvt_pk_bf16_f32 v245, v98, v99
  v_cvt_pk_bf16_f32 v246, v100, v101
  v_cvt_pk_bf16_f32 v247, v102, v103
  buffer_store_dwordx4 v[244:247], v252, s[28:31], s46 offen offset:3584 sc1
  s_waitcnt vmcnt(0)
  s_endpgm
L_ffn_B:
  s_waitcnt vmcnt(4)
  s_barrier
  ds_read_b128 v[104:107], v10 offset:0
  ds_read_b128 v[108:111], v11 offset:0
  ds_read_b128 v[112:115], v12 offset:0
  ds_read_b128 v[116:119], v13 offset:0
  s_mov_b32 s50, 331776
  s_add_u32 m0, s45, 46080
  s_nop 0
  buffer_load_dwordx4 v4, s[24:27], s50 offen lds
  s_add_u32 m0, s45, 47104
  s_mov_b32 exec_hi, 0xffff
  buffer_load_dwordx4 v5, s[24:27], s50 offen lds
  s_mov_b64 exec, -1
  ds_read_b64_tr_b16 v[24:25], v6 offset:0
  ds_read_b64_tr_b16 v[26:27], v6 offset:1792
  ds_read_b64_tr_b16 v[28:29], v6 offset:64
  ds_read_b64_tr_b16 v[30:31], v6 offset:1856
  ds_read_b64_tr_b16 v[32:33], v6 offset:128
  ds_read_b64_tr_b16 v[34:35], v6 offset:1920
  ds_read_b64_tr_b16 v[36:37], v6 offset:7168
  ds_read_b64_tr_b16 v[38:39], v6 offset:8960
  s_waitcnt lgkmcnt(6)
  v_mfma_f32_32x32x16_bf16 v[40:55], v[24:27], v[104:107], 0
  v_mov_b32 v216, 0
  v_mov_b32 v217, 0
  v_mov_b32 v218, 0
  v_mov_b32 v219, 0
  v_lshlrev_b32 v240, 16, v196
  v_and_b32 v241, 0xffff0000, v196
  v_add_f32 v216, v216, v240
  v_fmac_f32 v217, v240, v240
  v_add_f32 v216, v216, v241
  v_fmac_f32 v217, v241, v241
  v_lshlrev_b32 v240, 16, v197
  v_and_b32 v241, 0xffff0000, v197
  v_add_f32 v216, v216, v240
  ds_read_b64_tr_b16 v[24:25], v6 offset:7232
  ds_read_b64_tr_b16 v[26:27], v6 offset:9024
  s_waitcnt lgkmcnt(6)
  v_mfma_f32_32x32x16_bf16 v[56:71], v[28:31], v[104:107], 0
  v_fmac_f32 v217, v240, v240
  v_add_f32 v216, v216, v241
  v_fmac_f32 v217, v241, v241
  v_lshlrev_b32 v240, 16, v198
  v_and_b32 v241, 0xffff0000, v198
  v_add_f32 v216, v216, v240
  v_fmac_f32 v217, v240, v240
  v_add_f32 v216, v216, v241
  v_fmac_f32 v217, v241, v241
  v_lshlrev_b32 v240, 16, v199
  v_and_b32 v241, 0xffff0000, v199
  v_add_f32 v216, v216, v240
  v_fmac_f32 v217, v240, v240
  v_add_f32 v216, v216, v241
  ds_read_b64_tr_b16 v[28:29], v6 offset:7296
  ds_read_b64_tr_b16 v[30:31], v6 offset:9088
  s_waitcnt lgkmcnt(6)
  v_mfma_f32_32x32x16_bf16 v[72:87], v[32:35], v[104:107], 0
  v_fmac_f32 v217, v241, v241
  v_lshlrev_b32 v240, 16, v200
  v_and_b32 v241, 0xffff0000, v200
  v_add_f32 v216, v216, v240
  v_fmac_f32 v217, v240, v240
  v_add_f32 v216, v216, v241
  v_fmac_f32 v217, v241, v241
  v_lshlrev_b32 v240, 16, v201
  v_and_b32 v241, 0xffff0000, v201
  v_add_f32 v216, v216, v240
  v_fmac_f32 v217, v240, v240
  v_add_f32 v216, v216, v241
  v_fmac_f32 v217, v241, v241
  v_lshlrev_b32 v240, 16, v202
  ds_read_b64_tr_b16 v[32:33], v6 offset:15360
  ds_read_b64_tr_b16 v[34:35], v6 offset:17152
  s_waitcnt lgkmcnt(6)
  v_mfma_f32_32x32x16_bf16 v[40:55], v[36:39], v[108:111], v[40:55]
  s_mov_b32 s50, 442368
  s_add_u32 m0, s45, 61440
  s_nop 0
  buffer_load_dwordx4 v4, s[24:27], s50 offen lds
  s_add_u32 m0, s45, 62464
  s_mov_b32 exec_hi, 0xffff
  buffer_load_dwordx4 v5, s[24:27], s50 offen lds
  s_mov_b64 exec, -1
  s_add_u32 s50, s49, 256
  s_add_u32 m0, s47, 124928
  s_nop 0
  buffer_load_dwordx4 v8, s[20:23], s50 offen lds
  s_add_u32 m0, s47, 125952
  s_nop 0
  buffer_load_dwordx4 v9, s[20:23], s50 offen lds
  v_and_b32 v241, 0xffff0000, v202
  v_add_f32 v216, v216, v240
  v_fmac_f32 v217, v240, v240
  v_add_f32 v216, v216, v241
  v_fmac_f32 v217, v241, v241
  v_lshlrev_b32 v240, 16, v203
  v_and_b32 v241, 0xffff0000, v203
  v_add_f32 v216, v216, v240
  v_fmac_f32 v217, v240, v240
  v_add_f32 v216, v216, v241
  v_fmac_f32 v217, v241, v241
  v_lshlrev_b32 v240, 16, v204
  v_and_b32 v241, 0xffff0000, v204
  v_add_f32 v218, v218, v240
  ds_read_b64_tr_b16 v[36:37], v6 offset:15424
  ds_read_b64_tr_b16 v[38:39], v6 offset:17216
  s_waitcnt lgkmcnt(6)
  v_mfma_f32_32x32x16_bf16 v[56:71], v[24:27], v[108:111], v[56:71]
  v_fmac_f32 v219, v240, v240
  v_add_f32 v218, v218, v241
  v_fmac_f32 v219, v241, v241
  v_lshlrev_b32 v240, 16, v205
  v_and_b32 v241, 0xffff0000, v205
  v_add_f32 v218, v218, v240
  v_fmac_f32 v219, v240, v240
  v_add_f32 v218, v218, v241
  v_fmac_f32 v219, v241, v241
  v_lshlrev_b32 v240, 16, v206
  v_and_b32 v241, 0xffff0000, v206
  v_add_f32 v218, v218, v240
  v_fmac_f32 v219, v240, v240
  v_add_f32 v218, v218, v241
  ds_read_b64_tr_b16 v[24:25], v6 offset:15488
  ds_read_b64_tr_b16 v[26:27], v6 offset:17280
  s_waitcnt lgkmcnt(6)
  v_mfma_f32_32x32x16_bf16 v[72:87], v[28:31], v[108:111], v[72:87]
  v_fmac_f32 v219, v241, v241
  v_lshlrev_b32 v240, 16, v207
  v_and_b32 v241, 0xffff0000, v207
  v_add_f32 v218, v218, v240
  v_fmac_f32 v219, v240, v240
  v_add_f32 v218, v218, v241
  v_fmac_f32 v219, v241, v241
  v_lshlrev_b32 v240, 16, v208
  v_and_b32 v241, 0xffff0000, v208
  v_add_f32 v218, v218, v240
  v_fmac_f32 v219, v240, v240
  v_add_f32 v218, v218, v241
  v_fmac_f32 v219, v241, v241
  v_lshlrev_b32 v240, 16, v209
  ds_read_b64_tr_b16 v[28:29], v6 offset:22528
  ds_read_b64_tr_b16 v[30:31], v6 offset:24320
  s_waitcnt lgkmcnt(6)
  v_mfma_f32_32x32x16_bf16 v[40:55], v[32:35], v[112:115], v[40:55]
  v_and_b32 v241, 0xffff0000, v209
  v_add_f32 v218, v218, v240
  v_fmac_f32 v219, v240, v240
  v_add_f32 v218, v218, v241
  v_fmac_f32 v219, v241, v241
  v_lshlrev_b32 v240, 16, v210
  v_and_b32 v241, 0xffff0000, v210
  v_add_f32 v218, v218, v240
  v_fmac_f32 v219, v240, v240
  v_add_f32 v218, v218, v241
  v_fmac_f32 v219, v241, v241
  v_lshlrev_b32 v240, 16, v211
  v_and_b32 v241, 0xffff0000, v211
  v_add_f32 v218, v218, v240
  ds_read_b64_tr_b16 v[32:33], v6 offset:22592
  ds_read_b64_tr_b16 v[34:35], v6 offset:24384
  s_waitcnt lgkmcnt(6)
  v_mfma_f32_32x32x16_bf16 v[56:71], v[36:39], v[112:115], v[56:71]
  v_fmac_f32 v219, v240, v240
  v_add_f32 v218, v218, v241
  v_fmac_f32 v219, v241, v241
  s_nop 1
  v_add_f32_dpp v216, v216, v216 quad_perm:[1,0,3,2] row_mask:0xf bank_mask:0xf
  v_add_f32_dpp v217, v217, v217 quad_perm:[1,0,3,2] row_mask:0xf bank_mask:0xf
  v_add_f32_dpp v218, v218, v218 quad_perm:[1,0,3,2] row_mask:0xf bank_mask:0xf
  v_add_f32_dpp v219, v219, v219 quad_perm:[1,0,3,2] row_mask:0xf bank_mask:0xf
  s_nop 1
  v_add_f32_dpp v216, v216, v216 quad_perm:[2,3,0,1] row_mask:0xf bank_mask:0xf
  v_add_f32_dpp v217, v217, v217 quad_perm:[2,3,0,1] row_mask:0xf bank_mask:0xf
  v_add_f32_dpp v218, v218, v218 quad_perm:[2,3,0,1] row_mask:0xf bank_mask:0xf
  v_add_f32_dpp v219, v219, v219 quad_perm:[2,3,0,1] row_mask:0xf bank_mask:0xf
  s_nop 1
  ds_read_b64_tr_b16 v[36:37], v6 offset:22656
  ds_read_b64_tr_b16 v[38:39], v6 offset:24448
  s_waitcnt lgkmcnt(6)
  v_mfma_f32_32x32x16_bf16 v[72:87], v[24:27], v[112:115], v[72:87]
  v_add_f32_dpp v216, v216, v216 row_half_mirror row_mask:0xf bank_mask:0xf
  v_add_f32_dpp v217, v217, v217 row_half_mirror row_mask:0xf bank_mask:0xf
  v_add_f32_dpp v218, v218, v218 row_half_mirror row_mask:0xf bank_mask:0xf
  v_add_f32_dpp v219, v219, v219 row_half_mirror row_mask:0xf bank_mask:0xf
  s_nop 1
  v_add_f32_dpp v216, v216, v216 row_mirror row_mask:0xf bank_mask:0xf
  v_add_f32_dpp v217, v217, v217 row_mirror row_mask:0xf bank_mask:0xf
  v_add_f32_dpp v218, v218, v218 row_mirror row_mask:0xf bank_mask:0xf
  v_add_f32_dpp v219, v219, v219 row_mirror row_mask:0xf bank_mask:0xf
  v_mov_b32 v220, v216
  v_mov_b32 v221, v217
  v_mov_b32 v222, v218
  v_mov_b32 v223, v219
  v_permlane16_swap_b32 v216, v220
  s_waitcnt vmcnt(4)
  s_barrier
  ds_read_b128 v[120:123], v10 offset:16384
  ds_read_b128 v[124:127], v11 offset:16384
  ds_read_b128 v[128:131], v12 offset:16384
  ds_read_b128 v[132:135], v13 offset:16384
  s_mov_b32 s50, 552960
  s_add_u32 m0, s45, 76800
  s_nop 0
  buffer_load_dwordx4 v4, s[24:27], s50 offen lds
  s_add_u32 m0, s45, 77824
  s_mov_b32 exec_hi, 0xffff
  buffer_load_dwordx4 v5, s[24:27], s50 offen lds
  s_mov_b64 exec, -1
  ds_read_b64_tr_b16 v[24:25], v6 offset:30720
  ds_read_b64_tr_b16 v[26:27], v6 offset:32512
  s_waitcnt lgkmcnt(10)
  v_mfma_f32_32x32x16_bf16 v[40:55], v[28:31], v[116:119], v[40:55]
  s_mov_b32 s50, 663552
  s_add_u32 m0, s45, 0
  s_nop 0
  buffer_load_dwordx4 v4, s[24:27], s50 offen lds
  s_add_u32 m0, s45, 1024
  s_mov_b32 exec_hi, 0xffff
  buffer_load_dwordx4 v5, s[24:27], s50 offen lds
  s_mov_b64 exec, -1
  s_add_u32 s50, s49, 384
  s_add_u32 m0, s47, 92160
  s_nop 0
  buffer_load_dwordx4 v8, s[20:23], s50 offen lds
  s_add_u32 m0, s47, 93184
  s_nop 0
  buffer_load_dwordx4 v9, s[20:23], s50 offen lds
  v_permlane16_swap_b32 v217, v221
  v_permlane16_swap_b32 v218, v222
  v_permlane16_swap_b32 v219, v223
  v_add_f32 v216, v216, v220
  v_add_f32 v217, v217, v221
  v_add_f32 v218, v218, v222
  v_add_f32 v219, v219, v223
  v_mov_b32 v220, v216
  v_mov_b32 v221, v217
  v_mov_b32 v222, v218
  v_mov_b32 v223, v219
  v_permlane32_swap_b32 v216, v220
  v_permlane32_swap_b32 v217, v221
  v_permlane32_swap_b32 v218, v222
  ds_read_b64_tr_b16 v[28:29], v6 offset:30784
  ds_read_b64_tr_b16 v[30:31], v6 offset:32576
  s_waitcnt lgkmcnt(10)
  v_mfma_f32_32x32x16_bf16 v[56:71], v[32:35], v[116:119], v[56:71]
  v_permlane32_swap_b32 v219, v223
  v_add_f32 v216, v216, v220
  v_add_f32 v217, v217, v221
  v_add_f32 v218, v218, v222
  v_add_f32 v219, v219, v223
  v_mul_f32 v216, 0x3acccccd, v216
  v_mul_f32 v217, 0x3acccccd, v217
  v_fma_f32 v217, -v216, v216, v217
  v_max_f32 v217, 0, v217
  v_cvt_pk_bf16_f32 v240, v216, v217
  v_lshlrev_b32 v212, 16, v240
  v_xor_b32 v212, 0x80000000, v212
  v_and_b32 v240, 0xffff0000, v240
  v_add_f32 v240, 0x3727c5ac, v240
  ds_read_b64_tr_b16 v[32:33], v6 offset:30848
  ds_read_b64_tr_b16 v[34:35], v6 offset:32640
  s_waitcnt lgkmcnt(10)
  v_mfma_f32_32x32x16_bf16 v[72:87], v[36:39], v[116:119], v[72:87]
  v_cvt_pk_bf16_f32 v240, v240, v240
  v_and_b32 v240, 0xffff0000, v240
  v_sqrt_f32 v240, v240
  s_nop 0
  v_cvt_pk_bf16_f32 v240, v240, v240
  v_and_b32 v240, 0xffff0000, v240
  v_rcp_f32 v213, v240
  v_mul_f32 v218, 0x3acccccd, v218
  v_mul_f32 v219, 0x3acccccd, v219
  v_fma_f32 v219, -v218, v218, v219
  v_max_f32 v219, 0, v219
  v_cvt_pk_bf16_f32 v240, v218, v219
  v_lshlrev_b32 v214, 16, v240
  v_xor_b32 v214, 0x80000000, v214
  v_and_b32 v240, 0xffff0000, v240
  ds_read_b64_tr_b16 v[36:37], v6 offset:37888
  ds_read_b64_tr_b16 v[38:39], v6 offset:39680
  s_waitcnt lgkmcnt(6)
  v_mfma_f32_32x32x16_bf16 v[40:55], v[24:27], v[120:123], v[40:55]
  v_add_f32 v240, 0x3727c5ac, v240
  v_cvt_pk_bf16_f32 v240, v240, v240
  v_and_b32 v240, 0xffff0000, v240
  v_sqrt_f32 v240, v240
  s_nop 0
  v_cvt_pk_bf16_f32 v240, v240, v240
  v_and_b32 v240, 0xffff0000, v240
  v_rcp_f32 v215, v240
  v_mov_b32 v240, 0
  v_mov_b32 v241, 0
  v_lshlrev_b32 v242, 3, v0
  v_mov_b32 v248, 0x7ffffff0
  v_cmp_gt_u32 vcc, 320, v0
  s_nop 1
  v_cndmask_b32 v242, v248, v242, vcc
  s_lshl_b32 s63, s40, 3
  ds_read_b64_tr_b16 v[24:25], v6 offset:37952
  ds_read_b64_tr_b16 v[26:27], v6 offset:39744
  s_waitcnt lgkmcnt(6)
  v_mfma_f32_32x32x16_bf16 v[56:71], v[28:31], v[120:123], v[56:71]
  s_add_u32 s63, s63, s41
  s_sub_u32 s63, s63, 8
  s_mul_i32 s62, s63, 2560
  s_add_u32 s62, s62, 12320768
  s_cmp_lt_u32 s63, 126
  s_cselect_b32 s62, s62, 0x7ffffff0
  buffer_store_dwordx2 v[240:241], v242, s[28:31], s62 offen sc1
  v_cmp_eq_u32 vcc, 0, v0
  s_nop 1
  v_cndmask_b32 v242, v248, 0, vcc
  s_lshl_b32 s62, s63, 8
  s_add_u32 s62, s62, 18591744
  buffer_store_dword v240, v242, s[28:31], s62 offen
  v_lshlrev_b32 v244, 16, v224
  ds_read_b64_tr_b16 v[28:29], v6 offset:38016
  ds_read_b64_tr_b16 v[30:31], v6 offset:39808
  s_waitcnt lgkmcnt(6)
  v_mfma_f32_32x32x16_bf16 v[72:87], v[32:35], v[120:123], v[72:87]
  v_and_b32 v245, 0xffff0000, v224
  v_lshlrev_b32 v246, 16, v225
  v_and_b32 v247, 0xffff0000, v225
  v_lshlrev_b32 v238, 16, v226
  v_and_b32 v239, 0xffff0000, v226
  v_add_f32 v244, v244, v238
  v_add_f32 v245, v245, v239
  v_lshlrev_b32 v238, 16, v227
  v_and_b32 v239, 0xffff0000, v227
  v_add_f32 v246, v246, v238
  v_add_f32 v247, v247, v239
  v_lshlrev_b32 v238, 16, v228
  v_and_b32 v239, 0xffff0000, v228
  v_add_f32 v244, v244, v238
  ds_read_b64_tr_b16 v[32:33], v7 offset:0
  ds_read_b64_tr_b16 v[34:35], v7 offset:1792
  s_waitcnt lgkmcnt(6)
  v_mfma_f32_32x32x16_bf16 v[40:55], v[36:39], v[124:127], v[40:55]
  v_add_f32 v245, v245, v239
  v_lshlrev_b32 v238, 16, v229
  v_and_b32 v239, 0xffff0000, v229
  v_add_f32 v246, v246, v238
  v_add_f32 v247, v247, v239
  v_lshlrev_b32 v238, 16, v230
  v_and_b32 v239, 0xffff0000, v230
  v_add_f32 v244, v244, v238
  v_add_f32 v245, v245, v239
  v_lshlrev_b32 v238, 16, v231
  v_and_b32 v239, 0xffff0000, v231
  v_add_f32 v246, v246, v238
  v_add_f32 v247, v247, v239
  v_lshlrev_b32 v238, 16, v232
  ds_read_b64_tr_b16 v[36:37], v7 offset:64
  ds_read_b64_tr_b16 v[38:39], v7 offset:1856
  s_waitcnt lgkmcnt(6)
  v_mfma_f32_32x32x16_bf16 v[56:71], v[24:27], v[124:127], v[56:71]
  v_and_b32 v239, 0xffff0000, v232
  v_add_f32 v244, v244, v238
  v_add_f32 v245, v245, v239
  v_lshlrev_b32 v238, 16, v233
  v_and_b32 v239, 0xffff0000, v233
  v_add_f32 v246, v246, v238
  v_add_f32 v247, v247, v239
  s_lshl_b32 s62, s42, 10
  s_add_u32 s62, s62, 143360
  v_lshlrev_b32 v238, 4, v1
  v_add_u32 v238, s62, v238
  ds_write_b128 v238, v[244:247]
  v_mov_b32 v238, s62
  ds_write_b128 v238, v[212:215] offset:1008
  ds_read_b64_tr_b16 v[24:25], v7 offset:128
  ds_read_b64_tr_b16 v[26:27], v7 offset:1920
  s_waitcnt lgkmcnt(8)
  v_mfma_f32_32x32x16_bf16 v[72:87], v[28:31], v[124:127], v[72:87]
  s_lshl_b32 s92, s40, 3
  s_add_u32 s92, s92, s41
  s_sub_u32 s92, s92, 8
  s_lshl_b32 s92, s92, 3
  s_add_u32 s92, s92, s42
  s_cmp_lt_u32 s92, 640
  s_cselect_b32 s96, s88, s90
  s_cselect_b32 s97, s89, s91
  s_cselect_b32 s93, 0, 640
  s_and_b32 s97, s97, 0xffff
  s_mov_b32 s98, 2211840
  s_mov_b32 s99, 0x20000
  s_sub_u32 s93, s92, s93
  s_mul_i32 s93, s93, 1280
  ds_read_b64_tr_b16 v[28:29], v7 offset:7168
  ds_read_b64_tr_b16 v[30:31], v7 offset:8960
  s_waitcnt lgkmcnt(8)
  v_mfma_f32_32x32x16_bf16 v[40:55], v[32:35], v[128:131], v[40:55]
  v_lshlrev_b32 v176, 4, v1
  v_mov_b32 v177, 0x7ffffff0
  v_cmp_gt_u32 vcc, 16, v1
  s_nop 1
  v_cndmask_b32 v177, v177, v176, vcc
  ds_read_b64_tr_b16 v[32:33], v7 offset:7232
  ds_read_b64_tr_b16 v[34:35], v7 offset:9024
  s_waitcnt lgkmcnt(8)
  v_mfma_f32_32x32x16_bf16 v[56:71], v[36:39], v[128:131], v[56:71]
  buffer_load_dwordx4 v[160:163], v176, s[96:99], s93 offen
  buffer_load_dwordx4 v[164:167], v177, s[96:99], s93 offen offset:1024
  s_mov_b32 s96, s90
  s_and_b32 s97, s91, 0xffff
  ds_read_b64_tr_b16 v[36:37], v7 offset:7296
  ds_read_b64_tr_b16 v[38:39], v7 offset:9088
  s_waitcnt lgkmcnt(6)
  v_mfma_f32_32x32x16_bf16 v[72:87], v[24:27], v[128:131], v[72:87]
  s_add_u32 s93, s92, 1408
  s_mul_i32 s93, s93, 1280
  buffer_load_dwordx4 v[168:171], v176, s[96:99], s93 offen
  buffer_load_dwordx4 v[172:175], v177, s[96:99], s93 offen offset:1024
  s_waitcnt vmcnt(10)
  s_barrier
  ds_read_b128 v[104:107], v10 offset:32768
  ds_read_b128 v[108:111], v11 offset:32768
  ds_read_b128 v[112:115], v12 offset:32768
  ds_read_b128 v[116:119], v13 offset:32768
  s_mov_b32 s50, 774144
  s_add_u32 m0, s45, 15360
  s_nop 0
  buffer_load_dwordx4 v4, s[24:27], s50 offen lds
  s_add_u32 m0, s45, 16384
  s_mov_b32 exec_hi, 0xffff
  buffer_load_dwordx4 v5, s[24:27], s50 offen lds
  s_mov_b64 exec, -1
  ds_read_b64_tr_b16 v[24:25], v7 offset:15360
  ds_read_b64_tr_b16 v[26:27], v7 offset:17152
  s_waitcnt lgkmcnt(10)
  v_mfma_f32_32x32x16_bf16 v[40:55], v[28:31], v[132:135], v[40:55]
  s_mov_b32 s50, 884736
  s_add_u32 m0, s45, 30720
  s_nop 0
  buffer_load_dwordx4 v4, s[24:27], s50 offen lds
  s_add_u32 m0, s45, 31744
  s_mov_b32 exec_hi, 0xffff
  buffer_load_dwordx4 v5, s[24:27], s50 offen lds
  s_mov_b64 exec, -1
  s_add_u32 s50, s49, 512
  s_add_u32 m0, s47, 108544
  s_nop 0
  buffer_load_dwordx4 v8, s[20:23], s50 offen lds
  s_add_u32 m0, s47, 109568
  s_nop 0
  buffer_load_dwordx4 v9, s[20:23], s50 offen lds
  s_add_u32 s93, s92, 384
  s_mul_i32 s93, s93, 1280
  buffer_load_dwordx4 v[184:187], v176, s[96:99], s93 offen
  buffer_load_dwordx4 v[188:191], v177, s[96:99], s93 offen offset:1024
  ds_read_b64_tr_b16 v[28:29], v7 offset:15424
  ds_read_b64_tr_b16 v[30:31], v7 offset:17216
  s_waitcnt lgkmcnt(10)
  v_mfma_f32_32x32x16_bf16 v[56:71], v[32:35], v[132:135], v[56:71]
  v_add_u32 v178, 0, v1
  v_mul_u32_u24 v179, 6554, v178
  v_lshrrev_b32 v179, 16, v179
  v_mul_u32_u24 v180, 10, v179
  ds_read_b64_tr_b16 v[32:33], v7 offset:15488
  ds_read_b64_tr_b16 v[34:35], v7 offset:17280
  s_waitcnt lgkmcnt(10)
  v_mfma_f32_32x32x16_bf16 v[72:87], v[36:39], v[132:135], v[72:87]
  v_sub_u32 v180, v178, v180
  s_mov_b32 s94, 378880
  v_mul_lo_u32 v179, v179, s94
  v_lshl_add_u32 v176, v180, 4, v179
  ds_read_b64_tr_b16 v[36:37], v7 offset:22528
  ds_read_b64_tr_b16 v[38:39], v7 offset:24320
  s_waitcnt lgkmcnt(6)
  v_mfma_f32_32x32x16_bf16 v[40:55], v[24:27], v[104:107], v[40:55]
  v_add_u32 v178, 64, v1
  v_mul_u32_u24 v179, 6554, v178
  v_lshrrev_b32 v179, 16, v179
  v_mul_u32_u24 v180, 10, v179
  ds_read_b64_tr_b16 v[24:25], v7 offset:22592
  ds_read_b64_tr_b16 v[26:27], v7 offset:24384
  s_waitcnt lgkmcnt(6)
  v_mfma_f32_32x32x16_bf16 v[56:71], v[28:31], v[104:107], v[56:71]
  v_sub_u32 v180, v178, v180
  s_mov_b32 s94, 378880
  v_mul_lo_u32 v179, v179, s94
  v_lshl_add_u32 v177, v180, 4, v179
  ds_read_b64_tr_b16 v[28:29], v7 offset:22656
  ds_read_b64_tr_b16 v[30:31], v7 offset:24448
  s_waitcnt lgkmcnt(6)
  v_mfma_f32_32x32x16_bf16 v[72:87], v[32:35], v[104:107], v[72:87]
  v_mov_b32 v178, 0x7ffffff0
  v_cmp_gt_u32 vcc, 16, v1
  s_nop 1
  v_cndmask_b32 v177, v178, v177, vcc
  s_sub_u32 s93, s92, 640
  ds_read_b64_tr_b16 v[32:33], v7 offset:30720
  ds_read_b64_tr_b16 v[34:35], v7 offset:32512
  s_waitcnt lgkmcnt(6)
  v_mfma_f32_32x32x16_bf16 v[40:55], v[36:39], v[108:111], v[40:55]
  s_lshr_b32 s94, s93, 5
  s_mul_i32 s95, s94, 5120
  s_and_b32 s94, s93, 7
  s_and_b32 s101, s93, 8
  ds_read_b64_tr_b16 v[36:37], v7 offset:30784
  ds_read_b64_tr_b16 v[38:39], v7 offset:32576
  s_waitcnt lgkmcnt(6)
  v_mfma_f32_32x32x16_bf16 v[56:71], v[24:27], v[108:111], v[56:71]
  s_lshl_b32 s101, s101, 1
  s_or_b32 s94, s94, s101
  s_and_b32 s101, s93, 16
  s_lshr_b32 s101, s101, 1
  ds_read_b64_tr_b16 v[24:25], v7 offset:30848
  ds_read_b64_tr_b16 v[26:27], v7 offset:32640
  s_waitcnt lgkmcnt(6)
  v_mfma_f32_32x32x16_bf16 v[72:87], v[28:31], v[108:111], v[72:87]
  s_or_b32 s94, s94, s101
  s_mul_i32 s94, s94, 160
  s_add_u32 s95, s95, s94
  s_mov_b32 s100, s95
  ds_read_b64_tr_b16 v[28:29], v7 offset:37888
  ds_read_b64_tr_b16 v[30:31], v7 offset:39680
  s_waitcnt lgkmcnt(6)
  v_mfma_f32_32x32x16_bf16 v[40:55], v[32:35], v[112:115], v[40:55]
  s_mul_i32 s93, s92, 3277
  s_lshr_b32 s93, s93, 16
  s_mul_i32 s94, s93, 20
  s_sub_u32 s94, s92, s94
  ds_read_b64_tr_b16 v[32:33], v7 offset:37952
  ds_read_b64_tr_b16 v[34:35], v7 offset:39744
  s_waitcnt lgkmcnt(6)
  v_mfma_f32_32x32x16_bf16 v[56:71], v[36:39], v[112:115], v[56:71]
  s_lshr_b32 s95, s93, 3
  s_mul_i32 s95, s95, 25600
  s_add_u32 s95, s95, 276480
  s_and_b32 s93, s93, 7
  ds_read_b64_tr_b16 v[36:37], v7 offset:38016
  ds_read_b64_tr_b16 v[38:39], v7 offset:39808
  s_waitcnt lgkmcnt(6)
  v_mfma_f32_32x32x16_bf16 v[72:87], v[24:27], v[112:115], v[72:87]
  s_lshr_b32 s96, s93, 1
  s_mul_i32 s96, s96, 5120
  s_and_b32 s97, s93, 1
  s_lshl_b32 s97, s97, 4
  s_waitcnt vmcnt(6)
  s_barrier
  ds_read_b128 v[120:123], v10 offset:0
  ds_read_b128 v[124:127], v11 offset:0
  ds_read_b128 v[128:131], v12 offset:0
  ds_read_b128 v[132:135], v13 offset:0
  s_mov_b32 s50, 995328
  s_add_u32 m0, s45, 46080
  s_nop 0
  buffer_load_dwordx4 v4, s[24:27], s50 offen lds
  s_add_u32 m0, s45, 47104
  s_mov_b32 exec_hi, 0xffff
  buffer_load_dwordx4 v5, s[24:27], s50 offen lds
  s_mov_b64 exec, -1
  ds_read_b64_tr_b16 v[24:25], v6 offset:0
  ds_read_b64_tr_b16 v[26:27], v6 offset:1792
  s_waitcnt lgkmcnt(10)
  v_mfma_f32_32x32x16_bf16 v[40:55], v[28:31], v[116:119], v[40:55]
  s_mov_b32 s50, 1105920
  s_add_u32 m0, s45, 61440
  s_nop 0
  buffer_load_dwordx4 v4, s[24:27], s50 offen lds
  s_add_u32 m0, s45, 62464
  s_mov_b32 exec_hi, 0xffff
  buffer_load_dwordx4 v5, s[24:27], s50 offen lds
  s_mov_b64 exec, -1
  s_add_u32 s50, s49, 640
  s_add_u32 m0, s47, 124928
  s_nop 0
  buffer_load_dwordx4 v8, s[20:23], s50 offen lds
  s_add_u32 m0, s47, 125952
  s_nop 0
  buffer_load_dwordx4 v9, s[20:23], s50 offen lds
  s_add_u32 s97, s97, s94
  s_mul_i32 s97, s97, 160
  s_add_u32 s96, s96, s97
  s_lshr_b32 s97, s93, 2
  ds_read_b64_tr_b16 v[28:29], v6 offset:64
  ds_read_b64_tr_b16 v[30:31], v6 offset:1856
  s_waitcnt lgkmcnt(10)
  v_mfma_f32_32x32x16_bf16 v[56:71], v[32:35], v[116:119], v[56:71]
  s_lshl_b32 s97, s97, 4
  s_and_b32 s98, s93, 3
  s_add_u32 s97, s97, s98
  s_sub_u32 s98, s94, 16
  ds_read_b64_tr_b16 v[32:33], v6 offset:128
  ds_read_b64_tr_b16 v[34:35], v6 offset:1920
  s_waitcnt lgkmcnt(10)
  v_mfma_f32_32x32x16_bf16 v[72:87], v[36:39], v[116:119], v[72:87]
  s_lshl_b32 s98, s98, 2
  s_add_u32 s97, s97, s98
  s_mul_i32 s97, s97, 160
  s_add_u32 s97, s97, 20480
  ds_read_b64_tr_b16 v[36:37], v6 offset:7168
  ds_read_b64_tr_b16 v[38:39], v6 offset:8960
  s_waitcnt lgkmcnt(6)
  v_mfma_f32_32x32x16_bf16 v[40:55], v[24:27], v[120:123], v[40:55]
  s_cmp_lt_u32 s94, 16
  s_cselect_b32 s96, s96, s97
  s_add_u32 s95, s95, s96
  s_cmp_lt_u32 s92, 640
  s_cselect_b32 s95, s95, s100
  ds_read_b64_tr_b16 v[24:25], v6 offset:7232
  ds_read_b64_tr_b16 v[26:27], v6 offset:9024
  s_waitcnt lgkmcnt(6)
  v_mfma_f32_32x32x16_bf16 v[56:71], v[28:31], v[120:123], v[56:71]
  s_add_u32 s100, s95, 12939264
  s_waitcnt vmcnt(6)
  buffer_store_dwordx4 v[160:163], v176, s[28:31], s100 offen sc1
  buffer_store_dwordx4 v[164:167], v177, s[28:31], s100 offen sc1
  ds_read_b64_tr_b16 v[28:29], v6 offset:7296
  ds_read_b64_tr_b16 v[30:31], v6 offset:9088
  s_waitcnt lgkmcnt(6)
  v_mfma_f32_32x32x16_bf16 v[72:87], v[32:35], v[120:123], v[72:87]
  s_add_u32 s93, s92, 1408
  s_lshr_b32 s94, s93, 5
  s_mul_i32 s95, s94, 5120
  s_and_b32 s94, s93, 7
  ds_read_b64_tr_b16 v[32:33], v6 offset:15360
  ds_read_b64_tr_b16 v[34:35], v6 offset:17152
  s_waitcnt lgkmcnt(6)
  v_mfma_f32_32x32x16_bf16 v[40:55], v[36:39], v[124:127], v[40:55]
  s_and_b32 s101, s93, 8
  s_lshl_b32 s101, s101, 1
  s_or_b32 s94, s94, s101
  s_and_b32 s101, s93, 16
  ds_read_b64_tr_b16 v[36:37], v6 offset:15424
  ds_read_b64_tr_b16 v[38:39], v6 offset:17216
  s_waitcnt lgkmcnt(6)
  v_mfma_f32_32x32x16_bf16 v[56:71], v[24:27], v[124:127], v[56:71]
  s_lshr_b32 s101, s101, 1
  s_or_b32 s94, s94, s101
  s_mul_i32 s94, s94, 160
  s_add_u32 s95, s95, s94
  ds_read_b64_tr_b16 v[24:25], v6 offset:15488
  ds_read_b64_tr_b16 v[26:27], v6 offset:17280
  s_waitcnt lgkmcnt(6)
  v_mfma_f32_32x32x16_bf16 v[72:87], v[28:31], v[124:127], v[72:87]
  s_add_u32 s95, s95, 12939264
  s_cmp_lt_u32 s92, 320
  s_cselect_b32 s95, s95, 0x7ffffff0
  buffer_store_dwordx4 v[168:171], v176, s[28:31], s95 offen sc1
  ds_read_b64_tr_b16 v[28:29], v6 offset:22528
  ds_read_b64_tr_b16 v[30:31], v6 offset:24320
  s_waitcnt lgkmcnt(6)
  v_mfma_f32_32x32x16_bf16 v[40:55], v[32:35], v[128:131], v[40:55]
  buffer_store_dwordx4 v[172:175], v177, s[28:31], s95 offen sc1
  s_add_u32 s93, s92, 384
  s_lshr_b32 s94, s93, 5
  s_mul_i32 s95, s94, 5120
  ds_read_b64_tr_b16 v[32:33], v6 offset:22592
  ds_read_b64_tr_b16 v[34:35], v6 offset:24384
  s_waitcnt lgkmcnt(6)
  v_mfma_f32_32x32x16_bf16 v[56:71], v[36:39], v[128:131], v[56:71]
  s_and_b32 s94, s93, 7
  s_and_b32 s101, s93, 8
  s_lshl_b32 s101, s101, 1
  s_or_b32 s94, s94, s101
  ds_read_b64_tr_b16 v[36:37], v6 offset:22656
  ds_read_b64_tr_b16 v[38:39], v6 offset:24448
  s_waitcnt lgkmcnt(6)
  v_mfma_f32_32x32x16_bf16 v[72:87], v[24:27], v[128:131], v[72:87]
  s_and_b32 s101, s93, 16
  s_lshr_b32 s101, s101, 1
  s_or_b32 s94, s94, s101
  s_mul_i32 s94, s94, 160
  s_waitcnt vmcnt(8)
  s_barrier
  ds_read_b128 v[104:107], v10 offset:16384
  ds_read_b128 v[108:111], v11 offset:16384
  ds_read_b128 v[112:115], v12 offset:16384
  ds_read_b128 v[116:119], v13 offset:16384
  s_mov_b32 s50, 1216512
  s_add_u32 m0, s45, 76800
  s_nop 0
  buffer_load_dwordx4 v4, s[24:27], s50 offen lds
  s_add_u32 m0, s45, 77824
  s_mov_b32 exec_hi, 0xffff
  buffer_load_dwordx4 v5, s[24:27], s50 offen lds
  s_mov_b64 exec, -1
  ds_read_b64_tr_b16 v[24:25], v6 offset:30720
  ds_read_b64_tr_b16 v[26:27], v6 offset:32512
  s_waitcnt lgkmcnt(10)
  v_mfma_f32_32x32x16_bf16 v[40:55], v[28:31], v[132:135], v[40:55]
  s_mov_b32 s50, 1327104
  s_add_u32 m0, s45, 0
  s_nop 0
  buffer_load_dwordx4 v4, s[24:27], s50 offen lds
  s_add_u32 m0, s45, 1024
  s_mov_b32 exec_hi, 0xffff
  buffer_load_dwordx4 v5, s[24:27], s50 offen lds
  s_mov_b64 exec, -1
  s_add_u32 s50, s49, 768
  s_add_u32 m0, s47, 92160
  s_nop 0
  buffer_load_dwordx4 v8, s[20:23], s50 offen lds
  s_add_u32 m0, s47, 93184
  s_nop 0
  buffer_load_dwordx4 v9, s[20:23], s50 offen lds
  s_add_u32 s95, s95, s94
  s_add_u32 s95, s95, 12939264
  buffer_store_dwordx4 v[184:187], v176, s[28:31], s95 offen sc1
  buffer_store_dwordx4 v[188:191], v177, s[28:31], s95 offen sc1
  ds_read_b64_tr_b16 v[28:29], v6 offset:30784
  ds_read_b64_tr_b16 v[30:31], v6 offset:32576
  s_waitcnt lgkmcnt(10)
  v_mfma_f32_32x32x16_bf16 v[56:71], v[32:35], v[132:135], v[56:71]
  ds_read_b64_tr_b16 v[32:33], v6 offset:30848
  ds_read_b64_tr_b16 v[34:35], v6 offset:32640
  s_waitcnt lgkmcnt(10)
  v_mfma_f32_32x32x16_bf16 v[72:87], v[36:39], v[132:135], v[72:87]
  ds_read_b64_tr_b16 v[36:37], v6 offset:37888
  ds_read_b64_tr_b16 v[38:39], v6 offset:39680
  s_waitcnt lgkmcnt(6)
  v_mfma_f32_32x32x16_bf16 v[40:55], v[24:27], v[104:107], v[40:55]
  ds_read_b64_tr_b16 v[24:25], v6 offset:37952
  ds_read_b64_tr_b16 v[26:27], v6 offset:39744
  s_waitcnt lgkmcnt(6)
  v_mfma_f32_32x32x16_bf16 v[56:71], v[28:31], v[104:107], v[56:71]
  ds_read_b64_tr_b16 v[28:29], v6 offset:38016
  ds_read_b64_tr_b16 v[30:31], v6 offset:39808
  s_waitcnt lgkmcnt(6)
  v_mfma_f32_32x32x16_bf16 v[72:87], v[32:35], v[104:107], v[72:87]
  ds_read_b64_tr_b16 v[32:33], v7 offset:0
  ds_read_b64_tr_b16 v[34:35], v7 offset:1792
  s_waitcnt lgkmcnt(6)
  v_mfma_f32_32x32x16_bf16 v[40:55], v[36:39], v[108:111], v[40:55]
  ds_read_b64_tr_b16 v[36:37], v7 offset:64
  ds_read_b64_tr_b16 v[38:39], v7 offset:1856
  s_waitcnt lgkmcnt(6)
  v_mfma_f32_32x32x16_bf16 v[56:71], v[24:27], v[108:111], v[56:71]
  ds_read_b64_tr_b16 v[24:25], v7 offset:128
  ds_read_b64_tr_b16 v[26:27], v7 offset:1920
  s_waitcnt lgkmcnt(6)
  v_mfma_f32_32x32x16_bf16 v[72:87], v[28:31], v[108:111], v[72:87]
  ds_read_b64_tr_b16 v[28:29], v7 offset:7168
  ds_read_b64_tr_b16 v[30:31], v7 offset:8960
  s_waitcnt lgkmcnt(6)
  v_mfma_f32_32x32x16_bf16 v[40:55], v[32:35], v[112:115], v[40:55]
  ds_read_b64_tr_b16 v[32:33], v7 offset:7232
  ds_read_b64_tr_b16 v[34:35], v7 offset:9024
  s_waitcnt lgkmcnt(6)
  v_mfma_f32_32x32x16_bf16 v[56:71], v[36:39], v[112:115], v[56:71]
  ds_read_b64_tr_b16 v[36:37], v7 offset:7296
  ds_read_b64_tr_b16 v[38:39], v7 offset:9088
  s_waitcnt lgkmcnt(6)
  v_mfma_f32_32x32x16_bf16 v[72:87], v[24:27], v[112:115], v[72:87]
  s_waitcnt vmcnt(6)
  s_barrier
  ds_read_b128 v[120:123], v10 offset:32768
  ds_read_b128 v[124:127], v11 offset:32768
  ds_read_b128 v[128:131], v12 offset:32768
  ds_read_b128 v[132:135], v13 offset:32768
  s_mov_b32 s50, 1437696
  s_add_u32 m0, s45, 15360
  s_nop 0
  buffer_load_dwordx4 v4, s[24:27], s50 offen lds
  s_add_u32 m0, s45, 16384
  s_mov_b32 exec_hi, 0xffff
  buffer_load_dwordx4 v5, s[24:27], s50 offen lds
  s_mov_b64 exec, -1
  ds_read_b64_tr_b16 v[24:25], v7 offset:15360
  ds_read_b64_tr_b16 v[26:27], v7 offset:17152
  s_waitcnt lgkmcnt(10)
  v_mfma_f32_32x32x16_bf16 v[40:55], v[28:31], v[116:119], v[40:55]
  s_mov_b32 s50, 1548288
  s_add_u32 m0, s45, 30720
  s_nop 0
  buffer_load_dwordx4 v4, s[24:27], s50 offen lds
  s_add_u32 m0, s45, 31744
  s_mov_b32 exec_hi, 0xffff
  buffer_load_dwordx4 v5, s[24:27], s50 offen lds
  s_mov_b64 exec, -1
  s_add_u32 s50, s49, 896
  s_add_u32 m0, s47, 108544
  s_nop 0
  buffer_load_dwordx4 v8, s[20:23], s50 offen lds
  s_add_u32 m0, s47, 109568
  s_nop 0
  buffer_load_dwordx4 v9, s[20:23], s50 offen lds
  ds_read_b64_tr_b16 v[28:29], v7 offset:15424
  ds_read_b64_tr_b16 v[30:31], v7 offset:17216
  s_waitcnt lgkmcnt(10)
  v_mfma_f32_32x32x16_bf16 v[56:71], v[32:35], v[116:119], v[56:71]
  ds_read_b64_tr_b16 v[32:33], v7 offset:15488
  ds_read_b64_tr_b16 v[34:35], v7 offset:17280
  s_waitcnt lgkmcnt(10)
  v_mfma_f32_32x32x16_bf16 v[72:87], v[36:39], v[116:119], v[72:87]
  ds_read_b64_tr_b16 v[36:37], v7 offset:22528
  ds_read_b64_tr_b16 v[38:39], v7 offset:24320
  s_waitcnt lgkmcnt(6)
  v_mfma_f32_32x32x16_bf16 v[40:55], v[24:27], v[120:123], v[40:55]
  ds_read_b64_tr_b16 v[24:25], v7 offset:22592
  ds_read_b64_tr_b16 v[26:27], v7 offset:24384
  s_waitcnt lgkmcnt(6)
  v_mfma_f32_32x32x16_bf16 v[56:71], v[28:31], v[120:123], v[56:71]
  ds_read_b64_tr_b16 v[28:29], v7 offset:22656
  ds_read_b64_tr_b16 v[30:31], v7 offset:24448
  s_waitcnt lgkmcnt(6)
  v_mfma_f32_32x32x16_bf16 v[72:87], v[32:35], v[120:123], v[72:87]
  ds_read_b64_tr_b16 v[32:33], v7 offset:30720
  ds_read_b64_tr_b16 v[34:35], v7 offset:32512
  s_waitcnt lgkmcnt(6)
  v_mfma_f32_32x32x16_bf16 v[40:55], v[36:39], v[124:127], v[40:55]
  ds_read_b64_tr_b16 v[36:37], v7 offset:30784
  ds_read_b64_tr_b16 v[38:39], v7 offset:32576
  s_waitcnt lgkmcnt(6)
  v_mfma_f32_32x32x16_bf16 v[56:71], v[24:27], v[124:127], v[56:71]
  ds_read_b64_tr_b16 v[24:25], v7 offset:30848
  ds_read_b64_tr_b16 v[26:27], v7 offset:32640
  s_waitcnt lgkmcnt(6)
  v_mfma_f32_32x32x16_bf16 v[72:87], v[28:31], v[124:127], v[72:87]
  ds_read_b64_tr_b16 v[28:29], v7 offset:37888
  ds_read_b64_tr_b16 v[30:31], v7 offset:39680
  s_waitcnt lgkmcnt(6)
  v_mfma_f32_32x32x16_bf16 v[40:55], v[32:35], v[128:131], v[40:55]
  ds_read_b64_tr_b16 v[32:33], v7 offset:37952
  ds_read_b64_tr_b16 v[34:35], v7 offset:39744
  s_waitcnt lgkmcnt(6)
  v_mfma_f32_32x32x16_bf16 v[56:71], v[36:39], v[128:131], v[56:71]
  ds_read_b64_tr_b16 v[36:37], v7 offset:38016
  ds_read_b64_tr_b16 v[38:39], v7 offset:39808
  s_waitcnt lgkmcnt(6)
  v_mfma_f32_32x32x16_bf16 v[72:87], v[24:27], v[128:131], v[72:87]
  s_waitcnt vmcnt(4)
  s_barrier
  ds_read_b128 v[104:107], v10 offset:0
  ds_read_b128 v[108:111], v11 offset:0
  ds_read_b128 v[112:115], v12 offset:0
  ds_read_b128 v[116:119], v13 offset:0
  s_mov_b32 s50, 1658880
  s_add_u32 m0, s45, 46080
  s_nop 0
  buffer_load_dwordx4 v4, s[24:27], s50 offen lds
  s_add_u32 m0, s45, 47104
  s_mov_b32 exec_hi, 0xffff
  buffer_load_dwordx4 v5, s[24:27], s50 offen lds
  s_mov_b64 exec, -1
  ds_read_b64_tr_b16 v[24:25], v6 offset:0
  ds_read_b64_tr_b16 v[26:27], v6 offset:1792
  s_waitcnt lgkmcnt(10)
  v_mfma_f32_32x32x16_bf16 v[40:55], v[28:31], v[132:135], v[40:55]
  s_mov_b32 s50, 1769472
  s_add_u32 m0, s45, 61440
  s_nop 0
  buffer_load_dwordx4 v4, s[24:27], s50 offen lds
  s_add_u32 m0, s45, 62464
  s_mov_b32 exec_hi, 0xffff
  buffer_load_dwordx4 v5, s[24:27], s50 offen lds
  s_mov_b64 exec, -1
  s_add_u32 s50, s49, 1024
  s_add_u32 m0, s47, 124928
  s_nop 0
  buffer_load_dwordx4 v8, s[20:23], s50 offen lds
  s_add_u32 m0, s47, 125952
  s_nop 0
  buffer_load_dwordx4 v9, s[20:23], s50 offen lds
  ds_read_b64_tr_b16 v[28:29], v6 offset:64
  ds_read_b64_tr_b16 v[30:31], v6 offset:1856
  s_waitcnt lgkmcnt(10)
  v_mfma_f32_32x32x16_bf16 v[56:71], v[32:35], v[132:135], v[56:71]
  ds_read_b64_tr_b16 v[32:33], v6 offset:128
  ds_read_b64_tr_b16 v[34:35], v6 offset:1920
  s_waitcnt lgkmcnt(10)
  v_mfma_f32_32x32x16_bf16 v[72:87], v[36:39], v[132:135], v[72:87]
  ds_read_b64_tr_b16 v[36:37], v6 offset:7168
  ds_read_b64_tr_b16 v[38:39], v6 offset:8960
  s_waitcnt lgkmcnt(6)
  v_mfma_f32_32x32x16_bf16 v[40:55], v[24:27], v[104:107], v[40:55]
  ds_read_b64_tr_b16 v[24:25], v6 offset:7232
  ds_read_b64_tr_b16 v[26:27], v6 offset:9024
  s_waitcnt lgkmcnt(6)
  v_mfma_f32_32x32x16_bf16 v[56:71], v[28:31], v[104:107], v[56:71]
  ds_read_b64_tr_b16 v[28:29], v6 offset:7296
  ds_read_b64_tr_b16 v[30:31], v6 offset:9088
  s_waitcnt lgkmcnt(6)
  v_mfma_f32_32x32x16_bf16 v[72:87], v[32:35], v[104:107], v[72:87]
  ds_read_b64_tr_b16 v[32:33], v6 offset:15360
  ds_read_b64_tr_b16 v[34:35], v6 offset:17152
  s_waitcnt lgkmcnt(6)
  v_mfma_f32_32x32x16_bf16 v[40:55], v[36:39], v[108:111], v[40:55]
  ds_read_b64_tr_b16 v[36:37], v6 offset:15424
  ds_read_b64_tr_b16 v[38:39], v6 offset:17216
  s_waitcnt lgkmcnt(6)
  v_mfma_f32_32x32x16_bf16 v[56:71], v[24:27], v[108:111], v[56:71]
  ds_read_b64_tr_b16 v[24:25], v6 offset:15488
  ds_read_b64_tr_b16 v[26:27], v6 offset:17280
  s_waitcnt lgkmcnt(6)
  v_mfma_f32_32x32x16_bf16 v[72:87], v[28:31], v[108:111], v[72:87]
  ds_read_b64_tr_b16 v[28:29], v6 offset:22528
  ds_read_b64_tr_b16 v[30:31], v6 offset:24320
  s_waitcnt lgkmcnt(6)
  v_mfma_f32_32x32x16_bf16 v[40:55], v[32:35], v[112:115], v[40:55]
  ds_read_b64_tr_b16 v[32:33], v6 offset:22592
  ds_read_b64_tr_b16 v[34:35], v6 offset:24384
  s_waitcnt lgkmcnt(6)
  v_mfma_f32_32x32x16_bf16 v[56:71], v[36:39], v[112:115], v[56:71]
  ds_read_b64_tr_b16 v[36:37], v6 offset:22656
  ds_read_b64_tr_b16 v[38:39], v6 offset:24448
  s_waitcnt lgkmcnt(6)
  v_mfma_f32_32x32x16_bf16 v[72:87], v[24:27], v[112:115], v[72:87]
  s_waitcnt vmcnt(4)
  s_barrier
  ds_read_b128 v[120:123], v10 offset:16384
  ds_read_b128 v[124:127], v11 offset:16384
  ds_read_b128 v[128:131], v12 offset:16384
  ds_read_b128 v[132:135], v13 offset:16384
  s_mov_b32 s50, 1880064
  s_add_u32 m0, s45, 76800
  s_nop 0
  buffer_load_dwordx4 v4, s[24:27], s50 offen lds
  s_add_u32 m0, s45, 77824
  s_mov_b32 exec_hi, 0xffff
  buffer_load_dwordx4 v5, s[24:27], s50 offen lds
  s_mov_b64 exec, -1
  ds_read_b64_tr_b16 v[24:25], v6 offset:30720
  ds_read_b64_tr_b16 v[26:27], v6 offset:32512
  s_waitcnt lgkmcnt(10)
  v_mfma_f32_32x32x16_bf16 v[40:55], v[28:31], v[116:119], v[40:55]
  s_mov_b32 s50, 1990656
  s_add_u32 m0, s45, 0
  s_nop 0
  buffer_load_dwordx4 v4, s[24:27], s50 offen lds
  s_add_u32 m0, s45, 1024
  s_mov_b32 exec_hi, 0xffff
  buffer_load_dwordx4 v5, s[24:27], s50 offen lds
  s_mov_b64 exec, -1
  s_add_u32 s50, s49, 1152
  s_add_u32 m0, s47, 92160
  s_nop 0
  buffer_load_dwordx4 v8, s[20:23], s50 offen lds
  s_add_u32 m0, s47, 93184
  s_nop 0
  buffer_load_dwordx4 v9, s[20:23], s50 offen lds
  ds_read_b64_tr_b16 v[28:29], v6 offset:30784
  ds_read_b64_tr_b16 v[30:31], v6 offset:32576
  s_waitcnt lgkmcnt(10)
  v_mfma_f32_32x32x16_bf16 v[56:71], v[32:35], v[116:119], v[56:71]
  ds_read_b64_tr_b16 v[32:33], v6 offset:30848
  ds_read_b64_tr_b16 v[34:35], v6 offset:32640
  s_waitcnt lgkmcnt(10)
  v_mfma_f32_32x32x16_bf16 v[72:87], v[36:39], v[116:119], v[72:87]
  ds_read_b64_tr_b16 v[36:37], v6 offset:37888
  ds_read_b64_tr_b16 v[38:39], v6 offset:39680
  s_waitcnt lgkmcnt(6)
  v_mfma_f32_32x32x16_bf16 v[40:55], v[24:27], v[120:123], v[40:55]
  ds_read_b64_tr_b16 v[24:25], v6 offset:37952
  ds_read_b64_tr_b16 v[26:27], v6 offset:39744
  s_waitcnt lgkmcnt(6)
  v_mfma_f32_32x32x16_bf16 v[56:71], v[28:31], v[120:123], v[56:71]
  ds_read_b64_tr_b16 v[28:29], v6 offset:38016
  ds_read_b64_tr_b16 v[30:31], v6 offset:39808
  s_waitcnt lgkmcnt(6)
  v_mfma_f32_32x32x16_bf16 v[72:87], v[32:35], v[120:123], v[72:87]
  ds_read_b64_tr_b16 v[32:33], v7 offset:0
  ds_read_b64_tr_b16 v[34:35], v7 offset:1792
  s_waitcnt lgkmcnt(6)
  v_mfma_f32_32x32x16_bf16 v[40:55], v[36:39], v[124:127], v[40:55]
  ds_read_b64_tr_b16 v[36:37], v7 offset:64
  ds_read_b64_tr_b16 v[38:39], v7 offset:1856
  s_waitcnt lgkmcnt(6)
  v_mfma_f32_32x32x16_bf16 v[56:71], v[24:27], v[124:127], v[56:71]
  ds_read_b64_tr_b16 v[24:25], v7 offset:128
  ds_read_b64_tr_b16 v[26:27], v7 offset:1920
  s_waitcnt lgkmcnt(6)
  v_mfma_f32_32x32x16_bf16 v[72:87], v[28:31], v[124:127], v[72:87]
  ds_read_b64_tr_b16 v[28:29], v7 offset:7168
  ds_read_b64_tr_b16 v[30:31], v7 offset:8960
  s_waitcnt lgkmcnt(6)
  v_mfma_f32_32x32x16_bf16 v[40:55], v[32:35], v[128:131], v[40:55]
  ds_read_b64_tr_b16 v[32:33], v7 offset:7232
  ds_read_b64_tr_b16 v[34:35], v7 offset:9024
  s_waitcnt lgkmcnt(6)
  v_mfma_f32_32x32x16_bf16 v[56:71], v[36:39], v[128:131], v[56:71]
  ds_read_b64_tr_b16 v[36:37], v7 offset:7296
  ds_read_b64_tr_b16 v[38:39], v7 offset:9088
  s_waitcnt lgkmcnt(6)
  v_mfma_f32_32x32x16_bf16 v[72:87], v[24:27], v[128:131], v[72:87]
  s_waitcnt vmcnt(4)
  s_barrier
  ds_read_b128 v[104:107], v10 offset:32768
  ds_read_b128 v[108:111], v11 offset:32768
  ds_read_b128 v[112:115], v12 offset:32768
  ds_read_b128 v[116:119], v13 offset:32768
  s_mov_b32 s50, 2101248
  s_add_u32 m0, s45, 15360
  s_nop 0
  buffer_load_dwordx4 v4, s[24:27], s50 offen lds
  s_add_u32 m0, s45, 16384
  s_mov_b32 exec_hi, 0xffff
  buffer_load_dwordx4 v5, s[24:27], s50 offen lds
  s_mov_b64 exec, -1
  ds_read_b64_tr_b16 v[24:25], v7 offset:15360
  ds_read_b64_tr_b16 v[26:27], v7 offset:17152
  s_waitcnt lgkmcnt(10)
  v_mfma_f32_32x32x16_bf16 v[40:55], v[28:31], v[132:135], v[40:55]
  ds_read_b64_tr_b16 v[28:29], v7 offset:15424
  ds_read_b64_tr_b16 v[30:31], v7 offset:17216
  s_waitcnt lgkmcnt(10)
  v_mfma_f32_32x32x16_bf16 v[56:71], v[32:35], v[132:135], v[56:71]
  ds_read_b64_tr_b16 v[32:33], v7 offset:15488
  ds_read_b64_tr_b16 v[34:35], v7 offset:17280
  s_waitcnt lgkmcnt(10)
  v_mfma_f32_32x32x16_bf16 v[72:87], v[36:39], v[132:135], v[72:87]
  ds_read_b64_tr_b16 v[36:37], v7 offset:22528
  ds_read_b64_tr_b16 v[38:39], v7 offset:24320
  s_waitcnt lgkmcnt(6)
  v_mfma_f32_32x32x16_bf16 v[40:55], v[24:27], v[104:107], v[40:55]
  ds_read_b64_tr_b16 v[24:25], v7 offset:22592
  ds_read_b64_tr_b16 v[26:27], v7 offset:24384
  s_waitcnt lgkmcnt(6)
  v_mfma_f32_32x32x16_bf16 v[56:71], v[28:31], v[104:107], v[56:71]
  ds_read_b64_tr_b16 v[28:29], v7 offset:22656
  ds_read_b64_tr_b16 v[30:31], v7 offset:24448
  s_waitcnt lgkmcnt(6)
  v_mfma_f32_32x32x16_bf16 v[72:87], v[32:35], v[104:107], v[72:87]
  ds_read_b64_tr_b16 v[32:33], v7 offset:30720
  ds_read_b64_tr_b16 v[34:35], v7 offset:32512
  s_waitcnt lgkmcnt(6)
  v_mfma_f32_32x32x16_bf16 v[40:55], v[36:39], v[108:111], v[40:55]
  ds_read_b64_tr_b16 v[36:37], v7 offset:30784
  ds_read_b64_tr_b16 v[38:39], v7 offset:32576
  s_waitcnt lgkmcnt(6)
  v_mfma_f32_32x32x16_bf16 v[56:71], v[24:27], v[108:111], v[56:71]
  ds_read_b64_tr_b16 v[24:25], v7 offset:30848
  ds_read_b64_tr_b16 v[26:27], v7 offset:32640
  s_waitcnt lgkmcnt(6)
  v_mfma_f32_32x32x16_bf16 v[72:87], v[28:31], v[108:111], v[72:87]
  ds_read_b64_tr_b16 v[28:29], v7 offset:37888
  ds_read_b64_tr_b16 v[30:31], v7 offset:39680
  s_waitcnt lgkmcnt(6)
  v_mfma_f32_32x32x16_bf16 v[40:55], v[32:35], v[112:115], v[40:55]
  ds_read_b64_tr_b16 v[32:33], v7 offset:37952
  ds_read_b64_tr_b16 v[34:35], v7 offset:39744
  s_waitcnt lgkmcnt(6)
  v_mfma_f32_32x32x16_bf16 v[56:71], v[36:39], v[112:115], v[56:71]
  ds_read_b64_tr_b16 v[36:37], v7 offset:38016
  ds_read_b64_tr_b16 v[38:39], v7 offset:39808
  s_waitcnt lgkmcnt(6)
  v_mfma_f32_32x32x16_bf16 v[72:87], v[24:27], v[112:115], v[72:87]
  s_waitcnt vmcnt(0)
  s_barrier
  ds_read_b128 v[120:123], v10 offset:0
  ds_read_b128 v[124:127], v11 offset:0
  ds_read_b128 v[128:131], v12 offset:0
  ds_read_b128 v[132:135], v13 offset:0
  ds_read_b64_tr_b16 v[24:25], v6 offset:0
  ds_read_b64_tr_b16 v[26:27], v6 offset:1792
  s_waitcnt lgkmcnt(10)
  v_mfma_f32_32x32x16_bf16 v[40:55], v[28:31], v[116:119], v[40:55]
  ds_read_b64_tr_b16 v[28:29], v6 offset:64
  ds_read_b64_tr_b16 v[30:31], v6 offset:1856
  s_waitcnt lgkmcnt(10)
  v_mfma_f32_32x32x16_bf16 v[56:71], v[32:35], v[116:119], v[56:71]
  ds_read_b64_tr_b16 v[32:33], v6 offset:128
  ds_read_b64_tr_b16 v[34:35], v6 offset:1920
  s_waitcnt lgkmcnt(10)
  v_mfma_f32_32x32x16_bf16 v[72:87], v[36:39], v[116:119], v[72:87]
  s_lshl_b32 s46, s40, 10
  s_lshl_b32 s54, s43, 8
  s_add_u32 s46, s46, s54
  s_add_u32 s46, s46, 12644352
  v_lshlrev_b32 v22, 3, v16
  buffer_load_dwordx2 v[14:15], v22, s[28:31], s46 offen sc1
  ds_read_b64_tr_b16 v[36:37], v6 offset:7168
  ds_read_b64_tr_b16 v[38:39], v6 offset:8960
  s_waitcnt lgkmcnt(6)
  v_mfma_f32_32x32x16_bf16 v[40:55], v[24:27], v[120:123], v[40:55]
  ds_read_b64_tr_b16 v[24:25], v6 offset:7232
  ds_read_b64_tr_b16 v[26:27], v6 offset:9024
  s_waitcnt lgkmcnt(6)
  v_mfma_f32_32x32x16_bf16 v[56:71], v[28:31], v[120:123], v[56:71]
  ds_read_b64_tr_b16 v[28:29], v6 offset:7296
  ds_read_b64_tr_b16 v[30:31], v6 offset:9088
  s_waitcnt lgkmcnt(6)
  v_mfma_f32_32x32x16_bf16 v[72:87], v[32:35], v[120:123], v[72:87]
  ds_read_b64_tr_b16 v[32:33], v6 offset:15360
  ds_read_b64_tr_b16 v[34:35], v6 offset:17152
  s_waitcnt lgkmcnt(6)
  v_mfma_f32_32x32x16_bf16 v[40:55], v[36:39], v[124:127], v[40:55]
  ds_read_b64_tr_b16 v[36:37], v6 offset:15424
  ds_read_b64_tr_b16 v[38:39], v6 offset:17216
  s_waitcnt lgkmcnt(6)
  v_mfma_f32_32x32x16_bf16 v[56:71], v[24:27], v[124:127], v[56:71]
  ds_read_b64_tr_b16 v[24:25], v6 offset:15488
  ds_read_b64_tr_b16 v[26:27], v6 offset:17280
  s_waitcnt lgkmcnt(6)
  v_mfma_f32_32x32x16_bf16 v[72:87], v[28:31], v[124:127], v[72:87]
  ds_read_b64_tr_b16 v[28:29], v6 offset:22528
  ds_read_b64_tr_b16 v[30:31], v6 offset:24320
  s_waitcnt lgkmcnt(6)
  v_mfma_f32_32x32x16_bf16 v[40:55], v[32:35], v[128:131], v[40:55]
  ds_read_b64_tr_b16 v[32:33], v6 offset:22592
  ds_read_b64_tr_b16 v[34:35], v6 offset:24384
  s_waitcnt lgkmcnt(6)
  v_mfma_f32_32x32x16_bf16 v[56:71], v[36:39], v[128:131], v[56:71]
  ds_read_b64_tr_b16 v[36:37], v6 offset:22656
  ds_read_b64_tr_b16 v[38:39], v6 offset:24448
  s_waitcnt lgkmcnt(6)
  v_mfma_f32_32x32x16_bf16 v[72:87], v[24:27], v[128:131], v[72:87]
  s_waitcnt lgkmcnt(4)
  v_mfma_f32_32x32x16_bf16 v[40:55], v[28:31], v[132:135], v[40:55]
  s_waitcnt lgkmcnt(2)
  v_mfma_f32_32x32x16_bf16 v[56:71], v[32:35], v[132:135], v[56:71]
  s_waitcnt lgkmcnt(0)
  v_mfma_f32_32x32x16_bf16 v[72:87], v[36:39], v[132:135], v[72:87]
  s_waitcnt vmcnt(0)
  s_barrier
  v_lshlrev_b32 v253, 4, v17
  v_add_u32 v253, 141824, v253
  v_mov_b32 v248, 2.0
  v_mov_b32 v249, s48
  v_mov_b32 v250, -2.0
  v_mov_b32 v251, 1.0
  ds_read_b128 v[152:155], v253 offset:0
  ds_read_b128 v[156:159], v253 offset:32
  ds_read_b128 v[160:163], v253 offset:64
  ds_read_b128 v[164:167], v253 offset:96
  ds_read_b128 v[168:171], v253 offset:1024
  ds_read_b128 v[172:175], v253 offset:1056
  ds_read_b128 v[176:179], v253 offset:1088
  ds_read_b128 v[180:183], v253 offset:1120
  s_lshl_b32 s46, s40, 3
  s_lshl_b32 s54, s43, 1
  s_add_u32 s46, s46, s54
  s_mul_i32 s46, s46, 54
  s_add_u32 s46, s46, s56
  s_lshl_b32 s46, s46, 10
  s_add_u32 s46, s46, 4096
  v_and_b32 v252, 1, v3
  v_mul_u32_u24 v252, 55296, v252
  v_lshl_add_u32 v252, v2, 4, v252
  v_lshl_add_u32 v252, v17, 8, v252
  ds_read_b128 v[184:187], v253 offset:128
  ds_read_b128 v[188:191], v253 offset:160
  ds_read_b128 v[192:195], v253 offset:192
  ds_read_b128 v[196:199], v253 offset:224
  ds_read_b128 v[200:203], v253 offset:1152
  ds_read_b128 v[204:207], v253 offset:1184
  ds_read_b128 v[208:211], v253 offset:1216
  ds_read_b128 v[212:215], v253 offset:1248
  s_waitcnt lgkmcnt(8)
  v_fma_f32 v40, v152, v14, v40
  v_fma_f32 v41, v153, v14, v41
  v_fma_f32 v42, v154, v14, v42
  v_fma_f32 v43, v155, v14, v43
  v_fma_f32 v44, v156, v14, v44
  v_fma_f32 v45, v157, v14, v45
  v_fma_f32 v46, v158, v14, v46
  v_fma_f32 v47, v159, v14, v47
  v_fma_f32 v40, v40, v15, v168
  v_fma_f32 v41, v41, v15, v169
  v_fma_f32 v42, v42, v15, v170
  v_fma_f32 v43, v43, v15, v171
  v_fma_f32 v44, v44, v15, v172
  v_fma_f32 v45, v45, v15, v173
  v_fma_f32 v46, v46, v15, v174
  v_fma_f32 v47, v47, v15, v175
  v_mul_f32 v216, v40, v249
  v_mul_f32 v217, v41, v249
  v_mul_f32 v218, v42, v249
  v_mul_f32 v219, v43, v249
  v_mul_f32 v220, v44, v249
  v_mul_f32 v221, v45, v249
  v_mul_f32 v222, v46, v249
  v_mul_f32 v223, v47, v249
  v_exp_f32 v216, v216
  v_exp_f32 v217, v217
  v_exp_f32 v218, v218
  v_exp_f32 v219, v219
  v_exp_f32 v220, v220
  v_exp_f32 v221, v221
  v_exp_f32 v222, v222
  v_exp_f32 v223, v223
  v_add_f32 v224, v216, v248
  v_add_f32 v225, v217, v248
  v_add_f32 v226, v218, v248
  v_add_f32 v227, v219, v248
  v_add_f32 v228, v220, v248
  v_add_f32 v229, v221, v248
  v_add_f32 v230, v222, v248
  v_add_f32 v231, v223, v248
  v_fma_f32 v224, v216, v224, v248
  v_fma_f32 v225, v217, v225, v248
  v_fma_f32 v226, v218, v226, v248
  v_fma_f32 v227, v219, v227, v248
  v_fma_f32 v228, v220, v228, v248
  v_fma_f32 v229, v221, v229, v248
  v_fma_f32 v230, v222, v230, v248
  v_fma_f32 v231, v223, v231, v248
  v_rcp_f32 v224, v224
  v_rcp_f32 v225, v225
  v_rcp_f32 v226, v226
  v_rcp_f32 v227, v227
  v_rcp_f32 v228, v228
  v_rcp_f32 v229, v229
  v_rcp_f32 v230, v230
  v_rcp_f32 v231, v231
  v_fma_f32 v224, v224, v250, v251
  v_fma_f32 v225, v225, v250, v251
  v_fma_f32 v226, v226, v250, v251
  v_fma_f32 v227, v227, v250, v251
  v_fma_f32 v228, v228, v250, v251
  v_fma_f32 v229, v229, v250, v251
  v_fma_f32 v230, v230, v250, v251
  v_fma_f32 v231, v231, v250, v251
  v_mul_f32 v40, v40, v224
  v_mul_f32 v41, v41, v225
  v_mul_f32 v42, v42, v226
  v_mul_f32 v43, v43, v227
  v_mul_f32 v44, v44, v228
  v_mul_f32 v45, v45, v229
  v_mul_f32 v46, v46, v230
  v_mul_f32 v47, v47, v231
  v_cvt_pk_bf16_f32 v232, v40, v41
  v_cvt_pk_bf16_f32 v233, v42, v43
  v_cvt_pk_bf16_f32 v234, v44, v45
  v_cvt_pk_bf16_f32 v235, v46, v47
  buffer_store_dwordx4 v[232:235], v252, s[28:31], s46 offen offset:0 sc1
  v_fma_f32 v48, v160, v14, v48
  v_fma_f32 v49, v161, v14, v49
  v_fma_f32 v50, v162, v14, v50
  v_fma_f32 v51, v163, v14, v51
  v_fma_f32 v52, v164, v14, v52
  v_fma_f32 v53, v165, v14, v53
  v_fma_f32 v54, v166, v14, v54
  v_fma_f32 v55, v167, v14, v55
  v_fma_f32 v48, v48, v15, v176
  v_fma_f32 v49, v49, v15, v177
  v_fma_f32 v50, v50, v15, v178
  v_fma_f32 v51, v51, v15, v179
  v_fma_f32 v52, v52, v15, v180
  v_fma_f32 v53, v53, v15, v181
  v_fma_f32 v54, v54, v15, v182
  v_fma_f32 v55, v55, v15, v183
  v_mul_f32 v216, v48, v249
  v_mul_f32 v217, v49, v249
  v_mul_f32 v218, v50, v249
  v_mul_f32 v219, v51, v249
  v_mul_f32 v220, v52, v249
  v_mul_f32 v221, v53, v249
  v_mul_f32 v222, v54, v249
  v_mul_f32 v223, v55, v249
  v_exp_f32 v216, v216
  v_exp_f32 v217, v217
  v_exp_f32 v218, v218
  v_exp_f32 v219, v219
  v_exp_f32 v220, v220
  v_exp_f32 v221, v221
  v_exp_f32 v222, v222
  v_exp_f32 v223, v223
  v_add_f32 v224, v216, v248
  v_add_f32 v225, v217, v248
  v_add_f32 v226, v218, v248
  v_add_f32 v227, v219, v248
  v_add_f32 v228, v220, v248
  v_add_f32 v229, v221, v248
  v_add_f32 v230, v222, v248
  v_add_f32 v231, v223, v248
  v_fma_f32 v224, v216, v224, v248
  v_fma_f32 v225, v217, v225, v248
  v_fma_f32 v226, v218, v226, v248
  v_fma_f32 v227, v219, v227, v248
  v_fma_f32 v228, v220, v228, v248
  v_fma_f32 v229, v221, v229, v248
  v_fma_f32 v230, v222, v230, v248
  v_fma_f32 v231, v223, v231, v248
  v_rcp_f32 v224, v224
  v_rcp_f32 v225, v225
  v_rcp_f32 v226, v226
  v_rcp_f32 v227, v227
  v_rcp_f32 v228, v228
  v_rcp_f32 v229, v229
  v_rcp_f32 v230, v230
  v_rcp_f32 v231, v231
  v_fma_f32 v224, v224, v250, v251
  v_fma_f32 v225, v225, v250, v251
  v_fma_f32 v226, v226, v250, v251
  v_fma_f32 v227, v227, v250, v251
  v_fma_f32 v228, v228, v250, v251
  v_fma_f32 v229, v229, v250, v251
  v_fma_f32 v230, v230, v250, v251
  v_fma_f32 v231, v231, v250, v251
  v_mul_f32 v48, v48, v224
  v_mul_f32 v49, v49, v225
  v_mul_f32 v50, v50, v226
  v_mul_f32 v51, v51, v227
  v_mul_f32 v52, v52, v228
  v_mul_f32 v53, v53, v229
  v_mul_f32 v54, v54, v230
  v_mul_f32 v55, v55, v231
  v_cvt_pk_bf16_f32 v236, v48, v49
  v_cvt_pk_bf16_f32 v237, v50, v51
  v_cvt_pk_bf16_f32 v238, v52, v53
  v_cvt_pk_bf16_f32 v239, v54, v55
  buffer_store_dwordx4 v[236:239], v252, s[28:31], s46 offen offset:512 sc1
  ds_read_b128 v[152:155], v253 offset:256
  ds_read_b128 v[156:159], v253 offset:288
  ds_read_b128 v[160:163], v253 offset:320
  ds_read_b128 v[164:167], v253 offset:352
  ds_read_b128 v[168:171], v253 offset:1280
  ds_read_b128 v[172:175], v253 offset:1312
  ds_read_b128 v[176:179], v253 offset:1344
  ds_read_b128 v[180:183], v253 offset:1376
  s_waitcnt lgkmcnt(8)
  v_fma_f32 v56, v184, v14, v56
  v_fma_f32 v57, v185, v14, v57
  v_fma_f32 v58, v186, v14, v58
  v_fma_f32 v59, v187, v14, v59
  v_fma_f32 v60, v188, v14, v60
  v_fma_f32 v61, v189, v14, v61
  v_fma_f32 v62, v190, v14, v62
  v_fma_f32 v63, v191, v14, v63
  v_fma_f32 v56, v56, v15, v200
  v_fma_f32 v57, v57, v15, v201
  v_fma_f32 v58, v58, v15, v202
  v_fma_f32 v59, v59, v15, v203
  v_fma_f32 v60, v60, v15, v204
  v_fma_f32 v61, v61, v15, v205
  v_fma_f32 v62, v62, v15, v206
  v_fma_f32 v63, v63, v15, v207
  v_mul_f32 v216, v56, v249
  v_mul_f32 v217, v57, v249
  v_mul_f32 v218, v58, v249
  v_mul_f32 v219, v59, v249
  v_mul_f32 v220, v60, v249
  v_mul_f32 v221, v61, v249
  v_mul_f32 v222, v62, v249
  v_mul_f32 v223, v63, v249
  v_exp_f32 v216, v216
  v_exp_f32 v217, v217
  v_exp_f32 v218, v218
  v_exp_f32 v219, v219
  v_exp_f32 v220, v220
  v_exp_f32 v221, v221
  v_exp_f32 v222, v222
  v_exp_f32 v223, v223
  v_add_f32 v224, v216, v248
  v_add_f32 v225, v217, v248
  v_add_f32 v226, v218, v248
  v_add_f32 v227, v219, v248
  v_add_f32 v228, v220, v248
  v_add_f32 v229, v221, v248
  v_add_f32 v230, v222, v248
  v_add_f32 v231, v223, v248
  v_fma_f32 v224, v216, v224, v248
  v_fma_f32 v225, v217, v225, v248
  v_fma_f32 v226, v218, v226, v248
  v_fma_f32 v227, v219, v227, v248
  v_fma_f32 v228, v220, v228, v248
  v_fma_f32 v229, v221, v229, v248
  v_fma_f32 v230, v222, v230, v248
  v_fma_f32 v231, v223, v231, v248
  v_rcp_f32 v224, v224
  v_rcp_f32 v225, v225
  v_rcp_f32 v226, v226
  v_rcp_f32 v227, v227
  v_rcp_f32 v228, v228
  v_rcp_f32 v229, v229
  v_rcp_f32 v230, v230
  v_rcp_f32 v231, v231
  v_fma_f32 v224, v224, v250, v251
  v_fma_f32 v225, v225, v250, v251
  v_fma_f32 v226, v226, v250, v251
  v_fma_f32 v227, v227, v250, v251
  v_fma_f32 v228, v228, v250, v251
  v_fma_f32 v229, v229, v250, v251
  v_fma_f32 v230, v230, v250, v251
  v_fma_f32 v231, v231, v250, v251
  v_mul_f32 v56, v56, v224
  v_mul_f32 v57, v57, v225
  v_mul_f32 v58, v58, v226
  v_mul_f32 v59, v59, v227
  v_mul_f32 v60, v60, v228
  v_mul_f32 v61, v61, v229
  v_mul_f32 v62, v62, v230
  v_mul_f32 v63, v63, v231
  v_cvt_pk_bf16_f32 v240, v56, v57
  v_cvt_pk_bf16_f32 v241, v58, v59
  v_cvt_pk_bf16_f32 v242, v60, v61
  v_cvt_pk_bf16_f32 v243, v62, v63
  buffer_store_dwordx4 v[240:243], v252, s[28:31], s46 offen offset:1024 sc1
  v_fma_f32 v64, v192, v14, v64
  v_fma_f32 v65, v193, v14, v65
  v_fma_f32 v66, v194, v14, v66
  v_fma_f32 v67, v195, v14, v67
  v_fma_f32 v68, v196, v14, v68
  v_fma_f32 v69, v197, v14, v69
  v_fma_f32 v70, v198, v14, v70
  v_fma_f32 v71, v199, v14, v71
  v_fma_f32 v64, v64, v15, v208
  v_fma_f32 v65, v65, v15, v209
  v_fma_f32 v66, v66, v15, v210
  v_fma_f32 v67, v67, v15, v211
  v_fma_f32 v68, v68, v15, v212
  v_fma_f32 v69, v69, v15, v213
  v_fma_f32 v70, v70, v15, v214
  v_fma_f32 v71, v71, v15, v215
  v_mul_f32 v216, v64, v249
  v_mul_f32 v217, v65, v249
  v_mul_f32 v218, v66, v249
  v_mul_f32 v219, v67, v249
  v_mul_f32 v220, v68, v249
  v_mul_f32 v221, v69, v249
  v_mul_f32 v222, v70, v249
  v_mul_f32 v223, v71, v249
  v_exp_f32 v216, v216
  v_exp_f32 v217, v217
  v_exp_f32 v218, v218
  v_exp_f32 v219, v219
  v_exp_f32 v220, v220
  v_exp_f32 v221, v221
  v_exp_f32 v222, v222
  v_exp_f32 v223, v223
  v_add_f32 v224, v216, v248
  v_add_f32 v225, v217, v248
  v_add_f32 v226, v218, v248
  v_add_f32 v227, v219, v248
  v_add_f32 v228, v220, v248
  v_add_f32 v229, v221, v248
  v_add_f32 v230, v222, v248
  v_add_f32 v231, v223, v248
  v_fma_f32 v224, v216, v224, v248
  v_fma_f32 v225, v217, v225, v248
  v_fma_f32 v226, v218, v226, v248
  v_fma_f32 v227, v219, v227, v248
  v_fma_f32 v228, v220, v228, v248
  v_fma_f32 v229, v221, v229, v248
  v_fma_f32 v230, v222, v230, v248
  v_fma_f32 v231, v223, v231, v248
  v_rcp_f32 v224, v224
  v_rcp_f32 v225, v225
  v_rcp_f32 v226, v226
  v_rcp_f32 v227, v227
  v_rcp_f32 v228, v228
  v_rcp_f32 v229, v229
  v_rcp_f32 v230, v230
  v_rcp_f32 v231, v231
  v_fma_f32 v224, v224, v250, v251
  v_fma_f32 v225, v225, v250, v251
  v_fma_f32 v226, v226, v250, v251
  v_fma_f32 v227, v227, v250, v251
  v_fma_f32 v228, v228, v250, v251
  v_fma_f32 v229, v229, v250, v251
  v_fma_f32 v230, v230, v250, v251
  v_fma_f32 v231, v231, v250, v251
  v_mul_f32 v64, v64, v224
  v_mul_f32 v65, v65, v225
  v_mul_f32 v66, v66, v226
  v_mul_f32 v67, v67, v227
  v_mul_f32 v68, v68, v228
  v_mul_f32 v69, v69, v229
  v_mul_f32 v70, v70, v230
  v_mul_f32 v71, v71, v231
  v_cvt_pk_bf16_f32 v244, v64, v65
  v_cvt_pk_bf16_f32 v245, v66, v67
  v_cvt_pk_bf16_f32 v246, v68, v69
  v_cvt_pk_bf16_f32 v247, v70, v71
  buffer_store_dwordx4 v[244:247], v252, s[28:31], s46 offen offset:1536 sc1
  s_waitcnt lgkmcnt(0)
  v_fma_f32 v72, v152, v14, v72
  v_fma_f32 v73, v153, v14, v73
  v_fma_f32 v74, v154, v14, v74
  v_fma_f32 v75, v155, v14, v75
  v_fma_f32 v76, v156, v14, v76
  v_fma_f32 v77, v157, v14, v77
  v_fma_f32 v78, v158, v14, v78
  v_fma_f32 v79, v159, v14, v79
  v_fma_f32 v72, v72, v15, v168
  v_fma_f32 v73, v73, v15, v169
  v_fma_f32 v74, v74, v15, v170
  v_fma_f32 v75, v75, v15, v171
  v_fma_f32 v76, v76, v15, v172
  v_fma_f32 v77, v77, v15, v173
  v_fma_f32 v78, v78, v15, v174
  v_fma_f32 v79, v79, v15, v175
  v_mul_f32 v216, v72, v249
  v_mul_f32 v217, v73, v249
  v_mul_f32 v218, v74, v249
  v_mul_f32 v219, v75, v249
  v_mul_f32 v220, v76, v249
  v_mul_f32 v221, v77, v249
  v_mul_f32 v222, v78, v249
  v_mul_f32 v223, v79, v249
  v_exp_f32 v216, v216
  v_exp_f32 v217, v217
  v_exp_f32 v218, v218
  v_exp_f32 v219, v219
  v_exp_f32 v220, v220
  v_exp_f32 v221, v221
  v_exp_f32 v222, v222
  v_exp_f32 v223, v223
  v_add_f32 v224, v216, v248
  v_add_f32 v225, v217, v248
  v_add_f32 v226, v218, v248
  v_add_f32 v227, v219, v248
  v_add_f32 v228, v220, v248
  v_add_f32 v229, v221, v248
  v_add_f32 v230, v222, v248
  v_add_f32 v231, v223, v248
  v_fma_f32 v224, v216, v224, v248
  v_fma_f32 v225, v217, v225, v248
  v_fma_f32 v226, v218, v226, v248
  v_fma_f32 v227, v219, v227, v248
  v_fma_f32 v228, v220, v228, v248
  v_fma_f32 v229, v221, v229, v248
  v_fma_f32 v230, v222, v230, v248
  v_fma_f32 v231, v223, v231, v248
  v_rcp_f32 v224, v224
  v_rcp_f32 v225, v225
  v_rcp_f32 v226, v226
  v_rcp_f32 v227, v227
  v_rcp_f32 v228, v228
  v_rcp_f32 v229, v229
  v_rcp_f32 v230, v230
  v_rcp_f32 v231, v231
  v_fma_f32 v224, v224, v250, v251
  v_fma_f32 v225, v225, v250, v251
  v_fma_f32 v226, v226, v250, v251
  v_fma_f32 v227, v227, v250, v251
  v_fma_f32 v228, v228, v250, v251
  v_fma_f32 v229, v229, v250, v251
  v_fma_f32 v230, v230, v250, v251
  v_fma_f32 v231, v231, v250, v251
  v_mul_f32 v72, v72, v224
  v_mul_f32 v73, v73, v225
  v_mul_f32 v74, v74, v226
  v_mul_f32 v75, v75, v227
  v_mul_f32 v76, v76, v228
  v_mul_f32 v77, v77, v229
  v_mul_f32 v78, v78, v230
  v_mul_f32 v79, v79, v231
  v_cvt_pk_bf16_f32 v232, v72, v73
  v_cvt_pk_bf16_f32 v233, v74, v75
  v_cvt_pk_bf16_f32 v234, v76, v77
  v_cvt_pk_bf16_f32 v235, v78, v79
  buffer_store_dwordx4 v[232:235], v252, s[28:31], s46 offen offset:2048 sc1
  v_fma_f32 v80, v160, v14, v80
  v_fma_f32 v81, v161, v14, v81
  v_fma_f32 v82, v162, v14, v82
  v_fma_f32 v83, v163, v14, v83
  v_fma_f32 v84, v164, v14, v84
  v_fma_f32 v85, v165, v14, v85
  v_fma_f32 v86, v166, v14, v86
  v_fma_f32 v87, v167, v14, v87
  v_fma_f32 v80, v80, v15, v176
  v_fma_f32 v81, v81, v15, v177
  v_fma_f32 v82, v82, v15, v178
  v_fma_f32 v83, v83, v15, v179
  v_fma_f32 v84, v84, v15, v180
  v_fma_f32 v85, v85, v15, v181
  v_fma_f32 v86, v86, v15, v182
  v_fma_f32 v87, v87, v15, v183
  v_mul_f32 v216, v80, v249
  v_mul_f32 v217, v81, v249
  v_mul_f32 v218, v82, v249
  v_mul_f32 v219, v83, v249
  v_mul_f32 v220, v84, v249
  v_mul_f32 v221, v85, v249
  v_mul_f32 v222, v86, v249
  v_mul_f32 v223, v87, v249
  v_exp_f32 v216, v216
  v_exp_f32 v217, v217
  v_exp_f32 v218, v218
  v_exp_f32 v219, v219
  v_exp_f32 v220, v220
  v_exp_f32 v221, v221
  v_exp_f32 v222, v222
  v_exp_f32 v223, v223
  v_add_f32 v224, v216, v248
  v_add_f32 v225, v217, v248
  v_add_f32 v226, v218, v248
  v_add_f32 v227, v219, v248
  v_add_f32 v228, v220, v248
  v_add_f32 v229, v221, v248
  v_add_f32 v230, v222, v248
  v_add_f32 v231, v223, v248
  v_fma_f32 v224, v216, v224, v248
  v_fma_f32 v225, v217, v225, v248
  v_fma_f32 v226, v218, v226, v248
  v_fma_f32 v227, v219, v227, v248
  v_fma_f32 v228, v220, v228, v248
  v_fma_f32 v229, v221, v229, v248
  v_fma_f32 v230, v222, v230, v248
  v_fma_f32 v231, v223, v231, v248
  v_rcp_f32 v224, v224
  v_rcp_f32 v225, v225
  v_rcp_f32 v226, v226
  v_rcp_f32 v227, v227
  v_rcp_f32 v228, v228
  v_rcp_f32 v229, v229
  v_rcp_f32 v230, v230
  v_rcp_f32 v231, v231
  v_fma_f32 v224, v224, v250, v251
  v_fma_f32 v225, v225, v250, v251
  v_fma_f32 v226, v226, v250, v251
  v_fma_f32 v227, v227, v250, v251
  v_fma_f32 v228, v228, v250, v251
  v_fma_f32 v229, v229, v250, v251
  v_fma_f32 v230, v230, v250, v251
  v_fma_f32 v231, v231, v250, v251
  v_mul_f32 v80, v80, v224
  v_mul_f32 v81, v81, v225
  v_mul_f32 v82, v82, v226
  v_mul_f32 v83, v83, v227
  v_mul_f32 v84, v84, v228
  v_mul_f32 v85, v85, v229
  v_mul_f32 v86, v86, v230
  v_mul_f32 v87, v87, v231
  v_cvt_pk_bf16_f32 v236, v80, v81
  v_cvt_pk_bf16_f32 v237, v82, v83
  v_cvt_pk_bf16_f32 v238, v84, v85
  v_cvt_pk_bf16_f32 v239, v86, v87
  buffer_store_dwordx4 v[236:239], v252, s[28:31], s46 offen offset:2560 sc1
  s_waitcnt vmcnt(0)
  s_endpgm
L_k1_end:
  s_waitcnt vmcnt(0)
  s_endpgm
.globl k2_kernel
.p2align 8
.type k2_kernel,@function
k2_kernel:
  s_cmp_ge_u32 s2, 256
  s_cbranch_scc1 L_k2_end
  s_load_dwordx2 s[4:5], s[0:1], 0
  s_load_dwordx4 s[8:11], s[0:1], 64
  s_load_dwordx2 s[12:13], s[0:1], 80
  s_bfe_u32 s40, s2, 0x20001
  s_lshl_b32 s40, s40, 3
  s_bfe_u32 s43, s2, 0x30003
  s_add_u32 s40, s40, s43
  s_and_b32 s41, s2, 1
  s_lshl_b32 s41, s41, 2
  s_lshr_b32 s43, s2, 6
  s_add_u32 s41, s41, s43
  v_and_b32 v1, 63, v0
  v_and_b32 v2, 15, v0
  v_bfe_u32 v3, v0, 4, 2
  v_lshrrev_b32 v11, 6, v0
  s_nop 0
  v_readfirstlane_b32 s42, v11
  s_mov_b32 s46, 0x3fb8aa3b
  v_lshlrev_b32 v4, 4, v1
  s_mul_i32 s47, s42, 20480
  s_mov_b32 s44, s42
  s_cmp_eq_u32 s42, 6
  s_cselect_b32 s44, 54, s44
  s_cmp_eq_u32 s42, 7
  s_cselect_b32 s44, 64, s44
  s_mul_i32 s57, s41, 378880
  s_mul_i32 s43, s44, 5120
  s_add_u32 s57, s57, s43
  s_add_u32 s57, s57, 12939264
  v_lshrrev_b32 v11, 2, v1
  v_mul_u32_u24 v11, 160, v11
  v_and_b32 v12, 3, v1
  v_lshl_add_u32 v11, v12, 3, v11
  v_add_u32 v10, s47, v11
  s_waitcnt lgkmcnt(0)
  s_mov_b32 s36, s12
  s_and_b32 s37, s13, 0xffff
  s_mov_b32 s38, 0x11bd000
  s_mov_b32 s39, 0x20000
  s_cmp_ge_u32 s42, 6
  s_cbranch_scc1 L_k2_att
  s_setprio 2
  s_cmp_ge_u32 s42, 4
  s_cselect_b32 s61, -2, 0
  s_and_b32 s59, s40, 7
  s_and_b32 s43, s41, 3
  s_lshl_b32 s43, s43, 1
  s_add_u32 s59, s59, s43
  s_cmp_ge_u32 s59, 7
  s_cselect_b32 s43, 7, 0
  s_sub_u32 s59, s59, s43
  s_cmp_ge_u32 s59, 7
  s_cselect_b32 s43, 7, 0
  s_sub_u32 s59, s59, s43
  s_add_u32 s43, s57, 0
  s_add_u32 m0, s47, 0
  s_nop 0
  buffer_load_dwordx4 v4, s[36:39], s43 offen offset:0 lds
  buffer_load_dwordx4 v4, s[36:39], s43 offen offset:1024 lds
  buffer_load_dwordx4 v4, s[36:39], s43 offen offset:2048 lds
  buffer_load_dwordx4 v4, s[36:39], s43 offen offset:3072 lds
  s_add_u32 s43, s43, 4096
  s_add_u32 m0, s47, 4096
  s_nop 0
  buffer_load_dwordx4 v4, s[36:39], s43 offen lds
  s_lshl_b32 s43, s40, 2
  s_add_u32 s43, s43, 0
  s_mul_i32 s43, s43, 54
  s_add_u32 s43, s43, s44
  s_lshl_b32 s48, s43, 10
  s_lshl_b32 s43, s40, 2
  s_add_u32 s43, s43, 1
  s_mul_i32 s43, s43, 54
  s_add_u32 s43, s43, s44
  s_lshl_b32 s49, s43, 10
  s_lshl_b32 s43, s40, 2
  s_add_u32 s43, s43, 2
  s_mul_i32 s43, s43, 54
  s_add_u32 s43, s43, s44
  s_lshl_b32 s50, s43, 10
  s_lshl_b32 s43, s40, 2
  s_add_u32 s43, s43, 3
  s_mul_i32 s43, s43, 54
  s_add_u32 s43, s43, s44
  s_lshl_b32 s51, s43, 10
  s_add_u32 s43, s48, 0
  buffer_load_dwordx4 v[144:147], v4, s[36:39], s43 offen
  s_add_u32 s43, s49, 0
  buffer_load_dwordx4 v[148:151], v4, s[36:39], s43 offen
  s_add_u32 s43, s50, 0
  buffer_load_dwordx4 v[152:155], v4, s[36:39], s43 offen
  s_add_u32 s43, s51, 0
  buffer_load_dwordx4 v[156:159], v4, s[36:39], s43 offen
  s_add_u32 s43, s57, 30720
  s_add_u32 m0, s47, 5120
  s_nop 0
  buffer_load_dwordx4 v4, s[36:39], s43 offen offset:0 lds
  buffer_load_dwordx4 v4, s[36:39], s43 offen offset:1024 lds
  buffer_load_dwordx4 v4, s[36:39], s43 offen offset:2048 lds
  buffer_load_dwordx4 v4, s[36:39], s43 offen offset:3072 lds
  s_add_u32 s43, s43, 4096
  s_add_u32 m0, s47, 9216
  s_nop 0
  buffer_load_dwordx4 v4, s[36:39], s43 offen lds
  s_add_u32 s43, s48, 6144
  buffer_load_dwordx4 v[160:163], v4, s[36:39], s43 offen
  s_add_u32 s43, s49, 6144
  buffer_load_dwordx4 v[164:167], v4, s[36:39], s43 offen
  s_add_u32 s43, s50, 6144
  buffer_load_dwordx4 v[168:171], v4, s[36:39], s43 offen
  s_add_u32 s43, s51, 6144
  buffer_load_dwordx4 v[172:175], v4, s[36:39], s43 offen
  s_and_b32 s43, s42, 6
  s_cmp_eq_u32 s43, 2
  s_cbranch_scc1 L_k2_f7
  s_waitcnt vmcnt(13)
  ds_read_b64_tr_b16 v[104:105], v10 offset:0
  ds_read_b64_tr_b16 v[106:107], v10 offset:2560
  ds_read_b64_tr_b16 v[108:109], v10 offset:32
  ds_read_b64_tr_b16 v[110:111], v10 offset:2592
  ds_read_b64_tr_b16 v[112:113], v10 offset:64
  ds_read_b64_tr_b16 v[114:115], v10 offset:2624
  ds_read_b64_tr_b16 v[116:117], v10 offset:96
  ds_read_b64_tr_b16 v[118:119], v10 offset:2656
  ds_read_b64_tr_b16 v[120:121], v10 offset:128
  ds_read_b64_tr_b16 v[122:123], v10 offset:2688
  s_waitcnt vmcnt(4)
  ds_read_b64_tr_b16 v[124:125], v10 offset:5120
  ds_read_b64_tr_b16 v[126:127], v10 offset:7680
  ds_read_b64_tr_b16 v[128:129], v10 offset:5152
  ds_read_b64_tr_b16 v[130:131], v10 offset:7712
  ds_read_b64_tr_b16 v[132:133], v10 offset:5184
  ds_read_b64_tr_b16 v[134:135], v10 offset:7744
  ds_read_b64_tr_b16 v[136:137], v10 offset:5216
  ds_read_b64_tr_b16 v[138:139], v10 offset:7776
  ds_read_b64_tr_b16 v[140:141], v10 offset:5248
  ds_read_b64_tr_b16 v[142:143], v10 offset:7808
  s_add_u32 s43, s57, 61440
  s_add_u32 m0, s47, 10240
  s_nop 0
  buffer_load_dwordx4 v4, s[36:39], s43 offen offset:0 lds
  buffer_load_dwordx4 v4, s[36:39], s43 offen offset:1024 lds
  buffer_load_dwordx4 v4, s[36:39], s43 offen offset:2048 lds
  buffer_load_dwordx4 v4, s[36:39], s43 offen offset:3072 lds
  s_add_u32 s43, s43, 4096
  s_add_u32 m0, s47, 14336
  s_nop 0
  buffer_load_dwordx4 v4, s[36:39], s43 offen lds
  s_add_u32 s43, s57, 92160
  s_add_u32 m0, s47, 15360
  s_nop 0
  buffer_load_dwordx4 v4, s[36:39], s43 offen offset:0 lds
  buffer_load_dwordx4 v4, s[36:39], s43 offen offset:1024 lds
  buffer_load_dwordx4 v4, s[36:39], s43 offen offset:2048 lds
  buffer_load_dwordx4 v4, s[36:39], s43 offen offset:3072 lds
  s_add_u32 s43, s43, 4096
  s_add_u32 m0, s47, 19456
  s_nop 0
  buffer_load_dwordx4 v4, s[36:39], s43 offen lds
  s_add_u32 s43, s48, 12288
  buffer_load_dwordx4 v[176:179], v4, s[36:39], s43 offen
  s_add_u32 s43, s49, 12288
  buffer_load_dwordx4 v[180:183], v4, s[36:39], s43 offen
  s_add_u32 s43, s50, 12288
  buffer_load_dwordx4 v[184:187], v4, s[36:39], s43 offen
  s_add_u32 s43, s51, 12288
  buffer_load_dwordx4 v[188:191], v4, s[36:39], s43 offen
  s_add_u32 s43, s48, 18432
  buffer_load_dwordx4 v[192:195], v4, s[36:39], s43 offen
  s_add_u32 s43, s49, 18432
  buffer_load_dwordx4 v[196:199], v4, s[36:39], s43 offen
  s_add_u32 s43, s50, 18432
  buffer_load_dwordx4 v[200:203], v4, s[36:39], s43 offen
  s_add_u32 s43, s51, 18432
  buffer_load_dwordx4 v[204:207], v4, s[36:39], s43 offen
  s_waitcnt lgkmcnt(15)
  v_mfma_f32_16x16x32_bf16 v[24:27], v[104:107], v[144:147], 0
  v_mfma_f32_16x16x32_bf16 v[28:31], v[104:107], v[148:151], 0
  v_mfma_f32_16x16x32_bf16 v[32:35], v[104:107], v[152:155], 0
  v_mfma_f32_16x16x32_bf16 v[36:39], v[104:107], v[156:159], 0
  v_mfma_f32_16x16x32_bf16 v[40:43], v[108:111], v[144:147], 0
  v_mfma_f32_16x16x32_bf16 v[44:47], v[108:111], v[148:151], 0
  v_mfma_f32_16x16x32_bf16 v[48:51], v[108:111], v[152:155], 0
  v_mfma_f32_16x16x32_bf16 v[52:55], v[108:111], v[156:159], 0
  s_waitcnt lgkmcnt(14)
  v_mfma_f32_16x16x32_bf16 v[56:59], v[112:115], v[144:147], 0
  v_mfma_f32_16x16x32_bf16 v[60:63], v[112:115], v[148:151], 0
  v_mfma_f32_16x16x32_bf16 v[64:67], v[112:115], v[152:155], 0
  v_mfma_f32_16x16x32_bf16 v[68:71], v[112:115], v[156:159], 0
  s_waitcnt lgkmcnt(12)
  v_mfma_f32_16x16x32_bf16 v[72:75], v[116:119], v[144:147], 0
  v_mfma_f32_16x16x32_bf16 v[76:79], v[116:119], v[148:151], 0
  v_mfma_f32_16x16x32_bf16 v[80:83], v[116:119], v[152:155], 0
  v_mfma_f32_16x16x32_bf16 v[84:87], v[116:119], v[156:159], 0
  s_waitcnt lgkmcnt(10)
  v_mfma_f32_16x16x32_bf16 v[88:91], v[120:123], v[144:147], 0
  v_mfma_f32_16x16x32_bf16 v[92:95], v[120:123], v[148:151], 0
  v_mfma_f32_16x16x32_bf16 v[96:99], v[120:123], v[152:155], 0
  v_mfma_f32_16x16x32_bf16 v[100:103], v[120:123], v[156:159], 0
  s_waitcnt vmcnt(13)
  ds_read_b64_tr_b16 v[104:105], v10 offset:10240
  ds_read_b64_tr_b16 v[106:107], v10 offset:12800
  ds_read_b64_tr_b16 v[108:109], v10 offset:10272
  ds_read_b64_tr_b16 v[110:111], v10 offset:12832
  ds_read_b64_tr_b16 v[112:113], v10 offset:10304
  ds_read_b64_tr_b16 v[114:115], v10 offset:12864
  ds_read_b64_tr_b16 v[116:117], v10 offset:10336
  ds_read_b64_tr_b16 v[118:119], v10 offset:12896
  ds_read_b64_tr_b16 v[120:121], v10 offset:10368
  ds_read_b64_tr_b16 v[122:123], v10 offset:12928
  s_add_u32 s43, s57, 122880
  s_add_u32 m0, s47, 0
  s_nop 0
  buffer_load_dwordx4 v4, s[36:39], s43 offen offset:0 lds
  buffer_load_dwordx4 v4, s[36:39], s43 offen offset:1024 lds
  buffer_load_dwordx4 v4, s[36:39], s43 offen offset:2048 lds
  buffer_load_dwordx4 v4, s[36:39], s43 offen offset:3072 lds
  s_add_u32 s43, s43, 4096
  s_add_u32 m0, s47, 4096
  s_nop 0
  buffer_load_dwordx4 v4, s[36:39], s43 offen lds
  s_add_u32 s43, s48, 24576
  buffer_load_dwordx4 v[208:211], v4, s[36:39], s43 offen
  s_add_u32 s43, s49, 24576
  buffer_load_dwordx4 v[212:215], v4, s[36:39], s43 offen
  s_add_u32 s43, s50, 24576
  buffer_load_dwordx4 v[216:219], v4, s[36:39], s43 offen
  s_add_u32 s43, s51, 24576
  buffer_load_dwordx4 v[220:223], v4, s[36:39], s43 offen
  s_waitcnt lgkmcnt(15)
  v_mfma_f32_16x16x32_bf16 v[24:27], v[124:127], v[160:163], v[24:27]
  v_mfma_f32_16x16x32_bf16 v[28:31], v[124:127], v[164:167], v[28:31]
  v_mfma_f32_16x16x32_bf16 v[32:35], v[124:127], v[168:171], v[32:35]
  v_mfma_f32_16x16x32_bf16 v[36:39], v[124:127], v[172:175], v[36:39]
  v_mfma_f32_16x16x32_bf16 v[40:43], v[128:131], v[160:163], v[40:43]
  v_mfma_f32_16x16x32_bf16 v[44:47], v[128:131], v[164:167], v[44:47]
  v_mfma_f32_16x16x32_bf16 v[48:51], v[128:131], v[168:171], v[48:51]
  v_mfma_f32_16x16x32_bf16 v[52:55], v[128:131], v[172:175], v[52:55]
  s_waitcnt lgkmcnt(14)
  v_mfma_f32_16x16x32_bf16 v[56:59], v[132:135], v[160:163], v[56:59]
  v_mfma_f32_16x16x32_bf16 v[60:63], v[132:135], v[164:167], v[60:63]
  v_mfma_f32_16x16x32_bf16 v[64:67], v[132:135], v[168:171], v[64:67]
  v_mfma_f32_16x16x32_bf16 v[68:71], v[132:135], v[172:175], v[68:71]
  s_waitcnt lgkmcnt(12)
  v_mfma_f32_16x16x32_bf16 v[72:75], v[136:139], v[160:163], v[72:75]
  v_mfma_f32_16x16x32_bf16 v[76:79], v[136:139], v[164:167], v[76:79]
  v_mfma_f32_16x16x32_bf16 v[80:83], v[136:139], v[168:171], v[80:83]
  v_mfma_f32_16x16x32_bf16 v[84:87], v[136:139], v[172:175], v[84:87]
  s_waitcnt lgkmcnt(10)
  v_mfma_f32_16x16x32_bf16 v[88:91], v[140:143], v[160:163], v[88:91]
  v_mfma_f32_16x16x32_bf16 v[92:95], v[140:143], v[164:167], v[92:95]
  v_mfma_f32_16x16x32_bf16 v[96:99], v[140:143], v[168:171], v[96:99]
  v_mfma_f32_16x16x32_bf16 v[100:103], v[140:143], v[172:175], v[100:103]
  s_setprio 1
  s_waitcnt vmcnt(17)
  ds_read_b64_tr_b16 v[124:125], v10 offset:15360
  ds_read_b64_tr_b16 v[126:127], v10 offset:17920
  ds_read_b64_tr_b16 v[128:129], v10 offset:15392
  ds_read_b64_tr_b16 v[130:131], v10 offset:17952
  ds_read_b64_tr_b16 v[132:133], v10 offset:15424
  ds_read_b64_tr_b16 v[134:135], v10 offset:17984
  ds_read_b64_tr_b16 v[136:137], v10 offset:15456
  ds_read_b64_tr_b16 v[138:139], v10 offset:18016
  ds_read_b64_tr_b16 v[140:141], v10 offset:15488
  ds_read_b64_tr_b16 v[142:143], v10 offset:18048
  s_add_u32 s43, s57, 153600
  s_add_u32 m0, s47, 5120
  s_nop 0
  buffer_load_dwordx4 v4, s[36:39], s43 offen offset:0 lds
  buffer_load_dwordx4 v4, s[36:39], s43 offen offset:1024 lds
  buffer_load_dwordx4 v4, s[36:39], s43 offen offset:2048 lds
  buffer_load_dwordx4 v4, s[36:39], s43 offen offset:3072 lds
  s_add_u32 s43, s43, 4096
  s_add_u32 m0, s47, 9216
  s_nop 0
  buffer_load_dwordx4 v4, s[36:39], s43 offen lds
  s_add_u32 s43, s48, 30720
  buffer_load_dwordx4 v[224:227], v4, s[36:39], s43 offen
  s_add_u32 s43, s49, 30720
  buffer_load_dwordx4 v[228:231], v4, s[36:39], s43 offen
  s_add_u32 s43, s50, 30720
  buffer_load_dwordx4 v[232:235], v4, s[36:39], s43 offen
  s_add_u32 s43, s51, 30720
  buffer_load_dwordx4 v[236:239], v4, s[36:39], s43 offen
  s_waitcnt vmcnt(22)
  s_waitcnt lgkmcnt(15)
  v_mfma_f32_16x16x32_bf16 v[24:27], v[104:107], v[176:179], v[24:27]
  v_mfma_f32_16x16x32_bf16 v[28:31], v[104:107], v[180:183], v[28:31]
  v_mfma_f32_16x16x32_bf16 v[32:35], v[104:107], v[184:187], v[32:35]
  v_mfma_f32_16x16x32_bf16 v[36:39], v[104:107], v[188:191], v[36:39]
  v_mfma_f32_16x16x32_bf16 v[40:43], v[108:111], v[176:179], v[40:43]
  v_mfma_f32_16x16x32_bf16 v[44:47], v[108:111], v[180:183], v[44:47]
  v_mfma_f32_16x16x32_bf16 v[48:51], v[108:111], v[184:187], v[48:51]
  v_mfma_f32_16x16x32_bf16 v[52:55], v[108:111], v[188:191], v[52:55]
  s_waitcnt lgkmcnt(14)
  v_mfma_f32_16x16x32_bf16 v[56:59], v[112:115], v[176:179], v[56:59]
  v_mfma_f32_16x16x32_bf16 v[60:63], v[112:115], v[180:183], v[60:63]
  v_mfma_f32_16x16x32_bf16 v[64:67], v[112:115], v[184:187], v[64:67]
  v_mfma_f32_16x16x32_bf16 v[68:71], v[112:115], v[188:191], v[68:71]
  s_waitcnt lgkmcnt(12)
  v_mfma_f32_16x16x32_bf16 v[72:75], v[116:119], v[176:179], v[72:75]
  v_mfma_f32_16x16x32_bf16 v[76:79], v[116:119], v[180:183], v[76:79]
  v_mfma_f32_16x16x32_bf16 v[80:83], v[116:119], v[184:187], v[80:83]
  v_mfma_f32_16x16x32_bf16 v[84:87], v[116:119], v[188:191], v[84:87]
  s_waitcnt lgkmcnt(10)
  v_mfma_f32_16x16x32_bf16 v[88:91], v[120:123], v[176:179], v[88:91]
  v_mfma_f32_16x16x32_bf16 v[92:95], v[120:123], v[180:183], v[92:95]
  v_mfma_f32_16x16x32_bf16 v[96:99], v[120:123], v[184:187], v[96:99]
  v_mfma_f32_16x16x32_bf16 v[100:103], v[120:123], v[188:191], v[100:103]
  s_waitcnt vmcnt(13)
  ds_read_b64_tr_b16 v[104:105], v10 offset:0
  ds_read_b64_tr_b16 v[106:107], v10 offset:2560
  ds_read_b64_tr_b16 v[108:109], v10 offset:32
  ds_read_b64_tr_b16 v[110:111], v10 offset:2592
  ds_read_b64_tr_b16 v[112:113], v10 offset:64
  ds_read_b64_tr_b16 v[114:115], v10 offset:2624
  ds_read_b64_tr_b16 v[116:117], v10 offset:96
  ds_read_b64_tr_b16 v[118:119], v10 offset:2656
  ds_read_b64_tr_b16 v[120:121], v10 offset:128
  ds_read_b64_tr_b16 v[122:123], v10 offset:2688
  s_add_u32 s43, s57, 184320
  s_add_u32 m0, s47, 10240
  s_nop 0
  buffer_load_dwordx4 v4, s[36:39], s43 offen offset:0 lds
  buffer_load_dwordx4 v4, s[36:39], s43 offen offset:1024 lds
  buffer_load_dwordx4 v4, s[36:39], s43 offen offset:2048 lds
  buffer_load_dwordx4 v4, s[36:39], s43 offen offset:3072 lds
  s_add_u32 s43, s43, 4096
  s_add_u32 m0, s47, 14336
  s_nop 0
  buffer_load_dwordx4 v4, s[36:39], s43 offen lds
  s_add_u32 s43, s48, 36864
  buffer_load_dwordx4 v[240:243], v4, s[36:39], s43 offen
  s_add_u32 s43, s49, 36864
  buffer_load_dwordx4 v[244:247], v4, s[36:39], s43 offen
  s_add_u32 s43, s50, 36864
  buffer_load_dwordx4 v[248:251], v4, s[36:39], s43 offen
  s_add_u32 s43, s51, 36864
  buffer_load_dwordx4 v[252:255], v4, s[36:39], s43 offen
  s_waitcnt lgkmcnt(15)
  v_mfma_f32_16x16x32_bf16 v[24:27], v[124:127], v[192:195], v[24:27]
  v_mfma_f32_16x16x32_bf16 v[28:31], v[124:127], v[196:199], v[28:31]
  v_mfma_f32_16x16x32_bf16 v[32:35], v[124:127], v[200:203], v[32:35]
  v_mfma_f32_16x16x32_bf16 v[36:39], v[124:127], v[204:207], v[36:39]
  v_mfma_f32_16x16x32_bf16 v[40:43], v[128:131], v[192:195], v[40:43]
  v_mfma_f32_16x16x32_bf16 v[44:47], v[128:131], v[196:199], v[44:47]
  v_mfma_f32_16x16x32_bf16 v[48:51], v[128:131], v[200:203], v[48:51]
  v_mfma_f32_16x16x32_bf16 v[52:55], v[128:131], v[204:207], v[52:55]
  s_waitcnt lgkmcnt(14)
  v_mfma_f32_16x16x32_bf16 v[56:59], v[132:135], v[192:195], v[56:59]
  v_mfma_f32_16x16x32_bf16 v[60:63], v[132:135], v[196:199], v[60:63]
  v_mfma_f32_16x16x32_bf16 v[64:67], v[132:135], v[200:203], v[64:67]
  v_mfma_f32_16x16x32_bf16 v[68:71], v[132:135], v[204:207], v[68:71]
  s_waitcnt lgkmcnt(12)
  v_mfma_f32_16x16x32_bf16 v[72:75], v[136:139], v[192:195], v[72:75]
  v_mfma_f32_16x16x32_bf16 v[76:79], v[136:139], v[196:199], v[76:79]
  v_mfma_f32_16x16x32_bf16 v[80:83], v[136:139], v[200:203], v[80:83]
  v_mfma_f32_16x16x32_bf16 v[84:87], v[136:139], v[204:207], v[84:87]
  s_waitcnt lgkmcnt(10)
  v_mfma_f32_16x16x32_bf16 v[88:91], v[140:143], v[192:195], v[88:91]
  v_mfma_f32_16x16x32_bf16 v[92:95], v[140:143], v[196:199], v[92:95]
  v_mfma_f32_16x16x32_bf16 v[96:99], v[140:143], v[200:203], v[96:99]
  v_mfma_f32_16x16x32_bf16 v[100:103], v[140:143], v[204:207], v[100:103]
  s_waitcnt vmcnt(13)
  ds_read_b64_tr_b16 v[124:125], v10 offset:5120
  ds_read_b64_tr_b16 v[126:127], v10 offset:7680
  ds_read_b64_tr_b16 v[128:129], v10 offset:5152
  ds_read_b64_tr_b16 v[130:131], v10 offset:7712
  ds_read_b64_tr_b16 v[132:133], v10 offset:5184
  ds_read_b64_tr_b16 v[134:135], v10 offset:7744
  ds_read_b64_tr_b16 v[136:137], v10 offset:5216
  ds_read_b64_tr_b16 v[138:139], v10 offset:7776
  ds_read_b64_tr_b16 v[140:141], v10 offset:5248
  ds_read_b64_tr_b16 v[142:143], v10 offset:7808
  s_mul_i32 s43, s61, 5120
  s_add_u32 s43, s43, s57
  s_add_u32 s43, s43, 215040
  s_add_u32 m0, s47, 15360
  s_nop 0
  buffer_load_dwordx4 v4, s[36:39], s43 offen offset:0 lds
  buffer_load_dwordx4 v4, s[36:39], s43 offen offset:1024 lds
  buffer_load_dwordx4 v4, s[36:39], s43 offen offset:2048 lds
  buffer_load_dwordx4 v4, s[36:39], s43 offen offset:3072 lds
  s_add_u32 s43, s43, 4096
  s_add_u32 m0, s47, 19456
  s_nop 0
  buffer_load_dwordx4 v4, s[36:39], s43 offen lds
  s_mul_i32 s43, s61, 1024
  s_add_u32 s43, s43, s48
  s_add_u32 s43, s43, 43008
  buffer_load_dwordx4 v[144:147], v4, s[36:39], s43 offen
  s_mul_i32 s43, s61, 1024
  s_add_u32 s43, s43, s49
  s_add_u32 s43, s43, 43008
  buffer_load_dwordx4 v[148:151], v4, s[36:39], s43 offen
  s_mul_i32 s43, s61, 1024
  s_add_u32 s43, s43, s50
  s_add_u32 s43, s43, 43008
  buffer_load_dwordx4 v[152:155], v4, s[36:39], s43 offen
  s_mul_i32 s43, s61, 1024
  s_add_u32 s43, s43, s51
  s_add_u32 s43, s43, 43008
  buffer_load_dwordx4 v[156:159], v4, s[36:39], s43 offen
  s_waitcnt lgkmcnt(15)
  v_mfma_f32_16x16x32_bf16 v[24:27], v[104:107], v[208:211], v[24:27]
  v_mfma_f32_16x16x32_bf16 v[28:31], v[104:107], v[212:215], v[28:31]
  v_mfma_f32_16x16x32_bf16 v[32:35], v[104:107], v[216:219], v[32:35]
  v_mfma_f32_16x16x32_bf16 v[36:39], v[104:107], v[220:223], v[36:39]
  v_mfma_f32_16x16x32_bf16 v[40:43], v[108:111], v[208:211], v[40:43]
  v_mfma_f32_16x16x32_bf16 v[44:47], v[108:111], v[212:215], v[44:47]
  v_mfma_f32_16x16x32_bf16 v[48:51], v[108:111], v[216:219], v[48:51]
  v_mfma_f32_16x16x32_bf16 v[52:55], v[108:111], v[220:223], v[52:55]
  s_waitcnt lgkmcnt(14)
  v_mfma_f32_16x16x32_bf16 v[56:59], v[112:115], v[208:211], v[56:59]
  v_mfma_f32_16x16x32_bf16 v[60:63], v[112:115], v[212:215], v[60:63]
  v_mfma_f32_16x16x32_bf16 v[64:67], v[112:115], v[216:219], v[64:67]
  v_mfma_f32_16x16x32_bf16 v[68:71], v[112:115], v[220:223], v[68:71]
  s_waitcnt lgkmcnt(12)
  v_mfma_f32_16x16x32_bf16 v[72:75], v[116:119], v[208:211], v[72:75]
  v_mfma_f32_16x16x32_bf16 v[76:79], v[116:119], v[212:215], v[76:79]
  v_mfma_f32_16x16x32_bf16 v[80:83], v[116:119], v[216:219], v[80:83]
  v_mfma_f32_16x16x32_bf16 v[84:87], v[116:119], v[220:223], v[84:87]
  s_waitcnt lgkmcnt(10)
  v_mfma_f32_16x16x32_bf16 v[88:91], v[120:123], v[208:211], v[88:91]
  v_mfma_f32_16x16x32_bf16 v[92:95], v[120:123], v[212:215], v[92:95]
  v_mfma_f32_16x16x32_bf16 v[96:99], v[120:123], v[216:219], v[96:99]
  v_mfma_f32_16x16x32_bf16 v[100:103], v[120:123], v[220:223], v[100:103]
  s_setprio 0
  s_waitcnt vmcnt(13)
  ds_read_b64_tr_b16 v[104:105], v10 offset:10240
  ds_read_b64_tr_b16 v[106:107], v10 offset:12800
  ds_read_b64_tr_b16 v[108:109], v10 offset:10272
  ds_read_b64_tr_b16 v[110:111], v10 offset:12832
  ds_read_b64_tr_b16 v[112:113], v10 offset:10304
  ds_read_b64_tr_b16 v[114:115], v10 offset:12864
  ds_read_b64_tr_b16 v[116:117], v10 offset:10336
  ds_read_b64_tr_b16 v[118:119], v10 offset:12896
  ds_read_b64_tr_b16 v[120:121], v10 offset:10368
  ds_read_b64_tr_b16 v[122:123], v10 offset:12928
  s_mul_i32 s43, s61, 5120
  s_add_u32 s43, s43, s57
  s_add_u32 s43, s43, 235520
  s_add_u32 m0, s47, 0
  s_nop 0
  buffer_load_dwordx4 v4, s[36:39], s43 offen offset:0 lds
  buffer_load_dwordx4 v4, s[36:39], s43 offen offset:1024 lds
  buffer_load_dwordx4 v4, s[36:39], s43 offen offset:2048 lds
  buffer_load_dwordx4 v4, s[36:39], s43 offen offset:3072 lds
  s_add_u32 s43, s43, 4096
  s_add_u32 m0, s47, 4096
  s_nop 0
  buffer_load_dwordx4 v4, s[36:39], s43 offen lds
  s_mul_i32 s43, s61, 1024
  s_add_u32 s43, s43, s48
  s_add_u32 s43, s43, 47104
  buffer_load_dwordx4 v[160:163], v4, s[36:39], s43 offen
  s_mul_i32 s43, s61, 1024
  s_add_u32 s43, s43, s49
  s_add_u32 s43, s43, 47104
  buffer_load_dwordx4 v[164:167], v4, s[36:39], s43 offen
  s_mul_i32 s43, s61, 1024
  s_add_u32 s43, s43, s50
  s_add_u32 s43, s43, 47104
  buffer_load_dwordx4 v[168:171], v4, s[36:39], s43 offen
  s_mul_i32 s43, s61, 1024
  s_add_u32 s43, s43, s51
  s_add_u32 s43, s43, 47104
  buffer_load_dwordx4 v[172:175], v4, s[36:39], s43 offen
  s_waitcnt lgkmcnt(15)
  v_mfma_f32_16x16x32_bf16 v[24:27], v[124:127], v[224:227], v[24:27]
  v_mfma_f32_16x16x32_bf16 v[28:31], v[124:127], v[228:231], v[28:31]
  v_mfma_f32_16x16x32_bf16 v[32:35], v[124:127], v[232:235], v[32:35]
  v_mfma_f32_16x16x32_bf16 v[36:39], v[124:127], v[236:239], v[36:39]
  v_mfma_f32_16x16x32_bf16 v[40:43], v[128:131], v[224:227], v[40:43]
  v_mfma_f32_16x16x32_bf16 v[44:47], v[128:131], v[228:231], v[44:47]
  v_mfma_f32_16x16x32_bf16 v[48:51], v[128:131], v[232:235], v[48:51]
  v_mfma_f32_16x16x32_bf16 v[52:55], v[128:131], v[236:239], v[52:55]
  s_waitcnt lgkmcnt(14)
  v_mfma_f32_16x16x32_bf16 v[56:59], v[132:135], v[224:227], v[56:59]
  v_mfma_f32_16x16x32_bf16 v[60:63], v[132:135], v[228:231], v[60:63]
  v_mfma_f32_16x16x32_bf16 v[64:67], v[132:135], v[232:235], v[64:67]
  v_mfma_f32_16x16x32_bf16 v[68:71], v[132:135], v[236:239], v[68:71]
  s_waitcnt lgkmcnt(12)
  v_mfma_f32_16x16x32_bf16 v[72:75], v[136:139], v[224:227], v[72:75]
  v_mfma_f32_16x16x32_bf16 v[76:79], v[136:139], v[228:231], v[76:79]
  v_mfma_f32_16x16x32_bf16 v[80:83], v[136:139], v[232:235], v[80:83]
  v_mfma_f32_16x16x32_bf16 v[84:87], v[136:139], v[236:239], v[84:87]
  s_waitcnt lgkmcnt(10)
  v_mfma_f32_16x16x32_bf16 v[88:91], v[140:143], v[224:227], v[88:91]
  v_mfma_f32_16x16x32_bf16 v[92:95], v[140:143], v[228:231], v[92:95]
  v_mfma_f32_16x16x32_bf16 v[96:99], v[140:143], v[232:235], v[96:99]
  v_mfma_f32_16x16x32_bf16 v[100:103], v[140:143], v[236:239], v[100:103]
  s_waitcnt vmcnt(13)
  ds_read_b64_tr_b16 v[124:125], v10 offset:15360
  ds_read_b64_tr_b16 v[126:127], v10 offset:17920
  ds_read_b64_tr_b16 v[128:129], v10 offset:15392
  ds_read_b64_tr_b16 v[130:131], v10 offset:17952
  ds_read_b64_tr_b16 v[132:133], v10 offset:15424
  ds_read_b64_tr_b16 v[134:135], v10 offset:17984
  ds_read_b64_tr_b16 v[136:137], v10 offset:15456
  ds_read_b64_tr_b16 v[138:139], v10 offset:18016
  ds_read_b64_tr_b16 v[140:141], v10 offset:15488
  ds_read_b64_tr_b16 v[142:143], v10 offset:18048
  s_mul_i32 s43, s61, 5120
  s_add_u32 s43, s43, s57
  s_add_u32 s43, s43, 256000
  s_add_u32 m0, s47, 5120
  s_nop 0
  buffer_load_dwordx4 v4, s[36:39], s43 offen offset:0 lds
  buffer_load_dwordx4 v4, s[36:39], s43 offen offset:1024 lds
  buffer_load_dwordx4 v4, s[36:39], s43 offen offset:2048 lds
  buffer_load_dwordx4 v4, s[36:39], s43 offen offset:3072 lds
  s_add_u32 s43, s43, 4096
  s_add_u32 m0, s47, 9216
  s_nop 0
  buffer_load_dwordx4 v4, s[36:39], s43 offen lds
  s_mul_i32 s43, s61, 1024
  s_add_u32 s43, s43, s48
  s_add_u32 s43, s43, 51200
  buffer_load_dwordx4 v[176:179], v4, s[36:39], s43 offen
  s_mul_i32 s43, s61, 1024
  s_add_u32 s43, s43, s49
  s_add_u32 s43, s43, 51200
  buffer_load_dwordx4 v[180:183], v4, s[36:39], s43 offen
  s_mul_i32 s43, s61, 1024
  s_add_u32 s43, s43, s50
  s_add_u32 s43, s43, 51200
  buffer_load_dwordx4 v[184:187], v4, s[36:39], s43 offen
  s_mul_i32 s43, s61, 1024
  s_add_u32 s43, s43, s51
  s_add_u32 s43, s43, 51200
  buffer_load_dwordx4 v[188:191], v4, s[36:39], s43 offen
  s_waitcnt lgkmcnt(15)
  v_mfma_f32_16x16x32_bf16 v[24:27], v[104:107], v[240:243], v[24:27]
  v_mfma_f32_16x16x32_bf16 v[28:31], v[104:107], v[244:247], v[28:31]
  v_mfma_f32_16x16x32_bf16 v[32:35], v[104:107], v[248:251], v[32:35]
  v_mfma_f32_16x16x32_bf16 v[36:39], v[104:107], v[252:255], v[36:39]
  v_mfma_f32_16x16x32_bf16 v[40:43], v[108:111], v[240:243], v[40:43]
  v_mfma_f32_16x16x32_bf16 v[44:47], v[108:111], v[244:247], v[44:47]
  v_mfma_f32_16x16x32_bf16 v[48:51], v[108:111], v[248:251], v[48:51]
  v_mfma_f32_16x16x32_bf16 v[52:55], v[108:111], v[252:255], v[52:55]
  s_waitcnt lgkmcnt(14)
  v_mfma_f32_16x16x32_bf16 v[56:59], v[112:115], v[240:243], v[56:59]
  v_mfma_f32_16x16x32_bf16 v[60:63], v[112:115], v[244:247], v[60:63]
  v_mfma_f32_16x16x32_bf16 v[64:67], v[112:115], v[248:251], v[64:67]
  v_mfma_f32_16x16x32_bf16 v[68:71], v[112:115], v[252:255], v[68:71]
  s_waitcnt lgkmcnt(12)
  v_mfma_f32_16x16x32_bf16 v[72:75], v[116:119], v[240:243], v[72:75]
  v_mfma_f32_16x16x32_bf16 v[76:79], v[116:119], v[244:247], v[76:79]
  v_mfma_f32_16x16x32_bf16 v[80:83], v[116:119], v[248:251], v[80:83]
  v_mfma_f32_16x16x32_bf16 v[84:87], v[116:119], v[252:255], v[84:87]
  s_waitcnt lgkmcnt(10)
  v_mfma_f32_16x16x32_bf16 v[88:91], v[120:123], v[240:243], v[88:91]
  v_mfma_f32_16x16x32_bf16 v[92:95], v[120:123], v[244:247], v[92:95]
  v_mfma_f32_16x16x32_bf16 v[96:99], v[120:123], v[248:251], v[96:99]
  v_mfma_f32_16x16x32_bf16 v[100:103], v[120:123], v[252:255], v[100:103]
  s_waitcnt vmcnt(13)
  ds_read_b64_tr_b16 v[104:105], v10 offset:0
  ds_read_b64_tr_b16 v[106:107], v10 offset:2560
  ds_read_b64_tr_b16 v[108:109], v10 offset:32
  ds_read_b64_tr_b16 v[110:111], v10 offset:2592
  ds_read_b64_tr_b16 v[112:113], v10 offset:64
  ds_read_b64_tr_b16 v[114:115], v10 offset:2624
  ds_read_b64_tr_b16 v[116:117], v10 offset:96
  ds_read_b64_tr_b16 v[118:119], v10 offset:2656
  ds_read_b64_tr_b16 v[120:121], v10 offset:128
  ds_read_b64_tr_b16 v[122:123], v10 offset:2688
  s_waitcnt lgkmcnt(15)
  v_mfma_f32_16x16x32_bf16 v[24:27], v[124:127], v[144:147], v[24:27]
  v_mfma_f32_16x16x32_bf16 v[28:31], v[124:127], v[148:151], v[28:31]
  v_mfma_f32_16x16x32_bf16 v[32:35], v[124:127], v[152:155], v[32:35]
  v_mfma_f32_16x16x32_bf16 v[36:39], v[124:127], v[156:159], v[36:39]
  v_mfma_f32_16x16x32_bf16 v[40:43], v[128:131], v[144:147], v[40:43]
  v_mfma_f32_16x16x32_bf16 v[44:47], v[128:131], v[148:151], v[44:47]
  v_mfma_f32_16x16x32_bf16 v[48:51], v[128:131], v[152:155], v[48:51]
  v_mfma_f32_16x16x32_bf16 v[52:55], v[128:131], v[156:159], v[52:55]
  s_waitcnt lgkmcnt(14)
  v_mfma_f32_16x16x32_bf16 v[56:59], v[132:135], v[144:147], v[56:59]
  v_mfma_f32_16x16x32_bf16 v[60:63], v[132:135], v[148:151], v[60:63]
  v_mfma_f32_16x16x32_bf16 v[64:67], v[132:135], v[152:155], v[64:67]
  v_mfma_f32_16x16x32_bf16 v[68:71], v[132:135], v[156:159], v[68:71]
  s_waitcnt lgkmcnt(12)
  v_mfma_f32_16x16x32_bf16 v[72:75], v[136:139], v[144:147], v[72:75]
  v_mfma_f32_16x16x32_bf16 v[76:79], v[136:139], v[148:151], v[76:79]
  v_mfma_f32_16x16x32_bf16 v[80:83], v[136:139], v[152:155], v[80:83]
  v_mfma_f32_16x16x32_bf16 v[84:87], v[136:139], v[156:159], v[84:87]
  s_waitcnt lgkmcnt(10)
  v_mfma_f32_16x16x32_bf16 v[88:91], v[140:143], v[144:147], v[88:91]
  v_mfma_f32_16x16x32_bf16 v[92:95], v[140:143], v[148:151], v[92:95]
  v_mfma_f32_16x16x32_bf16 v[96:99], v[140:143], v[152:155], v[96:99]
  v_mfma_f32_16x16x32_bf16 v[100:103], v[140:143], v[156:159], v[100:103]
  s_waitcnt vmcnt(4)
  ds_read_b64_tr_b16 v[124:125], v10 offset:5120
  ds_read_b64_tr_b16 v[126:127], v10 offset:7680
  ds_read_b64_tr_b16 v[128:129], v10 offset:5152
  ds_read_b64_tr_b16 v[130:131], v10 offset:7712
  ds_read_b64_tr_b16 v[132:133], v10 offset:5184
  ds_read_b64_tr_b16 v[134:135], v10 offset:7744
  ds_read_b64_tr_b16 v[136:137], v10 offset:5216
  ds_read_b64_tr_b16 v[138:139], v10 offset:7776
  ds_read_b64_tr_b16 v[140:141], v10 offset:5248
  ds_read_b64_tr_b16 v[142:143], v10 offset:7808
  s_waitcnt lgkmcnt(15)
  v_mfma_f32_16x16x32_bf16 v[24:27], v[104:107], v[160:163], v[24:27]
  v_mfma_f32_16x16x32_bf16 v[28:31], v[104:107], v[164:167], v[28:31]
  v_mfma_f32_16x16x32_bf16 v[32:35], v[104:107], v[168:171], v[32:35]
  v_mfma_f32_16x16x32_bf16 v[36:39], v[104:107], v[172:175], v[36:39]
  v_mfma_f32_16x16x32_bf16 v[40:43], v[108:111], v[160:163], v[40:43]
  v_mfma_f32_16x16x32_bf16 v[44:47], v[108:111], v[164:167], v[44:47]
  v_mfma_f32_16x16x32_bf16 v[48:51], v[108:111], v[168:171], v[48:51]
  v_mfma_f32_16x16x32_bf16 v[52:55], v[108:111], v[172:175], v[52:55]
  s_waitcnt lgkmcnt(14)
  v_mfma_f32_16x16x32_bf16 v[56:59], v[112:115], v[160:163], v[56:59]
  v_mfma_f32_16x16x32_bf16 v[60:63], v[112:115], v[164:167], v[60:63]
  v_mfma_f32_16x16x32_bf16 v[64:67], v[112:115], v[168:171], v[64:67]
  v_mfma_f32_16x16x32_bf16 v[68:71], v[112:115], v[172:175], v[68:71]
  s_waitcnt lgkmcnt(12)
  v_mfma_f32_16x16x32_bf16 v[72:75], v[116:119], v[160:163], v[72:75]
  v_mfma_f32_16x16x32_bf16 v[76:79], v[116:119], v[164:167], v[76:79]
  v_mfma_f32_16x16x32_bf16 v[80:83], v[116:119], v[168:171], v[80:83]
  v_mfma_f32_16x16x32_bf16 v[84:87], v[116:119], v[172:175], v[84:87]
  s_waitcnt lgkmcnt(10)
  v_mfma_f32_16x16x32_bf16 v[88:91], v[120:123], v[160:163], v[88:91]
  v_mfma_f32_16x16x32_bf16 v[92:95], v[120:123], v[164:167], v[92:95]
  v_mfma_f32_16x16x32_bf16 v[96:99], v[120:123], v[168:171], v[96:99]
  v_mfma_f32_16x16x32_bf16 v[100:103], v[120:123], v[172:175], v[100:103]
  s_waitcnt vmcnt(0)
  s_waitcnt lgkmcnt(8)
  v_mfma_f32_16x16x32_bf16 v[24:27], v[124:127], v[176:179], v[24:27]
  v_mfma_f32_16x16x32_bf16 v[28:31], v[124:127], v[180:183], v[28:31]
  v_mfma_f32_16x16x32_bf16 v[32:35], v[124:127], v[184:187], v[32:35]
  v_mfma_f32_16x16x32_bf16 v[36:39], v[124:127], v[188:191], v[36:39]
  s_waitcnt lgkmcnt(6)
  v_mfma_f32_16x16x32_bf16 v[40:43], v[128:131], v[176:179], v[40:43]
  v_mfma_f32_16x16x32_bf16 v[44:47], v[128:131], v[180:183], v[44:47]
  v_mfma_f32_16x16x32_bf16 v[48:51], v[128:131], v[184:187], v[48:51]
  v_mfma_f32_16x16x32_bf16 v[52:55], v[128:131], v[188:191], v[52:55]
  s_waitcnt lgkmcnt(4)
  v_mfma_f32_16x16x32_bf16 v[56:59], v[132:135], v[176:179], v[56:59]
  v_mfma_f32_16x16x32_bf16 v[60:63], v[132:135], v[180:183], v[60:63]
  v_mfma_f32_16x16x32_bf16 v[64:67], v[132:135], v[184:187], v[64:67]
  v_mfma_f32_16x16x32_bf16 v[68:71], v[132:135], v[188:191], v[68:71]
  s_waitcnt lgkmcnt(2)
  v_mfma_f32_16x16x32_bf16 v[72:75], v[136:139], v[176:179], v[72:75]
  v_mfma_f32_16x16x32_bf16 v[76:79], v[136:139], v[180:183], v[76:79]
  v_mfma_f32_16x16x32_bf16 v[80:83], v[136:139], v[184:187], v[80:83]
  v_mfma_f32_16x16x32_bf16 v[84:87], v[136:139], v[188:191], v[84:87]
  s_waitcnt lgkmcnt(0)
  v_mfma_f32_16x16x32_bf16 v[88:91], v[140:143], v[176:179], v[88:91]
  v_mfma_f32_16x16x32_bf16 v[92:95], v[140:143], v[180:183], v[92:95]
  v_mfma_f32_16x16x32_bf16 v[96:99], v[140:143], v[184:187], v[96:99]
  v_mfma_f32_16x16x32_bf16 v[100:103], v[140:143], v[188:191], v[100:103]
  s_branch L_k2_fin
L_k2_f7:
  s_waitcnt vmcnt(13)
  ds_read_b64_tr_b16 v[104:105], v10 offset:0
  ds_read_b64_tr_b16 v[106:107], v10 offset:2560
  ds_read_b64_tr_b16 v[108:109], v10 offset:32
  ds_read_b64_tr_b16 v[110:111], v10 offset:2592
  ds_read_b64_tr_b16 v[112:113], v10 offset:64
  ds_read_b64_tr_b16 v[114:115], v10 offset:2624
  ds_read_b64_tr_b16 v[116:117], v10 offset:96
  ds_read_b64_tr_b16 v[118:119], v10 offset:2656
  ds_read_b64_tr_b16 v[120:121], v10 offset:128
  ds_read_b64_tr_b16 v[122:123], v10 offset:2688
  s_waitcnt vmcnt(4)
  ds_read_b64_tr_b16 v[124:125], v10 offset:5120
  ds_read_b64_tr_b16 v[126:127], v10 offset:7680
  ds_read_b64_tr_b16 v[128:129], v10 offset:5152
  ds_read_b64_tr_b16 v[130:131], v10 offset:7712
  ds_read_b64_tr_b16 v[132:133], v10 offset:5184
  ds_read_b64_tr_b16 v[134:135], v10 offset:7744
  ds_read_b64_tr_b16 v[136:137], v10 offset:5216
  ds_read_b64_tr_b16 v[138:139], v10 offset:7776
  ds_read_b64_tr_b16 v[140:141], v10 offset:5248
  ds_read_b64_tr_b16 v[142:143], v10 offset:7808
  s_add_u32 s43, s57, 61440
  s_add_u32 m0, s47, 10240
  s_nop 0
  buffer_load_dwordx4 v4, s[36:39], s43 offen offset:0 lds
  buffer_load_dwordx4 v4, s[36:39], s43 offen offset:1024 lds
  buffer_load_dwordx4 v4, s[36:39], s43 offen offset:2048 lds
  buffer_load_dwordx4 v4, s[36:39], s43 offen offset:3072 lds
  s_add_u32 s43, s43, 4096
  s_add_u32 m0, s47, 14336
  s_nop 0
  buffer_load_dwordx4 v4, s[36:39], s43 offen lds
  s_add_u32 s43, s57, 92160
  s_add_u32 m0, s47, 15360
  s_nop 0
  buffer_load_dwordx4 v4, s[36:39], s43 offen offset:0 lds
  buffer_load_dwordx4 v4, s[36:39], s43 offen offset:1024 lds
  buffer_load_dwordx4 v4, s[36:39], s43 offen offset:2048 lds
  buffer_load_dwordx4 v4, s[36:39], s43 offen offset:3072 lds
  s_add_u32 s43, s43, 4096
  s_add_u32 m0, s47, 19456
  s_nop 0
  buffer_load_dwordx4 v4, s[36:39], s43 offen lds
  s_add_u32 s43, s48, 12288
  buffer_load_dwordx4 v[176:179], v4, s[36:39], s43 offen
  s_add_u32 s43, s49, 12288
  buffer_load_dwordx4 v[180:183], v4, s[36:39], s43 offen
  s_add_u32 s43, s50, 12288
  buffer_load_dwordx4 v[184:187], v4, s[36:39], s43 offen
  s_add_u32 s43, s51, 12288
  buffer_load_dwordx4 v[188:191], v4, s[36:39], s43 offen
  s_add_u32 s43, s48, 18432
  buffer_load_dwordx4 v[192:195], v4, s[36:39], s43 offen
  s_add_u32 s43, s49, 18432
  buffer_load_dwordx4 v[196:199], v4, s[36:39], s43 offen
  s_add_u32 s43, s50, 18432
  buffer_load_dwordx4 v[200:203], v4, s[36:39], s43 offen
  s_add_u32 s43, s51, 18432
  buffer_load_dwordx4 v[204:207], v4, s[36:39], s43 offen
  s_waitcnt lgkmcnt(15)
  v_mfma_f32_16x16x32_bf16 v[24:27], v[104:107], v[144:147], 0
  v_mfma_f32_16x16x32_bf16 v[28:31], v[104:107], v[148:151], 0
  v_mfma_f32_16x16x32_bf16 v[32:35], v[104:107], v[152:155], 0
  v_mfma_f32_16x16x32_bf16 v[36:39], v[104:107], v[156:159], 0
  v_mfma_f32_16x16x32_bf16 v[40:43], v[108:111], v[144:147], 0
  v_mfma_f32_16x16x32_bf16 v[44:47], v[108:111], v[148:151], 0
  v_mfma_f32_16x16x32_bf16 v[48:51], v[108:111], v[152:155], 0
  v_mfma_f32_16x16x32_bf16 v[52:55], v[108:111], v[156:159], 0
  s_waitcnt lgkmcnt(14)
  v_mfma_f32_16x16x32_bf16 v[56:59], v[112:115], v[144:147], 0
  v_mfma_f32_16x16x32_bf16 v[60:63], v[112:115], v[148:151], 0
  v_mfma_f32_16x16x32_bf16 v[64:67], v[112:115], v[152:155], 0
  v_mfma_f32_16x16x32_bf16 v[68:71], v[112:115], v[156:159], 0
  s_waitcnt lgkmcnt(12)
  v_mfma_f32_16x16x32_bf16 v[72:75], v[116:119], v[144:147], 0
  v_mfma_f32_16x16x32_bf16 v[76:79], v[116:119], v[148:151], 0
  v_mfma_f32_16x16x32_bf16 v[80:83], v[116:119], v[152:155], 0
  v_mfma_f32_16x16x32_bf16 v[84:87], v[116:119], v[156:159], 0
  s_waitcnt lgkmcnt(10)
  v_mfma_f32_16x16x32_bf16 v[88:91], v[120:123], v[144:147], 0
  v_mfma_f32_16x16x32_bf16 v[92:95], v[120:123], v[148:151], 0
  v_mfma_f32_16x16x32_bf16 v[96:99], v[120:123], v[152:155], 0
  v_mfma_f32_16x16x32_bf16 v[100:103], v[120:123], v[156:159], 0
  s_waitcnt vmcnt(13)
  ds_read_b64_tr_b16 v[104:105], v10 offset:10240
  ds_read_b64_tr_b16 v[106:107], v10 offset:12800
  ds_read_b64_tr_b16 v[108:109], v10 offset:10272
  ds_read_b64_tr_b16 v[110:111], v10 offset:12832
  ds_read_b64_tr_b16 v[112:113], v10 offset:10304
  ds_read_b64_tr_b16 v[114:115], v10 offset:12864
  ds_read_b64_tr_b16 v[116:117], v10 offset:10336
  ds_read_b64_tr_b16 v[118:119], v10 offset:12896
  ds_read_b64_tr_b16 v[120:121], v10 offset:10368
  ds_read_b64_tr_b16 v[122:123], v10 offset:12928
  s_add_u32 s43, s57, 122880
  s_add_u32 m0, s47, 0
  s_nop 0
  buffer_load_dwordx4 v4, s[36:39], s43 offen offset:0 lds
  buffer_load_dwordx4 v4, s[36:39], s43 offen offset:1024 lds
  buffer_load_dwordx4 v4, s[36:39], s43 offen offset:2048 lds
  buffer_load_dwordx4 v4, s[36:39], s43 offen offset:3072 lds
  s_add_u32 s43, s43, 4096
  s_add_u32 m0, s47, 4096
  s_nop 0
  buffer_load_dwordx4 v4, s[36:39], s43 offen lds
  s_add_u32 s43, s48, 24576
  buffer_load_dwordx4 v[208:211], v4, s[36:39], s43 offen
  s_add_u32 s43, s49, 24576
  buffer_load_dwordx4 v[212:215], v4, s[36:39], s43 offen
  s_add_u32 s43, s50, 24576
  buffer_load_dwordx4 v[216:219], v4, s[36:39], s43 offen
  s_add_u32 s43, s51, 24576
  buffer_load_dwordx4 v[220:223], v4, s[36:39], s43 offen
  s_waitcnt lgkmcnt(15)
  v_mfma_f32_16x16x32_bf16 v[24:27], v[124:127], v[160:163], v[24:27]
  v_mfma_f32_16x16x32_bf16 v[28:31], v[124:127], v[164:167], v[28:31]
  v_mfma_f32_16x16x32_bf16 v[32:35], v[124:127], v[168:171], v[32:35]
  v_mfma_f32_16x16x32_bf16 v[36:39], v[124:127], v[172:175], v[36:39]
  v_mfma_f32_16x16x32_bf16 v[40:43], v[128:131], v[160:163], v[40:43]
  v_mfma_f32_16x16x32_bf16 v[44:47], v[128:131], v[164:167], v[44:47]
  v_mfma_f32_16x16x32_bf16 v[48:51], v[128:131], v[168:171], v[48:51]
  v_mfma_f32_16x16x32_bf16 v[52:55], v[128:131], v[172:175], v[52:55]
  s_waitcnt lgkmcnt(14)
  v_mfma_f32_16x16x32_bf16 v[56:59], v[132:135], v[160:163], v[56:59]
  v_mfma_f32_16x16x32_bf16 v[60:63], v[132:135], v[164:167], v[60:63]
  v_mfma_f32_16x16x32_bf16 v[64:67], v[132:135], v[168:171], v[64:67]
  v_mfma_f32_16x16x32_bf16 v[68:71], v[132:135], v[172:175], v[68:71]
  s_waitcnt lgkmcnt(12)
  v_mfma_f32_16x16x32_bf16 v[72:75], v[136:139], v[160:163], v[72:75]
  v_mfma_f32_16x16x32_bf16 v[76:79], v[136:139], v[164:167], v[76:79]
  v_mfma_f32_16x16x32_bf16 v[80:83], v[136:139], v[168:171], v[80:83]
  v_mfma_f32_16x16x32_bf16 v[84:87], v[136:139], v[172:175], v[84:87]
  s_waitcnt lgkmcnt(10)
  v_mfma_f32_16x16x32_bf16 v[88:91], v[140:143], v[160:163], v[88:91]
  v_mfma_f32_16x16x32_bf16 v[92:95], v[140:143], v[164:167], v[92:95]
  v_mfma_f32_16x16x32_bf16 v[96:99], v[140:143], v[168:171], v[96:99]
  v_mfma_f32_16x16x32_bf16 v[100:103], v[140:143], v[172:175], v[100:103]
  s_waitcnt vmcnt(17)
  ds_read_b64_tr_b16 v[124:125], v10 offset:15360
  ds_read_b64_tr_b16 v[126:127], v10 offset:17920
  ds_read_b64_tr_b16 v[128:129], v10 offset:15392
  ds_read_b64_tr_b16 v[130:131], v10 offset:17952
  ds_read_b64_tr_b16 v[132:133], v10 offset:15424
  ds_read_b64_tr_b16 v[134:135], v10 offset:17984
  ds_read_b64_tr_b16 v[136:137], v10 offset:15456
  ds_read_b64_tr_b16 v[138:139], v10 offset:18016
  ds_read_b64_tr_b16 v[140:141], v10 offset:15488
  ds_read_b64_tr_b16 v[142:143], v10 offset:18048
  s_add_u32 s43, s57, 153600
  s_add_u32 m0, s47, 5120
  s_nop 0
  buffer_load_dwordx4 v4, s[36:39], s43 offen offset:0 lds
  buffer_load_dwordx4 v4, s[36:39], s43 offen offset:1024 lds
  buffer_load_dwordx4 v4, s[36:39], s43 offen offset:2048 lds
  buffer_load_dwordx4 v4, s[36:39], s43 offen offset:3072 lds
  s_add_u32 s43, s43, 4096
  s_add_u32 m0, s47, 9216
  s_nop 0
  buffer_load_dwordx4 v4, s[36:39], s43 offen lds
  s_add_u32 s43, s48, 30720
  buffer_load_dwordx4 v[224:227], v4, s[36:39], s43 offen
  s_add_u32 s43, s49, 30720
  buffer_load_dwordx4 v[228:231], v4, s[36:39], s43 offen
  s_add_u32 s43, s50, 30720
  buffer_load_dwordx4 v[232:235], v4, s[36:39], s43 offen
  s_add_u32 s43, s51, 30720
  buffer_load_dwordx4 v[236:239], v4, s[36:39], s43 offen
  s_waitcnt vmcnt(22)
  s_waitcnt lgkmcnt(15)
  v_mfma_f32_16x16x32_bf16 v[24:27], v[104:107], v[176:179], v[24:27]
  v_mfma_f32_16x16x32_bf16 v[28:31], v[104:107], v[180:183], v[28:31]
  v_mfma_f32_16x16x32_bf16 v[32:35], v[104:107], v[184:187], v[32:35]
  v_mfma_f32_16x16x32_bf16 v[36:39], v[104:107], v[188:191], v[36:39]
  v_mfma_f32_16x16x32_bf16 v[40:43], v[108:111], v[176:179], v[40:43]
  v_mfma_f32_16x16x32_bf16 v[44:47], v[108:111], v[180:183], v[44:47]
  v_mfma_f32_16x16x32_bf16 v[48:51], v[108:111], v[184:187], v[48:51]
  v_mfma_f32_16x16x32_bf16 v[52:55], v[108:111], v[188:191], v[52:55]
  s_waitcnt lgkmcnt(14)
  v_mfma_f32_16x16x32_bf16 v[56:59], v[112:115], v[176:179], v[56:59]
  v_mfma_f32_16x16x32_bf16 v[60:63], v[112:115], v[180:183], v[60:63]
  v_mfma_f32_16x16x32_bf16 v[64:67], v[112:115], v[184:187], v[64:67]
  v_mfma_f32_16x16x32_bf16 v[68:71], v[112:115], v[188:191], v[68:71]
  s_waitcnt lgkmcnt(12)
  v_mfma_f32_16x16x32_bf16 v[72:75], v[116:119], v[176:179], v[72:75]
  v_mfma_f32_16x16x32_bf16 v[76:79], v[116:119], v[180:183], v[76:79]
  v_mfma_f32_16x16x32_bf16 v[80:83], v[116:119], v[184:187], v[80:83]
  v_mfma_f32_16x16x32_bf16 v[84:87], v[116:119], v[188:191], v[84:87]
  s_waitcnt lgkmcnt(10)
  v_mfma_f32_16x16x32_bf16 v[88:91], v[120:123], v[176:179], v[88:91]
  v_mfma_f32_16x16x32_bf16 v[92:95], v[120:123], v[180:183], v[92:95]
  v_mfma_f32_16x16x32_bf16 v[96:99], v[120:123], v[184:187], v[96:99]
  v_mfma_f32_16x16x32_bf16 v[100:103], v[120:123], v[188:191], v[100:103]
  s_setprio 1
  s_waitcnt vmcnt(13)
  ds_read_b64_tr_b16 v[104:105], v10 offset:0
  ds_read_b64_tr_b16 v[106:107], v10 offset:2560
  ds_read_b64_tr_b16 v[108:109], v10 offset:32
  ds_read_b64_tr_b16 v[110:111], v10 offset:2592
  ds_read_b64_tr_b16 v[112:113], v10 offset:64
  ds_read_b64_tr_b16 v[114:115], v10 offset:2624
  ds_read_b64_tr_b16 v[116:117], v10 offset:96
  ds_read_b64_tr_b16 v[118:119], v10 offset:2656
  ds_read_b64_tr_b16 v[120:121], v10 offset:128
  ds_read_b64_tr_b16 v[122:123], v10 offset:2688
  s_add_u32 s43, s57, 184320
  s_add_u32 m0, s47, 10240
  s_nop 0
  buffer_load_dwordx4 v4, s[36:39], s43 offen offset:0 lds
  buffer_load_dwordx4 v4, s[36:39], s43 offen offset:1024 lds
  buffer_load_dwordx4 v4, s[36:39], s43 offen offset:2048 lds
  buffer_load_dwordx4 v4, s[36:39], s43 offen offset:3072 lds
  s_add_u32 s43, s43, 4096
  s_add_u32 m0, s47, 14336
  s_nop 0
  buffer_load_dwordx4 v4, s[36:39], s43 offen lds
  s_add_u32 s43, s48, 36864
  buffer_load_dwordx4 v[240:243], v4, s[36:39], s43 offen
  s_add_u32 s43, s49, 36864
  buffer_load_dwordx4 v[244:247], v4, s[36:39], s43 offen
  s_add_u32 s43, s50, 36864
  buffer_load_dwordx4 v[248:251], v4, s[36:39], s43 offen
  s_add_u32 s43, s51, 36864
  buffer_load_dwordx4 v[252:255], v4, s[36:39], s43 offen
  s_waitcnt lgkmcnt(15)
  v_mfma_f32_16x16x32_bf16 v[24:27], v[124:127], v[192:195], v[24:27]
  v_mfma_f32_16x16x32_bf16 v[28:31], v[124:127], v[196:199], v[28:31]
  v_mfma_f32_16x16x32_bf16 v[32:35], v[124:127], v[200:203], v[32:35]
  v_mfma_f32_16x16x32_bf16 v[36:39], v[124:127], v[204:207], v[36:39]
  v_mfma_f32_16x16x32_bf16 v[40:43], v[128:131], v[192:195], v[40:43]
  v_mfma_f32_16x16x32_bf16 v[44:47], v[128:131], v[196:199], v[44:47]
  v_mfma_f32_16x16x32_bf16 v[48:51], v[128:131], v[200:203], v[48:51]
  v_mfma_f32_16x16x32_bf16 v[52:55], v[128:131], v[204:207], v[52:55]
  s_waitcnt lgkmcnt(14)
  v_mfma_f32_16x16x32_bf16 v[56:59], v[132:135], v[192:195], v[56:59]
  v_mfma_f32_16x16x32_bf16 v[60:63], v[132:135], v[196:199], v[60:63]
  v_mfma_f32_16x16x32_bf16 v[64:67], v[132:135], v[200:203], v[64:67]
  v_mfma_f32_16x16x32_bf16 v[68:71], v[132:135], v[204:207], v[68:71]
  s_waitcnt lgkmcnt(12)
  v_mfma_f32_16x16x32_bf16 v[72:75], v[136:139], v[192:195], v[72:75]
  v_mfma_f32_16x16x32_bf16 v[76:79], v[136:139], v[196:199], v[76:79]
  v_mfma_f32_16x16x32_bf16 v[80:83], v[136:139], v[200:203], v[80:83]
  v_mfma_f32_16x16x32_bf16 v[84:87], v[136:139], v[204:207], v[84:87]
  s_waitcnt lgkmcnt(10)
  v_mfma_f32_16x16x32_bf16 v[88:91], v[140:143], v[192:195], v[88:91]
  v_mfma_f32_16x16x32_bf16 v[92:95], v[140:143], v[196:199], v[92:95]
  v_mfma_f32_16x16x32_bf16 v[96:99], v[140:143], v[200:203], v[96:99]
  v_mfma_f32_16x16x32_bf16 v[100:103], v[140:143], v[204:207], v[100:103]
  s_waitcnt vmcnt(13)
  ds_read_b64_tr_b16 v[124:125], v10 offset:5120
  ds_read_b64_tr_b16 v[126:127], v10 offset:7680
  ds_read_b64_tr_b16 v[128:129], v10 offset:5152
  ds_read_b64_tr_b16 v[130:131], v10 offset:7712
  ds_read_b64_tr_b16 v[132:133], v10 offset:5184
  ds_read_b64_tr_b16 v[134:135], v10 offset:7744
  ds_read_b64_tr_b16 v[136:137], v10 offset:5216
  ds_read_b64_tr_b16 v[138:139], v10 offset:7776
  ds_read_b64_tr_b16 v[140:141], v10 offset:5248
  ds_read_b64_tr_b16 v[142:143], v10 offset:7808
  s_waitcnt lgkmcnt(15)
  v_mfma_f32_16x16x32_bf16 v[24:27], v[104:107], v[208:211], v[24:27]
  v_mfma_f32_16x16x32_bf16 v[28:31], v[104:107], v[212:215], v[28:31]
  v_mfma_f32_16x16x32_bf16 v[32:35], v[104:107], v[216:219], v[32:35]
  v_mfma_f32_16x16x32_bf16 v[36:39], v[104:107], v[220:223], v[36:39]
  v_mfma_f32_16x16x32_bf16 v[40:43], v[108:111], v[208:211], v[40:43]
  v_mfma_f32_16x16x32_bf16 v[44:47], v[108:111], v[212:215], v[44:47]
  v_mfma_f32_16x16x32_bf16 v[48:51], v[108:111], v[216:219], v[48:51]
  v_mfma_f32_16x16x32_bf16 v[52:55], v[108:111], v[220:223], v[52:55]
  s_waitcnt lgkmcnt(14)
  v_mfma_f32_16x16x32_bf16 v[56:59], v[112:115], v[208:211], v[56:59]
  v_mfma_f32_16x16x32_bf16 v[60:63], v[112:115], v[212:215], v[60:63]
  v_mfma_f32_16x16x32_bf16 v[64:67], v[112:115], v[216:219], v[64:67]
  v_mfma_f32_16x16x32_bf16 v[68:71], v[112:115], v[220:223], v[68:71]
  s_waitcnt lgkmcnt(12)
  v_mfma_f32_16x16x32_bf16 v[72:75], v[116:119], v[208:211], v[72:75]
  v_mfma_f32_16x16x32_bf16 v[76:79], v[116:119], v[212:215], v[76:79]
  v_mfma_f32_16x16x32_bf16 v[80:83], v[116:119], v[216:219], v[80:83]
  v_mfma_f32_16x16x32_bf16 v[84:87], v[116:119], v[220:223], v[84:87]
  s_waitcnt lgkmcnt(10)
  v_mfma_f32_16x16x32_bf16 v[88:91], v[120:123], v[208:211], v[88:91]
  v_mfma_f32_16x16x32_bf16 v[92:95], v[120:123], v[212:215], v[92:95]
  v_mfma_f32_16x16x32_bf16 v[96:99], v[120:123], v[216:219], v[96:99]
  v_mfma_f32_16x16x32_bf16 v[100:103], v[120:123], v[220:223], v[100:103]
  s_waitcnt vmcnt(4)
  ds_read_b64_tr_b16 v[104:105], v10 offset:10240
  ds_read_b64_tr_b16 v[106:107], v10 offset:12800
  ds_read_b64_tr_b16 v[108:109], v10 offset:10272
  ds_read_b64_tr_b16 v[110:111], v10 offset:12832
  ds_read_b64_tr_b16 v[112:113], v10 offset:10304
  ds_read_b64_tr_b16 v[114:115], v10 offset:12864
  ds_read_b64_tr_b16 v[116:117], v10 offset:10336
  ds_read_b64_tr_b16 v[118:119], v10 offset:12896
  ds_read_b64_tr_b16 v[120:121], v10 offset:10368
  ds_read_b64_tr_b16 v[122:123], v10 offset:12928
  s_waitcnt lgkmcnt(15)
  v_mfma_f32_16x16x32_bf16 v[24:27], v[124:127], v[224:227], v[24:27]
  v_mfma_f32_16x16x32_bf16 v[28:31], v[124:127], v[228:231], v[28:31]
  v_mfma_f32_16x16x32_bf16 v[32:35], v[124:127], v[232:235], v[32:35]
  v_mfma_f32_16x16x32_bf16 v[36:39], v[124:127], v[236:239], v[36:39]
  v_mfma_f32_16x16x32_bf16 v[40:43], v[128:131], v[224:227], v[40:43]
  v_mfma_f32_16x16x32_bf16 v[44:47], v[128:131], v[228:231], v[44:47]
  v_mfma_f32_16x16x32_bf16 v[48:51], v[128:131], v[232:235], v[48:51]
  v_mfma_f32_16x16x32_bf16 v[52:55], v[128:131], v[236:239], v[52:55]
  s_waitcnt lgkmcnt(14)
  v_mfma_f32_16x16x32_bf16 v[56:59], v[132:135], v[224:227], v[56:59]
  v_mfma_f32_16x16x32_bf16 v[60:63], v[132:135], v[228:231], v[60:63]
  v_mfma_f32_16x16x32_bf16 v[64:67], v[132:135], v[232:235], v[64:67]
  v_mfma_f32_16x16x32_bf16 v[68:71], v[132:135], v[236:239], v[68:71]
  s_waitcnt lgkmcnt(12)
  v_mfma_f32_16x16x32_bf16 v[72:75], v[136:139], v[224:227], v[72:75]
  v_mfma_f32_16x16x32_bf16 v[76:79], v[136:139], v[228:231], v[76:79]
  v_mfma_f32_16x16x32_bf16 v[80:83], v[136:139], v[232:235], v[80:83]
  v_mfma_f32_16x16x32_bf16 v[84:87], v[136:139], v[236:239], v[84:87]
  s_waitcnt lgkmcnt(10)
  v_mfma_f32_16x16x32_bf16 v[88:91], v[140:143], v[224:227], v[88:91]
  v_mfma_f32_16x16x32_bf16 v[92:95], v[140:143], v[228:231], v[92:95]
  v_mfma_f32_16x16x32_bf16 v[96:99], v[140:143], v[232:235], v[96:99]
  v_mfma_f32_16x16x32_bf16 v[100:103], v[140:143], v[236:239], v[100:103]
  s_waitcnt vmcnt(0)
  s_waitcnt lgkmcnt(8)
  v_mfma_f32_16x16x32_bf16 v[24:27], v[104:107], v[240:243], v[24:27]
  v_mfma_f32_16x16x32_bf16 v[28:31], v[104:107], v[244:247], v[28:31]
  v_mfma_f32_16x16x32_bf16 v[32:35], v[104:107], v[248:251], v[32:35]
  v_mfma_f32_16x16x32_bf16 v[36:39], v[104:107], v[252:255], v[36:39]
  s_waitcnt lgkmcnt(6)
  v_mfma_f32_16x16x32_bf16 v[40:43], v[108:111], v[240:243], v[40:43]
  v_mfma_f32_16x16x32_bf16 v[44:47], v[108:111], v[244:247], v[44:47]
  v_mfma_f32_16x16x32_bf16 v[48:51], v[108:111], v[248:251], v[48:51]
  v_mfma_f32_16x16x32_bf16 v[52:55], v[108:111], v[252:255], v[52:55]
  s_waitcnt lgkmcnt(4)
  v_mfma_f32_16x16x32_bf16 v[56:59], v[112:115], v[240:243], v[56:59]
  v_mfma_f32_16x16x32_bf16 v[60:63], v[112:115], v[244:247], v[60:63]
  v_mfma_f32_16x16x32_bf16 v[64:67], v[112:115], v[248:251], v[64:67]
  v_mfma_f32_16x16x32_bf16 v[68:71], v[112:115], v[252:255], v[68:71]
  s_waitcnt lgkmcnt(2)
  v_mfma_f32_16x16x32_bf16 v[72:75], v[116:119], v[240:243], v[72:75]
  v_mfma_f32_16x16x32_bf16 v[76:79], v[116:119], v[244:247], v[76:79]
  v_mfma_f32_16x16x32_bf16 v[80:83], v[116:119], v[248:251], v[80:83]
  v_mfma_f32_16x16x32_bf16 v[84:87], v[116:119], v[252:255], v[84:87]
  s_waitcnt lgkmcnt(0)
  v_mfma_f32_16x16x32_bf16 v[88:91], v[120:123], v[240:243], v[88:91]
  v_mfma_f32_16x16x32_bf16 v[92:95], v[120:123], v[244:247], v[92:95]
  v_mfma_f32_16x16x32_bf16 v[96:99], v[120:123], v[248:251], v[96:99]
  v_mfma_f32_16x16x32_bf16 v[100:103], v[120:123], v[252:255], v[100:103]
  s_branch L_k2_fin
L_k2_att:
  s_setprio 3
  s_sub_u32 s58, s42, 6
  s_lshl_b32 s58, s58, 1
  s_lshl_b32 s43, s40, 2
  s_add_u32 s43, s43, 0
  s_lshl_b32 s43, s43, 3
  s_add_u32 s43, s43, s41
  s_mul_i32 s43, s43, 5120
  s_add_u32 s43, s43, 7077888
  s_add_u32 s45, s43, 4096
  buffer_load_dwordx4 v[56:59], v4, s[36:39], s45 offen
  s_lshl_b32 s45, s58, 10
  s_add_u32 s43, s43, s45
  buffer_load_dwordx4 v[24:27], v4, s[36:39], s43 offen offset:0
  buffer_load_dwordx4 v[40:43], v4, s[36:39], s43 offen offset:1024
  s_lshl_b32 s43, s40, 2
  s_add_u32 s43, s43, 1
  s_lshl_b32 s43, s43, 3
  s_add_u32 s43, s43, s41
  s_mul_i32 s43, s43, 5120
  s_add_u32 s43, s43, 7077888
  s_add_u32 s45, s43, 4096
  buffer_load_dwordx4 v[60:63], v4, s[36:39], s45 offen
  s_lshl_b32 s45, s58, 10
  s_add_u32 s43, s43, s45
  buffer_load_dwordx4 v[28:31], v4, s[36:39], s43 offen offset:0
  buffer_load_dwordx4 v[44:47], v4, s[36:39], s43 offen offset:1024
  s_lshl_b32 s43, s40, 2
  s_add_u32 s43, s43, 2
  s_lshl_b32 s43, s43, 3
  s_add_u32 s43, s43, s41
  s_mul_i32 s43, s43, 5120
  s_add_u32 s43, s43, 7077888
  s_add_u32 s45, s43, 4096
  buffer_load_dwordx4 v[64:67], v4, s[36:39], s45 offen
  s_lshl_b32 s45, s58, 10
  s_add_u32 s43, s43, s45
  buffer_load_dwordx4 v[32:35], v4, s[36:39], s43 offen offset:0
  buffer_load_dwordx4 v[48:51], v4, s[36:39], s43 offen offset:1024
  s_lshl_b32 s43, s40, 2
  s_add_u32 s43, s43, 3
  s_lshl_b32 s43, s43, 3
  s_add_u32 s43, s43, s41
  s_mul_i32 s43, s43, 5120
  s_add_u32 s43, s43, 7077888
  s_add_u32 s45, s43, 4096
  buffer_load_dwordx4 v[68:71], v4, s[36:39], s45 offen
  s_lshl_b32 s45, s58, 10
  s_add_u32 s43, s43, s45
  buffer_load_dwordx4 v[36:39], v4, s[36:39], s43 offen offset:0
  buffer_load_dwordx4 v[52:55], v4, s[36:39], s43 offen offset:1024
  s_lshl_b32 s45, s41, 2
  s_add_u32 s45, s45, s58
  s_mul_i32 s45, s45, 3360
  s_add_u32 s43, s45, 12320768
  s_add_u32 m0, s47, 0
  s_nop 0
  buffer_load_dwordx4 v4, s[36:39], s43 offen offset:0 lds
  buffer_load_dwordx4 v4, s[36:39], s43 offen offset:1024 lds
  buffer_load_dwordx4 v4, s[36:39], s43 offen offset:2048 lds
  buffer_load_dwordx4 v4, s[36:39], s43 offen offset:3072 lds
  s_add_u32 m0, s47, 4096
  s_add_u32 s43, s43, 4096
  buffer_load_dwordx4 v4, s[36:39], s43 offen offset:0 lds
  buffer_load_dwordx4 v4, s[36:39], s43 offen offset:1024 lds
  s_mov_b32 exec_hi, 0xf
  buffer_load_dwordx4 v4, s[36:39], s43 offen offset:2048 lds
  s_mov_b64 exec, -1
  s_add_u32 s43, s45, 12428288
  s_add_u32 m0, s47, 6720
  s_nop 0
  buffer_load_dwordx4 v4, s[36:39], s43 offen offset:0 lds
  buffer_load_dwordx4 v4, s[36:39], s43 offen offset:1024 lds
  buffer_load_dwordx4 v4, s[36:39], s43 offen offset:2048 lds
  buffer_load_dwordx4 v4, s[36:39], s43 offen offset:3072 lds
  s_add_u32 m0, s47, 10816
  s_add_u32 s43, s43, 4096
  buffer_load_dwordx4 v4, s[36:39], s43 offen offset:0 lds
  buffer_load_dwordx4 v4, s[36:39], s43 offen offset:1024 lds
  s_mov_b32 exec_hi, 0xf
  buffer_load_dwordx4 v4, s[36:39], s43 offen offset:2048 lds
  s_mov_b64 exec, -1
  s_add_u32 s43, s45, 12535808
  s_add_u32 m0, s47, 13440
  s_nop 0
  buffer_load_dwordx4 v4, s[36:39], s43 offen offset:0 lds
  buffer_load_dwordx4 v4, s[36:39], s43 offen offset:1024 lds
  buffer_load_dwordx4 v4, s[36:39], s43 offen offset:2048 lds
  buffer_load_dwordx4 v4, s[36:39], s43 offen offset:3072 lds
  s_add_u32 m0, s47, 17536
  s_add_u32 s43, s43, 4096
  buffer_load_dwordx4 v4, s[36:39], s43 offen offset:0 lds
  buffer_load_dwordx4 v4, s[36:39], s43 offen offset:1024 lds
  s_mov_b32 exec_hi, 0xf
  buffer_load_dwordx4 v4, s[36:39], s43 offen offset:2048 lds
  s_mov_b64 exec, -1
  v_mul_u32_u24 v11, 160, v2
  v_lshrrev_b32 v12, 2, v2
  v_add_u32 v12, 16, v12
  v_and_b32 v13, 3, v2
  v_cmp_eq_u32 vcc, 0, v13
  v_mov_b32 v13, 20
  s_nop 0
  v_cndmask_b32 v12, v13, v12, vcc
  v_mul_u32_u24 v12, 160, v12
  v_add_u32 v11, s47, v11
  v_add_u32 v12, s47, v12
  v_lshl_add_u32 v13, v3, 5, v11
  v_lshl_add_u32 v14, v3, 5, v12
  s_waitcnt vmcnt(0)
  ds_read_b128 v[72:75], v13 offset:0
  ds_read_b128 v[76:79], v13 offset:16
  ds_read_b128 v[80:83], v11 offset:128
  ds_read_b128 v[84:87], v11 offset:144
  ds_read_b128 v[88:91], v14 offset:0
  ds_read_b128 v[92:95], v14 offset:16
  ds_read_b128 v[96:99], v12 offset:128
  ds_read_b128 v[100:103], v12 offset:144
  ds_read_b128 v[104:107], v13 offset:3360
  ds_read_b128 v[108:111], v13 offset:3376
  ds_read_b128 v[112:115], v11 offset:3488
  ds_read_b128 v[116:119], v11 offset:3504
  ds_read_b128 v[120:123], v14 offset:3360
  ds_read_b128 v[124:127], v14 offset:3376
  ds_read_b128 v[128:131], v12 offset:3488
  ds_read_b128 v[132:135], v12 offset:3504
  s_waitcnt lgkmcnt(0)
  ds_read_b128 v[168:171], v13 offset:6720
  ds_read_b128 v[172:175], v13 offset:6736
  ds_read_b128 v[176:179], v11 offset:6848
  ds_read_b128 v[180:183], v11 offset:6864
  ds_read_b128 v[184:187], v14 offset:6720
  ds_read_b128 v[188:191], v14 offset:6736
  ds_read_b128 v[192:195], v12 offset:6848
  ds_read_b128 v[196:199], v12 offset:6864
  ds_read_b128 v[200:203], v13 offset:10080
  ds_read_b128 v[204:207], v13 offset:10096
  ds_read_b128 v[208:211], v11 offset:10208
  ds_read_b128 v[212:215], v11 offset:10224
  ds_read_b128 v[216:219], v14 offset:10080
  ds_read_b128 v[220:223], v14 offset:10096
  ds_read_b128 v[224:227], v12 offset:10208
  ds_read_b128 v[228:231], v12 offset:10224
  s_waitcnt lgkmcnt(0)
  v_add_f32 v72, v72, v168
  v_add_f32 v73, v73, v169
  v_add_f32 v74, v74, v170
  v_add_f32 v75, v75, v171
  v_add_f32 v76, v76, v172
  v_add_f32 v77, v77, v173
  v_add_f32 v78, v78, v174
  v_add_f32 v79, v79, v175
  v_add_f32 v80, v80, v176
  v_add_f32 v81, v81, v177
  v_add_f32 v82, v82, v178
  v_add_f32 v83, v83, v179
  v_add_f32 v84, v84, v180
  v_add_f32 v85, v85, v181
  v_add_f32 v86, v86, v182
  v_add_f32 v87, v87, v183
  v_add_f32 v88, v88, v184
  v_add_f32 v89, v89, v185
  v_add_f32 v90, v90, v186
  v_add_f32 v91, v91, v187
  v_add_f32 v92, v92, v188
  v_add_f32 v93, v93, v189
  v_add_f32 v94, v94, v190
  v_add_f32 v95, v95, v191
  v_add_f32 v96, v96, v192
  v_add_f32 v97, v97, v193
  v_add_f32 v98, v98, v194
  v_add_f32 v99, v99, v195
  v_add_f32 v100, v100, v196
  v_add_f32 v101, v101, v197
  v_add_f32 v102, v102, v198
  v_add_f32 v103, v103, v199
  v_add_f32 v104, v104, v200
  v_add_f32 v105, v105, v201
  v_add_f32 v106, v106, v202
  v_add_f32 v107, v107, v203
  v_add_f32 v108, v108, v204
  v_add_f32 v109, v109, v205
  v_add_f32 v110, v110, v206
  v_add_f32 v111, v111, v207
  v_add_f32 v112, v112, v208
  v_add_f32 v113, v113, v209
  v_add_f32 v114, v114, v210
  v_add_f32 v115, v115, v211
  v_add_f32 v116, v116, v212
  v_add_f32 v117, v117, v213
  v_add_f32 v118, v118, v214
  v_add_f32 v119, v119, v215
  v_add_f32 v120, v120, v216
  v_add_f32 v121, v121, v217
  v_add_f32 v122, v122, v218
  v_add_f32 v123, v123, v219
  v_add_f32 v124, v124, v220
  v_add_f32 v125, v125, v221
  v_add_f32 v126, v126, v222
  v_add_f32 v127, v127, v223
  v_add_f32 v128, v128, v224
  v_add_f32 v129, v129, v225
  v_add_f32 v130, v130, v226
  v_add_f32 v131, v131, v227
  v_add_f32 v132, v132, v228
  v_add_f32 v133, v133, v229
  v_add_f32 v134, v134, v230
  v_add_f32 v135, v135, v231
  ds_read_b128 v[168:171], v13 offset:13440
  ds_read_b128 v[172:175], v13 offset:13456
  ds_read_b128 v[176:179], v11 offset:13568
  ds_read_b128 v[180:183], v11 offset:13584
  ds_read_b128 v[184:187], v14 offset:13440
  ds_read_b128 v[188:191], v14 offset:13456
  ds_read_b128 v[192:195], v12 offset:13568
  ds_read_b128 v[196:199], v12 offset:13584
  ds_read_b128 v[200:203], v13 offset:16800
  ds_read_b128 v[204:207], v13 offset:16816
  ds_read_b128 v[208:211], v11 offset:16928
  ds_read_b128 v[212:215], v11 offset:16944
  ds_read_b128 v[216:219], v14 offset:16800
  ds_read_b128 v[220:223], v14 offset:16816
  ds_read_b128 v[224:227], v12 offset:16928
  ds_read_b128 v[228:231], v12 offset:16944
  s_waitcnt lgkmcnt(0)
  v_add_f32 v72, v72, v168
  v_add_f32 v73, v73, v169
  v_add_f32 v74, v74, v170
  v_add_f32 v75, v75, v171
  v_add_f32 v76, v76, v172
  v_add_f32 v77, v77, v173
  v_add_f32 v78, v78, v174
  v_add_f32 v79, v79, v175
  v_add_f32 v80, v80, v176
  v_add_f32 v81, v81, v177
  v_add_f32 v82, v82, v178
  v_add_f32 v83, v83, v179
  v_add_f32 v84, v84, v180
  v_add_f32 v85, v85, v181
  v_add_f32 v86, v86, v182
  v_add_f32 v87, v87, v183
  v_add_f32 v88, v88, v184
  v_add_f32 v89, v89, v185
  v_add_f32 v90, v90, v186
  v_add_f32 v91, v91, v187
  v_add_f32 v92, v92, v188
  v_add_f32 v93, v93, v189
  v_add_f32 v94, v94, v190
  v_add_f32 v95, v95, v191
  v_add_f32 v96, v96, v192
  v_add_f32 v97, v97, v193
  v_add_f32 v98, v98, v194
  v_add_f32 v99, v99, v195
  v_add_f32 v100, v100, v196
  v_add_f32 v101, v101, v197
  v_add_f32 v102, v102, v198
  v_add_f32 v103, v103, v199
  v_add_f32 v104, v104, v200
  v_add_f32 v105, v105, v201
  v_add_f32 v106, v106, v202
  v_add_f32 v107, v107, v203
  v_add_f32 v108, v108, v204
  v_add_f32 v109, v109, v205
  v_add_f32 v110, v110, v206
  v_add_f32 v111, v111, v207
  v_add_f32 v112, v112, v208
  v_add_f32 v113, v113, v209
  v_add_f32 v114, v114, v210
  v_add_f32 v115, v115, v211
  v_add_f32 v116, v116, v212
  v_add_f32 v117, v117, v213
  v_add_f32 v118, v118, v214
  v_add_f32 v119, v119, v215
  v_add_f32 v120, v120, v216
  v_add_f32 v121, v121, v217
  v_add_f32 v122, v122, v218
  v_add_f32 v123, v123, v219
  v_add_f32 v124, v124, v220
  v_add_f32 v125, v125, v221
  v_add_f32 v126, v126, v222
  v_add_f32 v127, v127, v223
  v_add_f32 v128, v128, v224
  v_add_f32 v129, v129, v225
  v_add_f32 v130, v130, v226
  v_add_f32 v131, v131, v227
  v_add_f32 v132, v132, v228
  v_add_f32 v133, v133, v229
  v_add_f32 v134, v134, v230
  v_add_f32 v135, v135, v231
  v_cvt_pk_bf16_f32 v136, v72, v73
  v_cvt_pk_bf16_f32 v137, v74, v75
  v_cvt_pk_bf16_f32 v138, v76, v77
  v_cvt_pk_bf16_f32 v139, v78, v79
  v_cvt_pk_bf16_f32 v140, v80, v81
  v_cvt_pk_bf16_f32 v141, v82, v83
  v_cvt_pk_bf16_f32 v142, v84, v85
  v_cvt_pk_bf16_f32 v143, v86, v87
  v_cvt_pk_bf16_f32 v144, v88, v89
  v_cvt_pk_bf16_f32 v145, v90, v91
  v_cvt_pk_bf16_f32 v146, v92, v93
  v_cvt_pk_bf16_f32 v147, v94, v95
  v_cvt_pk_bf16_f32 v148, v96, v97
  v_cvt_pk_bf16_f32 v149, v98, v99
  v_cvt_pk_bf16_f32 v150, v100, v101
  v_cvt_pk_bf16_f32 v151, v102, v103
  v_cvt_pk_bf16_f32 v152, v104, v105
  v_cvt_pk_bf16_f32 v153, v106, v107
  v_cvt_pk_bf16_f32 v154, v108, v109
  v_cvt_pk_bf16_f32 v155, v110, v111
  v_cvt_pk_bf16_f32 v156, v112, v113
  v_cvt_pk_bf16_f32 v157, v114, v115
  v_cvt_pk_bf16_f32 v158, v116, v117
  v_cvt_pk_bf16_f32 v159, v118, v119
  v_cvt_pk_bf16_f32 v160, v120, v121
  v_cvt_pk_bf16_f32 v161, v122, v123
  v_cvt_pk_bf16_f32 v162, v124, v125
  v_cvt_pk_bf16_f32 v163, v126, v127
  v_cvt_pk_bf16_f32 v164, v128, v129
  v_cvt_pk_bf16_f32 v165, v130, v131
  v_cvt_pk_bf16_f32 v166, v132, v133
  v_cvt_pk_bf16_f32 v167, v134, v135
  s_add_u32 s45, s58, 0
  v_cmp_eq_u32 vcc, s45, v3
  s_nop 1
  v_cndmask_b32 v140, 0, v140, vcc
  v_cndmask_b32 v141, 0, v141, vcc
  v_cndmask_b32 v142, 0, v142, vcc
  v_cndmask_b32 v143, 0, v143, vcc
  v_cndmask_b32 v148, 0, v148, vcc
  v_cndmask_b32 v149, 0, v149, vcc
  v_cndmask_b32 v150, 0, v150, vcc
  v_cndmask_b32 v151, 0, v151, vcc
  s_add_u32 s45, s58, 1
  v_cmp_eq_u32 vcc, s45, v3
  s_nop 1
  v_cndmask_b32 v156, 0, v156, vcc
  v_cndmask_b32 v157, 0, v157, vcc
  v_cndmask_b32 v158, 0, v158, vcc
  v_cndmask_b32 v159, 0, v159, vcc
  v_cndmask_b32 v164, 0, v164, vcc
  v_cndmask_b32 v165, 0, v165, vcc
  v_cndmask_b32 v166, 0, v166, vcc
  v_cndmask_b32 v167, 0, v167, vcc
  v_mfma_f32_16x16x32_bf16 v[168:171], v[136:139], v[24:27], 0
  v_mfma_f32_16x16x32_bf16 v[172:175], v[144:147], v[24:27], 0
  v_mfma_f32_16x16x32_bf16 v[176:179], v[136:139], v[28:31], 0
  v_mfma_f32_16x16x32_bf16 v[180:183], v[144:147], v[28:31], 0
  v_mfma_f32_16x16x32_bf16 v[184:187], v[136:139], v[32:35], 0
  v_mfma_f32_16x16x32_bf16 v[188:191], v[144:147], v[32:35], 0
  v_mfma_f32_16x16x32_bf16 v[192:195], v[136:139], v[36:39], 0
  v_mfma_f32_16x16x32_bf16 v[196:199], v[144:147], v[36:39], 0
  v_mfma_f32_16x16x32_bf16 v[168:171], v[140:143], v[56:59], v[168:171]
  v_mfma_f32_16x16x32_bf16 v[172:175], v[148:151], v[56:59], v[172:175]
  v_mfma_f32_16x16x32_bf16 v[176:179], v[140:143], v[60:63], v[176:179]
  v_mfma_f32_16x16x32_bf16 v[180:183], v[148:151], v[60:63], v[180:183]
  v_mfma_f32_16x16x32_bf16 v[184:187], v[140:143], v[64:67], v[184:187]
  v_mfma_f32_16x16x32_bf16 v[188:191], v[148:151], v[64:67], v[188:191]
  v_mfma_f32_16x16x32_bf16 v[192:195], v[140:143], v[68:71], v[192:195]
  v_mfma_f32_16x16x32_bf16 v[196:199], v[148:151], v[68:71], v[196:199]
  v_mfma_f32_16x16x32_bf16 v[200:203], v[152:155], v[40:43], 0
  v_mfma_f32_16x16x32_bf16 v[204:207], v[160:163], v[40:43], 0
  v_mfma_f32_16x16x32_bf16 v[208:211], v[152:155], v[44:47], 0
  v_mfma_f32_16x16x32_bf16 v[212:215], v[160:163], v[44:47], 0
  v_mfma_f32_16x16x32_bf16 v[216:219], v[152:155], v[48:51], 0
  v_mfma_f32_16x16x32_bf16 v[220:223], v[160:163], v[48:51], 0
  v_mfma_f32_16x16x32_bf16 v[224:227], v[152:155], v[52:55], 0
  v_mfma_f32_16x16x32_bf16 v[228:231], v[160:163], v[52:55], 0
  v_mfma_f32_16x16x32_bf16 v[200:203], v[156:159], v[56:59], v[200:203]
  v_mfma_f32_16x16x32_bf16 v[204:207], v[164:167], v[56:59], v[204:207]
  v_mfma_f32_16x16x32_bf16 v[208:211], v[156:159], v[60:63], v[208:211]
  v_mfma_f32_16x16x32_bf16 v[212:215], v[164:167], v[60:63], v[212:215]
  v_mfma_f32_16x16x32_bf16 v[216:219], v[156:159], v[64:67], v[216:219]
  v_mfma_f32_16x16x32_bf16 v[220:223], v[164:167], v[64:67], v[220:223]
  v_mfma_f32_16x16x32_bf16 v[224:227], v[156:159], v[68:71], v[224:227]
  v_mfma_f32_16x16x32_bf16 v[228:231], v[164:167], v[68:71], v[228:231]
  s_lshl_b32 s43, s41, 2
  s_add_u32 s43, s43, s58
  s_lshr_b32 s44, s43, 3
  s_mul_i32 s44, s44, 5
  s_bfe_u32 s43, s43, 0x20001
  s_add_u32 s45, s44, s43
  s_lshl_b32 s45, s45, 10
  s_add_u32 s44, s44, 4
  s_lshl_b32 s44, s44, 10
  s_lshl_b32 s43, s43, 8
  s_add_u32 s44, s44, s43
  v_lshlrev_b32 v5, 2, v1
  s_mul_i32 s43, s40, 81920
  s_add_u32 s43, s43, 15970304
  s_add_u32 s45, s45, s43
  s_add_u32 s44, s44, s43
  v_add_f32 v173, 0x358637bd, v173
  v_add_f32 v181, 0x358637bd, v181
  v_add_f32 v189, 0x358637bd, v189
  v_add_f32 v197, 0x358637bd, v197
  v_rcp_f32 v173, v173
  v_rcp_f32 v181, v181
  v_rcp_f32 v189, v189
  v_rcp_f32 v197, v197
  v_mul_f32 v168, v168, v173
  v_mul_f32 v169, v169, v173
  v_mul_f32 v170, v170, v173
  v_mul_f32 v171, v171, v173
  v_mul_f32 v172, v172, v173
  v_mul_f32 v176, v176, v181
  v_mul_f32 v177, v177, v181
  v_mul_f32 v178, v178, v181
  v_mul_f32 v179, v179, v181
  v_mul_f32 v180, v180, v181
  v_mul_f32 v184, v184, v189
  v_mul_f32 v185, v185, v189
  v_mul_f32 v186, v186, v189
  v_mul_f32 v187, v187, v189
  v_mul_f32 v188, v188, v189
  v_mul_f32 v192, v192, v197
  v_mul_f32 v193, v193, v197
  v_mul_f32 v194, v194, v197
  v_mul_f32 v195, v195, v197
  v_mul_f32 v196, v196, v197
  v_add_f32 v205, 0x358637bd, v205
  v_add_f32 v213, 0x358637bd, v213
  v_add_f32 v221, 0x358637bd, v221
  v_add_f32 v229, 0x358637bd, v229
  v_rcp_f32 v205, v205
  v_rcp_f32 v213, v213
  v_rcp_f32 v221, v221
  v_rcp_f32 v229, v229
  v_mul_f32 v200, v200, v205
  v_mul_f32 v201, v201, v205
  v_mul_f32 v202, v202, v205
  v_mul_f32 v203, v203, v205
  v_mul_f32 v204, v204, v205
  v_mul_f32 v208, v208, v213
  v_mul_f32 v209, v209, v213
  v_mul_f32 v210, v210, v213
  v_mul_f32 v211, v211, v213
  v_mul_f32 v212, v212, v213
  v_mul_f32 v216, v216, v221
  v_mul_f32 v217, v217, v221
  v_mul_f32 v218, v218, v221
  v_mul_f32 v219, v219, v221
  v_mul_f32 v220, v220, v221
  v_mul_f32 v224, v224, v229
  v_mul_f32 v225, v225, v229
  v_mul_f32 v226, v226, v229
  v_mul_f32 v227, v227, v229
  v_mul_f32 v228, v228, v229
  v_cvt_pk_bf16_f32 v72, v168, v169
  v_cvt_pk_bf16_f32 v73, v170, v171
  v_cvt_pk_bf16_f32 v74, v200, v201
  v_cvt_pk_bf16_f32 v75, v202, v203
  v_cvt_pk_bf16_f32 v76, v172, v204
  buffer_store_dwordx4 v[72:75], v4, s[36:39], s45 offen sc1
  buffer_store_dword v76, v5, s[36:39], s44 offen sc1
  s_add_u32 s45, s45, 20480
  s_add_u32 s44, s44, 20480
  v_cvt_pk_bf16_f32 v80, v176, v177
  v_cvt_pk_bf16_f32 v81, v178, v179
  v_cvt_pk_bf16_f32 v82, v208, v209
  v_cvt_pk_bf16_f32 v83, v210, v211
  v_cvt_pk_bf16_f32 v84, v180, v212
  buffer_store_dwordx4 v[80:83], v4, s[36:39], s45 offen sc1
  buffer_store_dword v84, v5, s[36:39], s44 offen sc1
  s_add_u32 s45, s45, 20480
  s_add_u32 s44, s44, 20480
  v_cvt_pk_bf16_f32 v88, v184, v185
  v_cvt_pk_bf16_f32 v89, v186, v187
  v_cvt_pk_bf16_f32 v90, v216, v217
  v_cvt_pk_bf16_f32 v91, v218, v219
  v_cvt_pk_bf16_f32 v92, v188, v220
  buffer_store_dwordx4 v[88:91], v4, s[36:39], s45 offen sc1
  buffer_store_dword v92, v5, s[36:39], s44 offen sc1
  s_add_u32 s45, s45, 20480
  s_add_u32 s44, s44, 20480
  v_cvt_pk_bf16_f32 v96, v192, v193
  v_cvt_pk_bf16_f32 v97, v194, v195
  v_cvt_pk_bf16_f32 v98, v224, v225
  v_cvt_pk_bf16_f32 v99, v226, v227
  v_cvt_pk_bf16_f32 v100, v196, v228
  buffer_store_dwordx4 v[96:99], v4, s[36:39], s45 offen sc1
  buffer_store_dword v100, v5, s[36:39], s44 offen sc1
  s_add_u32 s45, s45, 20480
  s_add_u32 s44, s44, 20480
  s_lshl_b32 s43, s40, 2
  s_add_u32 s43, s43, 0
  s_mul_i32 s43, s43, 20
  s_mul_i32 s45, s58, 5
  s_add_u32 s43, s43, s45
  s_lshl_b32 s43, s43, 10
  s_add_u32 s48, s43, 15970304
  s_lshl_b32 s43, s40, 2
  s_add_u32 s43, s43, 1
  s_mul_i32 s43, s43, 20
  s_mul_i32 s45, s58, 5
  s_add_u32 s43, s43, s45
  s_lshl_b32 s43, s43, 10
  s_add_u32 s49, s43, 15970304
  s_lshl_b32 s43, s40, 2
  s_add_u32 s43, s43, 2
  s_mul_i32 s43, s43, 20
  s_mul_i32 s45, s58, 5
  s_add_u32 s43, s43, s45
  s_lshl_b32 s43, s43, 10
  s_add_u32 s50, s43, 15970304
  s_lshl_b32 s43, s40, 2
  s_add_u32 s43, s43, 3
  s_mul_i32 s43, s43, 20
  s_mul_i32 s45, s58, 5
  s_add_u32 s43, s43, s45
  s_lshl_b32 s43, s43, 10
  s_add_u32 s51, s43, 15970304
  v_mov_b32 v11, 1
  s_lshl_b32 s43, s40, 8
  s_add_u32 s43, s43, 18591744
  v_mov_b32 v12, s43
  s_waitcnt vmcnt(0)
  s_mov_b64 exec, 1
  buffer_atomic_add v11, v12, s[36:39], 0 offen sc1
  s_mov_b64 exec, -1
  s_add_u32 s43, s57, 0
  s_add_u32 m0, s47, 0
  s_nop 0
  buffer_load_dwordx4 v4, s[36:39], s43 offen offset:0 lds
  buffer_load_dwordx4 v4, s[36:39], s43 offen offset:1024 lds
  buffer_load_dwordx4 v4, s[36:39], s43 offen offset:2048 lds
  buffer_load_dwordx4 v4, s[36:39], s43 offen offset:3072 lds
  s_add_u32 s43, s43, 4096
  s_add_u32 m0, s47, 4096
  s_nop 0
  buffer_load_dwordx4 v4, s[36:39], s43 offen lds
  s_add_u32 s43, s57, 5120
  s_add_u32 m0, s47, 5120
  s_nop 0
  buffer_load_dwordx4 v4, s[36:39], s43 offen offset:0 lds
  buffer_load_dwordx4 v4, s[36:39], s43 offen offset:1024 lds
  buffer_load_dwordx4 v4, s[36:39], s43 offen offset:2048 lds
  buffer_load_dwordx4 v4, s[36:39], s43 offen offset:3072 lds
  s_add_u32 s43, s43, 4096
  s_add_u32 m0, s47, 9216
  s_nop 0
  buffer_load_dwordx4 v4, s[36:39], s43 offen lds
  s_add_u32 s43, s57, 10240
  s_add_u32 m0, s47, 10240
  s_nop 0
  buffer_load_dwordx4 v4, s[36:39], s43 offen offset:0 lds
  buffer_load_dwordx4 v4, s[36:39], s43 offen offset:1024 lds
  buffer_load_dwordx4 v4, s[36:39], s43 offen offset:2048 lds
  buffer_load_dwordx4 v4, s[36:39], s43 offen offset:3072 lds
  s_add_u32 s43, s43, 4096
  s_add_u32 m0, s47, 14336
  s_nop 0
  buffer_load_dwordx4 v4, s[36:39], s43 offen lds
  s_add_u32 s43, s57, 15360
  s_add_u32 m0, s47, 15360
  s_nop 0
  buffer_load_dwordx4 v4, s[36:39], s43 offen offset:0 lds
  buffer_load_dwordx4 v4, s[36:39], s43 offen offset:1024 lds
  buffer_load_dwordx4 v4, s[36:39], s43 offen offset:2048 lds
  buffer_load_dwordx4 v4, s[36:39], s43 offen offset:3072 lds
  s_add_u32 s43, s43, 4096
  s_add_u32 m0, s47, 19456
  s_nop 0
  buffer_load_dwordx4 v4, s[36:39], s43 offen lds
  s_setprio 0
L_k2_poll:
  s_sleep 4
  buffer_load_dword v11, v12, s[36:39], 0 offen sc1
  s_waitcnt vmcnt(0)
  v_readfirstlane_b32 s43, v11
  s_nop 0
  s_cmp_ge_u32 s43, 16
  s_cbranch_scc0 L_k2_poll
  s_setprio 3
L_k2_g:
  s_add_u32 s43, s48, 0
  buffer_load_dwordx4 v[144:147], v4, s[36:39], s43 offen sc1
  s_add_u32 s43, s49, 0
  buffer_load_dwordx4 v[148:151], v4, s[36:39], s43 offen sc1
  s_add_u32 s43, s50, 0
  buffer_load_dwordx4 v[152:155], v4, s[36:39], s43 offen sc1
  s_add_u32 s43, s51, 0
  buffer_load_dwordx4 v[156:159], v4, s[36:39], s43 offen sc1
  s_add_u32 s43, s48, 1024
  buffer_load_dwordx4 v[160:163], v4, s[36:39], s43 offen sc1
  s_add_u32 s43, s49, 1024
  buffer_load_dwordx4 v[164:167], v4, s[36:39], s43 offen sc1
  s_add_u32 s43, s50, 1024
  buffer_load_dwordx4 v[168:171], v4, s[36:39], s43 offen sc1
  s_add_u32 s43, s51, 1024
  buffer_load_dwordx4 v[172:175], v4, s[36:39], s43 offen sc1
  s_add_u32 s43, s48, 2048
  buffer_load_dwordx4 v[176:179], v4, s[36:39], s43 offen sc1
  s_add_u32 s43, s49, 2048
  buffer_load_dwordx4 v[180:183], v4, s[36:39], s43 offen sc1
  s_add_u32 s43, s50, 2048
  buffer_load_dwordx4 v[184:187], v4, s[36:39], s43 offen sc1
  s_add_u32 s43, s51, 2048
  buffer_load_dwordx4 v[188:191], v4, s[36:39], s43 offen sc1
  s_add_u32 s43, s48, 3072
  buffer_load_dwordx4 v[192:195], v4, s[36:39], s43 offen sc1
  s_add_u32 s43, s49, 3072
  buffer_load_dwordx4 v[196:199], v4, s[36:39], s43 offen sc1
  s_add_u32 s43, s50, 3072
  buffer_load_dwordx4 v[200:203], v4, s[36:39], s43 offen sc1
  s_add_u32 s43, s51, 3072
  buffer_load_dwordx4 v[204:207], v4, s[36:39], s43 offen sc1
  ds_read_b64_tr_b16 v[104:105], v10 offset:0
  ds_read_b64_tr_b16 v[106:107], v10 offset:2560
  ds_read_b64_tr_b16 v[108:109], v10 offset:32
  ds_read_b64_tr_b16 v[110:111], v10 offset:2592
  ds_read_b64_tr_b16 v[112:113], v10 offset:64
  ds_read_b64_tr_b16 v[114:115], v10 offset:2624
  ds_read_b64_tr_b16 v[116:117], v10 offset:96
  ds_read_b64_tr_b16 v[118:119], v10 offset:2656
  ds_read_b64_tr_b16 v[120:121], v10 offset:128
  ds_read_b64_tr_b16 v[122:123], v10 offset:2688
  ds_read_b64_tr_b16 v[124:125], v10 offset:5120
  ds_read_b64_tr_b16 v[126:127], v10 offset:7680
  ds_read_b64_tr_b16 v[128:129], v10 offset:5152
  ds_read_b64_tr_b16 v[130:131], v10 offset:7712
  ds_read_b64_tr_b16 v[132:133], v10 offset:5184
  ds_read_b64_tr_b16 v[134:135], v10 offset:7744
  ds_read_b64_tr_b16 v[136:137], v10 offset:5216
  ds_read_b64_tr_b16 v[138:139], v10 offset:7776
  ds_read_b64_tr_b16 v[140:141], v10 offset:5248
  ds_read_b64_tr_b16 v[142:143], v10 offset:7808
  s_waitcnt vmcnt(12)
  s_waitcnt lgkmcnt(15)
  v_mfma_f32_16x16x32_bf16 v[24:27], v[104:107], v[144:147], 0
  v_mfma_f32_16x16x32_bf16 v[28:31], v[104:107], v[148:151], 0
  v_mfma_f32_16x16x32_bf16 v[32:35], v[104:107], v[152:155], 0
  v_mfma_f32_16x16x32_bf16 v[36:39], v[104:107], v[156:159], 0
  v_mfma_f32_16x16x32_bf16 v[40:43], v[108:111], v[144:147], 0
  v_mfma_f32_16x16x32_bf16 v[44:47], v[108:111], v[148:151], 0
  v_mfma_f32_16x16x32_bf16 v[48:51], v[108:111], v[152:155], 0
  v_mfma_f32_16x16x32_bf16 v[52:55], v[108:111], v[156:159], 0
  s_waitcnt lgkmcnt(14)
  v_mfma_f32_16x16x32_bf16 v[56:59], v[112:115], v[144:147], 0
  v_mfma_f32_16x16x32_bf16 v[60:63], v[112:115], v[148:151], 0
  v_mfma_f32_16x16x32_bf16 v[64:67], v[112:115], v[152:155], 0
  v_mfma_f32_16x16x32_bf16 v[68:71], v[112:115], v[156:159], 0
  s_waitcnt lgkmcnt(12)
  v_mfma_f32_16x16x32_bf16 v[72:75], v[116:119], v[144:147], 0
  v_mfma_f32_16x16x32_bf16 v[76:79], v[116:119], v[148:151], 0
  v_mfma_f32_16x16x32_bf16 v[80:83], v[116:119], v[152:155], 0
  v_mfma_f32_16x16x32_bf16 v[84:87], v[116:119], v[156:159], 0
  s_waitcnt lgkmcnt(10)
  v_mfma_f32_16x16x32_bf16 v[88:91], v[120:123], v[144:147], 0
  v_mfma_f32_16x16x32_bf16 v[92:95], v[120:123], v[148:151], 0
  v_mfma_f32_16x16x32_bf16 v[96:99], v[120:123], v[152:155], 0
  v_mfma_f32_16x16x32_bf16 v[100:103], v[120:123], v[156:159], 0
  ds_read_b64_tr_b16 v[104:105], v10 offset:10240
  ds_read_b64_tr_b16 v[106:107], v10 offset:12800
  ds_read_b64_tr_b16 v[108:109], v10 offset:10272
  ds_read_b64_tr_b16 v[110:111], v10 offset:12832
  ds_read_b64_tr_b16 v[112:113], v10 offset:10304
  ds_read_b64_tr_b16 v[114:115], v10 offset:12864
  ds_read_b64_tr_b16 v[116:117], v10 offset:10336
  ds_read_b64_tr_b16 v[118:119], v10 offset:12896
  ds_read_b64_tr_b16 v[120:121], v10 offset:10368
  ds_read_b64_tr_b16 v[122:123], v10 offset:12928
  s_add_u32 s43, s57, 20480
  s_add_u32 m0, s47, 0
  s_nop 0
  buffer_load_dwordx4 v4, s[36:39], s43 offen offset:0 lds
  buffer_load_dwordx4 v4, s[36:39], s43 offen offset:1024 lds
  buffer_load_dwordx4 v4, s[36:39], s43 offen offset:2048 lds
  buffer_load_dwordx4 v4, s[36:39], s43 offen offset:3072 lds
  s_add_u32 s43, s43, 4096
  s_add_u32 m0, s47, 4096
  s_nop 0
  buffer_load_dwordx4 v4, s[36:39], s43 offen lds
  s_add_u32 s43, s48, 4096
  buffer_load_dword v208, v5, s[36:39], s43 offen offset:0 sc1
  buffer_load_dword v209, v5, s[36:39], s43 offen offset:256 sc1
  buffer_load_dword v210, v5, s[36:39], s43 offen offset:512 sc1
  buffer_load_dword v211, v5, s[36:39], s43 offen offset:768 sc1
  s_add_u32 s43, s49, 4096
  buffer_load_dword v212, v5, s[36:39], s43 offen offset:0 sc1
  buffer_load_dword v213, v5, s[36:39], s43 offen offset:256 sc1
  buffer_load_dword v214, v5, s[36:39], s43 offen offset:512 sc1
  buffer_load_dword v215, v5, s[36:39], s43 offen offset:768 sc1
  s_add_u32 s43, s50, 4096
  buffer_load_dword v216, v5, s[36:39], s43 offen offset:0 sc1
  buffer_load_dword v217, v5, s[36:39], s43 offen offset:256 sc1
  buffer_load_dword v218, v5, s[36:39], s43 offen offset:512 sc1
  buffer_load_dword v219, v5, s[36:39], s43 offen offset:768 sc1
  s_add_u32 s43, s51, 4096
  buffer_load_dword v220, v5, s[36:39], s43 offen offset:0 sc1
  buffer_load_dword v221, v5, s[36:39], s43 offen offset:256 sc1
  buffer_load_dword v222, v5, s[36:39], s43 offen offset:512 sc1
  buffer_load_dword v223, v5, s[36:39], s43 offen offset:768 sc1
  s_waitcnt vmcnt(29)
  s_waitcnt lgkmcnt(15)
  v_mfma_f32_16x16x32_bf16 v[24:27], v[124:127], v[160:163], v[24:27]
  v_mfma_f32_16x16x32_bf16 v[28:31], v[124:127], v[164:167], v[28:31]
  v_mfma_f32_16x16x32_bf16 v[32:35], v[124:127], v[168:171], v[32:35]
  v_mfma_f32_16x16x32_bf16 v[36:39], v[124:127], v[172:175], v[36:39]
  v_mfma_f32_16x16x32_bf16 v[40:43], v[128:131], v[160:163], v[40:43]
  v_mfma_f32_16x16x32_bf16 v[44:47], v[128:131], v[164:167], v[44:47]
  v_mfma_f32_16x16x32_bf16 v[48:51], v[128:131], v[168:171], v[48:51]
  v_mfma_f32_16x16x32_bf16 v[52:55], v[128:131], v[172:175], v[52:55]
  s_waitcnt lgkmcnt(14)
  v_mfma_f32_16x16x32_bf16 v[56:59], v[132:135], v[160:163], v[56:59]
  v_mfma_f32_16x16x32_bf16 v[60:63], v[132:135], v[164:167], v[60:63]
  v_mfma_f32_16x16x32_bf16 v[64:67], v[132:135], v[168:171], v[64:67]
  v_mfma_f32_16x16x32_bf16 v[68:71], v[132:135], v[172:175], v[68:71]
  s_waitcnt lgkmcnt(12)
  v_mfma_f32_16x16x32_bf16 v[72:75], v[136:139], v[160:163], v[72:75]
  v_mfma_f32_16x16x32_bf16 v[76:79], v[136:139], v[164:167], v[76:79]
  v_mfma_f32_16x16x32_bf16 v[80:83], v[136:139], v[168:171], v[80:83]
  v_mfma_f32_16x16x32_bf16 v[84:87], v[136:139], v[172:175], v[84:87]
  s_waitcnt lgkmcnt(10)
  v_mfma_f32_16x16x32_bf16 v[88:91], v[140:143], v[160:163], v[88:91]
  v_mfma_f32_16x16x32_bf16 v[92:95], v[140:143], v[164:167], v[92:95]
  v_mfma_f32_16x16x32_bf16 v[96:99], v[140:143], v[168:171], v[96:99]
  v_mfma_f32_16x16x32_bf16 v[100:103], v[140:143], v[172:175], v[100:103]
  ds_read_b64_tr_b16 v[124:125], v10 offset:15360
  ds_read_b64_tr_b16 v[126:127], v10 offset:17920
  ds_read_b64_tr_b16 v[128:129], v10 offset:15392
  ds_read_b64_tr_b16 v[130:131], v10 offset:17952
  ds_read_b64_tr_b16 v[132:133], v10 offset:15424
  ds_read_b64_tr_b16 v[134:135], v10 offset:17984
  ds_read_b64_tr_b16 v[136:137], v10 offset:15456
  ds_read_b64_tr_b16 v[138:139], v10 offset:18016
  ds_read_b64_tr_b16 v[140:141], v10 offset:15488
  ds_read_b64_tr_b16 v[142:143], v10 offset:18048
  s_add_u32 s43, s57, 25600
  s_add_u32 m0, s47, 5120
  s_nop 0
  buffer_load_dwordx4 v4, s[36:39], s43 offen offset:0 lds
  buffer_load_dwordx4 v4, s[36:39], s43 offen offset:1024 lds
  buffer_load_dwordx4 v4, s[36:39], s43 offen offset:2048 lds
  buffer_load_dwordx4 v4, s[36:39], s43 offen offset:3072 lds
  s_add_u32 s43, s43, 4096
  s_add_u32 m0, s47, 9216
  s_nop 0
  buffer_load_dwordx4 v4, s[36:39], s43 offen lds
  s_add_u32 s43, s48, 5120
  buffer_load_dwordx4 v[224:227], v4, s[36:39], s43 offen sc1
  s_add_u32 s43, s49, 5120
  buffer_load_dwordx4 v[228:231], v4, s[36:39], s43 offen sc1
  s_add_u32 s43, s50, 5120
  buffer_load_dwordx4 v[232:235], v4, s[36:39], s43 offen sc1
  s_add_u32 s43, s51, 5120
  buffer_load_dwordx4 v[236:239], v4, s[36:39], s43 offen sc1
  s_waitcnt vmcnt(34)
  s_waitcnt lgkmcnt(15)
  v_mfma_f32_16x16x32_bf16 v[24:27], v[104:107], v[176:179], v[24:27]
  v_mfma_f32_16x16x32_bf16 v[28:31], v[104:107], v[180:183], v[28:31]
  v_mfma_f32_16x16x32_bf16 v[32:35], v[104:107], v[184:187], v[32:35]
  v_mfma_f32_16x16x32_bf16 v[36:39], v[104:107], v[188:191], v[36:39]
  v_mfma_f32_16x16x32_bf16 v[40:43], v[108:111], v[176:179], v[40:43]
  v_mfma_f32_16x16x32_bf16 v[44:47], v[108:111], v[180:183], v[44:47]
  v_mfma_f32_16x16x32_bf16 v[48:51], v[108:111], v[184:187], v[48:51]
  v_mfma_f32_16x16x32_bf16 v[52:55], v[108:111], v[188:191], v[52:55]
  s_waitcnt lgkmcnt(14)
  v_mfma_f32_16x16x32_bf16 v[56:59], v[112:115], v[176:179], v[56:59]
  v_mfma_f32_16x16x32_bf16 v[60:63], v[112:115], v[180:183], v[60:63]
  v_mfma_f32_16x16x32_bf16 v[64:67], v[112:115], v[184:187], v[64:67]
  v_mfma_f32_16x16x32_bf16 v[68:71], v[112:115], v[188:191], v[68:71]
  s_waitcnt lgkmcnt(12)
  v_mfma_f32_16x16x32_bf16 v[72:75], v[116:119], v[176:179], v[72:75]
  v_mfma_f32_16x16x32_bf16 v[76:79], v[116:119], v[180:183], v[76:79]
  v_mfma_f32_16x16x32_bf16 v[80:83], v[116:119], v[184:187], v[80:83]
  v_mfma_f32_16x16x32_bf16 v[84:87], v[116:119], v[188:191], v[84:87]
  s_waitcnt lgkmcnt(10)
  v_mfma_f32_16x16x32_bf16 v[88:91], v[120:123], v[176:179], v[88:91]
  v_mfma_f32_16x16x32_bf16 v[92:95], v[120:123], v[180:183], v[92:95]
  v_mfma_f32_16x16x32_bf16 v[96:99], v[120:123], v[184:187], v[96:99]
  v_mfma_f32_16x16x32_bf16 v[100:103], v[120:123], v[188:191], v[100:103]
  s_waitcnt vmcnt(25)
  ds_read_b64_tr_b16 v[104:105], v10 offset:0
  ds_read_b64_tr_b16 v[106:107], v10 offset:2560
  ds_read_b64_tr_b16 v[108:109], v10 offset:32
  ds_read_b64_tr_b16 v[110:111], v10 offset:2592
  ds_read_b64_tr_b16 v[112:113], v10 offset:64
  ds_read_b64_tr_b16 v[114:115], v10 offset:2624
  ds_read_b64_tr_b16 v[116:117], v10 offset:96
  ds_read_b64_tr_b16 v[118:119], v10 offset:2656
  ds_read_b64_tr_b16 v[120:121], v10 offset:128
  ds_read_b64_tr_b16 v[122:123], v10 offset:2688
  s_add_u32 s43, s57, 30720
  s_add_u32 m0, s47, 10240
  s_nop 0
  buffer_load_dwordx4 v4, s[36:39], s43 offen offset:0 lds
  buffer_load_dwordx4 v4, s[36:39], s43 offen offset:1024 lds
  buffer_load_dwordx4 v4, s[36:39], s43 offen offset:2048 lds
  buffer_load_dwordx4 v4, s[36:39], s43 offen offset:3072 lds
  s_add_u32 s43, s43, 4096
  s_add_u32 m0, s47, 14336
  s_nop 0
  buffer_load_dwordx4 v4, s[36:39], s43 offen lds
  s_add_u32 s43, s48, 6144
  buffer_load_dwordx4 v[240:243], v4, s[36:39], s43 offen sc1
  s_add_u32 s43, s49, 6144
  buffer_load_dwordx4 v[244:247], v4, s[36:39], s43 offen sc1
  s_add_u32 s43, s50, 6144
  buffer_load_dwordx4 v[248:251], v4, s[36:39], s43 offen sc1
  s_add_u32 s43, s51, 6144
  buffer_load_dwordx4 v[252:255], v4, s[36:39], s43 offen sc1
  s_waitcnt lgkmcnt(15)
  v_mfma_f32_16x16x32_bf16 v[24:27], v[124:127], v[192:195], v[24:27]
  v_mfma_f32_16x16x32_bf16 v[28:31], v[124:127], v[196:199], v[28:31]
  v_mfma_f32_16x16x32_bf16 v[32:35], v[124:127], v[200:203], v[32:35]
  v_mfma_f32_16x16x32_bf16 v[36:39], v[124:127], v[204:207], v[36:39]
  v_mfma_f32_16x16x32_bf16 v[40:43], v[128:131], v[192:195], v[40:43]
  v_mfma_f32_16x16x32_bf16 v[44:47], v[128:131], v[196:199], v[44:47]
  v_mfma_f32_16x16x32_bf16 v[48:51], v[128:131], v[200:203], v[48:51]
  v_mfma_f32_16x16x32_bf16 v[52:55], v[128:131], v[204:207], v[52:55]
  s_waitcnt lgkmcnt(14)
  v_mfma_f32_16x16x32_bf16 v[56:59], v[132:135], v[192:195], v[56:59]
  v_mfma_f32_16x16x32_bf16 v[60:63], v[132:135], v[196:199], v[60:63]
  v_mfma_f32_16x16x32_bf16 v[64:67], v[132:135], v[200:203], v[64:67]
  v_mfma_f32_16x16x32_bf16 v[68:71], v[132:135], v[204:207], v[68:71]
  s_waitcnt lgkmcnt(12)
  v_mfma_f32_16x16x32_bf16 v[72:75], v[136:139], v[192:195], v[72:75]
  v_mfma_f32_16x16x32_bf16 v[76:79], v[136:139], v[196:199], v[76:79]
  v_mfma_f32_16x16x32_bf16 v[80:83], v[136:139], v[200:203], v[80:83]
  v_mfma_f32_16x16x32_bf16 v[84:87], v[136:139], v[204:207], v[84:87]
  s_waitcnt lgkmcnt(10)
  v_mfma_f32_16x16x32_bf16 v[88:91], v[140:143], v[192:195], v[88:91]
  v_mfma_f32_16x16x32_bf16 v[92:95], v[140:143], v[196:199], v[92:95]
  v_mfma_f32_16x16x32_bf16 v[96:99], v[140:143], v[200:203], v[96:99]
  v_mfma_f32_16x16x32_bf16 v[100:103], v[140:143], v[204:207], v[100:103]
  s_setprio 2
  s_waitcnt vmcnt(13)
  ds_read_b64_tr_b16 v[124:125], v10 offset:5120
  ds_read_b64_tr_b16 v[126:127], v10 offset:7680
  ds_read_b64_tr_b16 v[128:129], v10 offset:5152
  ds_read_b64_tr_b16 v[130:131], v10 offset:7712
  ds_read_b64_tr_b16 v[132:133], v10 offset:5184
  ds_read_b64_tr_b16 v[134:135], v10 offset:7744
  ds_read_b64_tr_b16 v[136:137], v10 offset:5216
  ds_read_b64_tr_b16 v[138:139], v10 offset:7776
  ds_read_b64_tr_b16 v[140:141], v10 offset:5248
  ds_read_b64_tr_b16 v[142:143], v10 offset:7808
  s_add_u32 s43, s57, 35840
  s_add_u32 m0, s47, 15360
  s_nop 0
  buffer_load_dwordx4 v4, s[36:39], s43 offen offset:0 lds
  buffer_load_dwordx4 v4, s[36:39], s43 offen offset:1024 lds
  buffer_load_dwordx4 v4, s[36:39], s43 offen offset:2048 lds
  buffer_load_dwordx4 v4, s[36:39], s43 offen offset:3072 lds
  s_add_u32 s43, s43, 4096
  s_add_u32 m0, s47, 19456
  s_nop 0
  buffer_load_dwordx4 v4, s[36:39], s43 offen lds
  s_add_u32 s43, s48, 7168
  buffer_load_dwordx4 v[144:147], v4, s[36:39], s43 offen sc1
  s_add_u32 s43, s49, 7168
  buffer_load_dwordx4 v[148:151], v4, s[36:39], s43 offen sc1
  s_add_u32 s43, s50, 7168
  buffer_load_dwordx4 v[152:155], v4, s[36:39], s43 offen sc1
  s_add_u32 s43, s51, 7168
  buffer_load_dwordx4 v[156:159], v4, s[36:39], s43 offen sc1
  s_waitcnt lgkmcnt(15)
  v_mfma_f32_16x16x32_bf16 v[24:27], v[104:107], v[208:211], v[24:27]
  v_mfma_f32_16x16x32_bf16 v[28:31], v[104:107], v[212:215], v[28:31]
  v_mfma_f32_16x16x32_bf16 v[32:35], v[104:107], v[216:219], v[32:35]
  v_mfma_f32_16x16x32_bf16 v[36:39], v[104:107], v[220:223], v[36:39]
  v_mfma_f32_16x16x32_bf16 v[40:43], v[108:111], v[208:211], v[40:43]
  v_mfma_f32_16x16x32_bf16 v[44:47], v[108:111], v[212:215], v[44:47]
  v_mfma_f32_16x16x32_bf16 v[48:51], v[108:111], v[216:219], v[48:51]
  v_mfma_f32_16x16x32_bf16 v[52:55], v[108:111], v[220:223], v[52:55]
  s_waitcnt lgkmcnt(14)
  v_mfma_f32_16x16x32_bf16 v[56:59], v[112:115], v[208:211], v[56:59]
  v_mfma_f32_16x16x32_bf16 v[60:63], v[112:115], v[212:215], v[60:63]
  v_mfma_f32_16x16x32_bf16 v[64:67], v[112:115], v[216:219], v[64:67]
  v_mfma_f32_16x16x32_bf16 v[68:71], v[112:115], v[220:223], v[68:71]
  s_waitcnt lgkmcnt(12)
  v_mfma_f32_16x16x32_bf16 v[72:75], v[116:119], v[208:211], v[72:75]
  v_mfma_f32_16x16x32_bf16 v[76:79], v[116:119], v[212:215], v[76:79]
  v_mfma_f32_16x16x32_bf16 v[80:83], v[116:119], v[216:219], v[80:83]
  v_mfma_f32_16x16x32_bf16 v[84:87], v[116:119], v[220:223], v[84:87]
  s_waitcnt lgkmcnt(10)
  v_mfma_f32_16x16x32_bf16 v[88:91], v[120:123], v[208:211], v[88:91]
  v_mfma_f32_16x16x32_bf16 v[92:95], v[120:123], v[212:215], v[92:95]
  v_mfma_f32_16x16x32_bf16 v[96:99], v[120:123], v[216:219], v[96:99]
  v_mfma_f32_16x16x32_bf16 v[100:103], v[120:123], v[220:223], v[100:103]
  s_waitcnt vmcnt(13)
  ds_read_b64_tr_b16 v[104:105], v10 offset:10240
  ds_read_b64_tr_b16 v[106:107], v10 offset:12800
  ds_read_b64_tr_b16 v[108:109], v10 offset:10272
  ds_read_b64_tr_b16 v[110:111], v10 offset:12832
  ds_read_b64_tr_b16 v[112:113], v10 offset:10304
  ds_read_b64_tr_b16 v[114:115], v10 offset:12864
  ds_read_b64_tr_b16 v[116:117], v10 offset:10336
  ds_read_b64_tr_b16 v[118:119], v10 offset:12896
  ds_read_b64_tr_b16 v[120:121], v10 offset:10368
  ds_read_b64_tr_b16 v[122:123], v10 offset:12928
  s_add_u32 s43, s57, 40960
  s_add_u32 m0, s47, 0
  s_nop 0
  buffer_load_dwordx4 v4, s[36:39], s43 offen offset:0 lds
  buffer_load_dwordx4 v4, s[36:39], s43 offen offset:1024 lds
  buffer_load_dwordx4 v4, s[36:39], s43 offen offset:2048 lds
  buffer_load_dwordx4 v4, s[36:39], s43 offen offset:3072 lds
  s_add_u32 s43, s43, 4096
  s_add_u32 m0, s47, 4096
  s_nop 0
  buffer_load_dwordx4 v4, s[36:39], s43 offen lds
  s_add_u32 s43, s48, 8192
  buffer_load_dwordx4 v[160:163], v4, s[36:39], s43 offen sc1
  s_add_u32 s43, s49, 8192
  buffer_load_dwordx4 v[164:167], v4, s[36:39], s43 offen sc1
  s_add_u32 s43, s50, 8192
  buffer_load_dwordx4 v[168:171], v4, s[36:39], s43 offen sc1
  s_add_u32 s43, s51, 8192
  buffer_load_dwordx4 v[172:175], v4, s[36:39], s43 offen sc1
  s_waitcnt lgkmcnt(15)
  v_mfma_f32_16x16x32_bf16 v[24:27], v[124:127], v[224:227], v[24:27]
  v_mfma_f32_16x16x32_bf16 v[28:31], v[124:127], v[228:231], v[28:31]
  v_mfma_f32_16x16x32_bf16 v[32:35], v[124:127], v[232:235], v[32:35]
  v_mfma_f32_16x16x32_bf16 v[36:39], v[124:127], v[236:239], v[36:39]
  v_mfma_f32_16x16x32_bf16 v[40:43], v[128:131], v[224:227], v[40:43]
  v_mfma_f32_16x16x32_bf16 v[44:47], v[128:131], v[228:231], v[44:47]
  v_mfma_f32_16x16x32_bf16 v[48:51], v[128:131], v[232:235], v[48:51]
  v_mfma_f32_16x16x32_bf16 v[52:55], v[128:131], v[236:239], v[52:55]
  s_waitcnt lgkmcnt(14)
  v_mfma_f32_16x16x32_bf16 v[56:59], v[132:135], v[224:227], v[56:59]
  v_mfma_f32_16x16x32_bf16 v[60:63], v[132:135], v[228:231], v[60:63]
  v_mfma_f32_16x16x32_bf16 v[64:67], v[132:135], v[232:235], v[64:67]
  v_mfma_f32_16x16x32_bf16 v[68:71], v[132:135], v[236:239], v[68:71]
  s_waitcnt lgkmcnt(12)
  v_mfma_f32_16x16x32_bf16 v[72:75], v[136:139], v[224:227], v[72:75]
  v_mfma_f32_16x16x32_bf16 v[76:79], v[136:139], v[228:231], v[76:79]
  v_mfma_f32_16x16x32_bf16 v[80:83], v[136:139], v[232:235], v[80:83]
  v_mfma_f32_16x16x32_bf16 v[84:87], v[136:139], v[236:239], v[84:87]
  s_waitcnt lgkmcnt(10)
  v_mfma_f32_16x16x32_bf16 v[88:91], v[140:143], v[224:227], v[88:91]
  v_mfma_f32_16x16x32_bf16 v[92:95], v[140:143], v[228:231], v[92:95]
  v_mfma_f32_16x16x32_bf16 v[96:99], v[140:143], v[232:235], v[96:99]
  v_mfma_f32_16x16x32_bf16 v[100:103], v[140:143], v[236:239], v[100:103]
  s_waitcnt vmcnt(13)
  ds_read_b64_tr_b16 v[124:125], v10 offset:15360
  ds_read_b64_tr_b16 v[126:127], v10 offset:17920
  ds_read_b64_tr_b16 v[128:129], v10 offset:15392
  ds_read_b64_tr_b16 v[130:131], v10 offset:17952
  ds_read_b64_tr_b16 v[132:133], v10 offset:15424
  ds_read_b64_tr_b16 v[134:135], v10 offset:17984
  ds_read_b64_tr_b16 v[136:137], v10 offset:15456
  ds_read_b64_tr_b16 v[138:139], v10 offset:18016
  ds_read_b64_tr_b16 v[140:141], v10 offset:15488
  ds_read_b64_tr_b16 v[142:143], v10 offset:18048
  s_add_u32 s43, s57, 46080
  s_add_u32 m0, s47, 5120
  s_nop 0
  buffer_load_dwordx4 v4, s[36:39], s43 offen offset:0 lds
  buffer_load_dwordx4 v4, s[36:39], s43 offen offset:1024 lds
  buffer_load_dwordx4 v4, s[36:39], s43 offen offset:2048 lds
  buffer_load_dwordx4 v4, s[36:39], s43 offen offset:3072 lds
  s_add_u32 s43, s43, 4096
  s_add_u32 m0, s47, 9216
  s_nop 0
  buffer_load_dwordx4 v4, s[36:39], s43 offen lds
  s_add_u32 s43, s48, 9216
  buffer_load_dword v176, v5, s[36:39], s43 offen offset:0 sc1
  buffer_load_dword v177, v5, s[36:39], s43 offen offset:256 sc1
  buffer_load_dword v178, v5, s[36:39], s43 offen offset:512 sc1
  buffer_load_dword v179, v5, s[36:39], s43 offen offset:768 sc1
  s_add_u32 s43, s49, 9216
  buffer_load_dword v180, v5, s[36:39], s43 offen offset:0 sc1
  buffer_load_dword v181, v5, s[36:39], s43 offen offset:256 sc1
  buffer_load_dword v182, v5, s[36:39], s43 offen offset:512 sc1
  buffer_load_dword v183, v5, s[36:39], s43 offen offset:768 sc1
  s_add_u32 s43, s50, 9216
  buffer_load_dword v184, v5, s[36:39], s43 offen offset:0 sc1
  buffer_load_dword v185, v5, s[36:39], s43 offen offset:256 sc1
  buffer_load_dword v186, v5, s[36:39], s43 offen offset:512 sc1
  buffer_load_dword v187, v5, s[36:39], s43 offen offset:768 sc1
  s_add_u32 s43, s51, 9216
  buffer_load_dword v188, v5, s[36:39], s43 offen offset:0 sc1
  buffer_load_dword v189, v5, s[36:39], s43 offen offset:256 sc1
  buffer_load_dword v190, v5, s[36:39], s43 offen offset:512 sc1
  buffer_load_dword v191, v5, s[36:39], s43 offen offset:768 sc1
  s_waitcnt lgkmcnt(15)
  v_mfma_f32_16x16x32_bf16 v[24:27], v[104:107], v[240:243], v[24:27]
  v_mfma_f32_16x16x32_bf16 v[28:31], v[104:107], v[244:247], v[28:31]
  v_mfma_f32_16x16x32_bf16 v[32:35], v[104:107], v[248:251], v[32:35]
  v_mfma_f32_16x16x32_bf16 v[36:39], v[104:107], v[252:255], v[36:39]
  v_mfma_f32_16x16x32_bf16 v[40:43], v[108:111], v[240:243], v[40:43]
  v_mfma_f32_16x16x32_bf16 v[44:47], v[108:111], v[244:247], v[44:47]
  v_mfma_f32_16x16x32_bf16 v[48:51], v[108:111], v[248:251], v[48:51]
  v_mfma_f32_16x16x32_bf16 v[52:55], v[108:111], v[252:255], v[52:55]
  s_waitcnt lgkmcnt(14)
  v_mfma_f32_16x16x32_bf16 v[56:59], v[112:115], v[240:243], v[56:59]
  v_mfma_f32_16x16x32_bf16 v[60:63], v[112:115], v[244:247], v[60:63]
  v_mfma_f32_16x16x32_bf16 v[64:67], v[112:115], v[248:251], v[64:67]
  v_mfma_f32_16x16x32_bf16 v[68:71], v[112:115], v[252:255], v[68:71]
  s_waitcnt lgkmcnt(12)
  v_mfma_f32_16x16x32_bf16 v[72:75], v[116:119], v[240:243], v[72:75]
  v_mfma_f32_16x16x32_bf16 v[76:79], v[116:119], v[244:247], v[76:79]
  v_mfma_f32_16x16x32_bf16 v[80:83], v[116:119], v[248:251], v[80:83]
  v_mfma_f32_16x16x32_bf16 v[84:87], v[116:119], v[252:255], v[84:87]
  s_waitcnt lgkmcnt(10)
  v_mfma_f32_16x16x32_bf16 v[88:91], v[120:123], v[240:243], v[88:91]
  v_mfma_f32_16x16x32_bf16 v[92:95], v[120:123], v[244:247], v[92:95]
  v_mfma_f32_16x16x32_bf16 v[96:99], v[120:123], v[248:251], v[96:99]
  v_mfma_f32_16x16x32_bf16 v[100:103], v[120:123], v[252:255], v[100:103]
  s_setprio 1
  s_waitcnt vmcnt(25)
  ds_read_b64_tr_b16 v[104:105], v10 offset:0
  ds_read_b64_tr_b16 v[106:107], v10 offset:2560
  ds_read_b64_tr_b16 v[108:109], v10 offset:32
  ds_read_b64_tr_b16 v[110:111], v10 offset:2592
  ds_read_b64_tr_b16 v[112:113], v10 offset:64
  ds_read_b64_tr_b16 v[114:115], v10 offset:2624
  ds_read_b64_tr_b16 v[116:117], v10 offset:96
  ds_read_b64_tr_b16 v[118:119], v10 offset:2656
  ds_read_b64_tr_b16 v[120:121], v10 offset:128
  ds_read_b64_tr_b16 v[122:123], v10 offset:2688
  s_waitcnt lgkmcnt(15)
  v_mfma_f32_16x16x32_bf16 v[24:27], v[124:127], v[144:147], v[24:27]
  v_mfma_f32_16x16x32_bf16 v[28:31], v[124:127], v[148:151], v[28:31]
  v_mfma_f32_16x16x32_bf16 v[32:35], v[124:127], v[152:155], v[32:35]
  v_mfma_f32_16x16x32_bf16 v[36:39], v[124:127], v[156:159], v[36:39]
  v_mfma_f32_16x16x32_bf16 v[40:43], v[128:131], v[144:147], v[40:43]
  v_mfma_f32_16x16x32_bf16 v[44:47], v[128:131], v[148:151], v[44:47]
  v_mfma_f32_16x16x32_bf16 v[48:51], v[128:131], v[152:155], v[48:51]
  v_mfma_f32_16x16x32_bf16 v[52:55], v[128:131], v[156:159], v[52:55]
  s_waitcnt lgkmcnt(14)
  v_mfma_f32_16x16x32_bf16 v[56:59], v[132:135], v[144:147], v[56:59]
  v_mfma_f32_16x16x32_bf16 v[60:63], v[132:135], v[148:151], v[60:63]
  v_mfma_f32_16x16x32_bf16 v[64:67], v[132:135], v[152:155], v[64:67]
  v_mfma_f32_16x16x32_bf16 v[68:71], v[132:135], v[156:159], v[68:71]
  s_waitcnt lgkmcnt(12)
  v_mfma_f32_16x16x32_bf16 v[72:75], v[136:139], v[144:147], v[72:75]
  v_mfma_f32_16x16x32_bf16 v[76:79], v[136:139], v[148:151], v[76:79]
  v_mfma_f32_16x16x32_bf16 v[80:83], v[136:139], v[152:155], v[80:83]
  v_mfma_f32_16x16x32_bf16 v[84:87], v[136:139], v[156:159], v[84:87]
  s_waitcnt lgkmcnt(10)
  v_mfma_f32_16x16x32_bf16 v[88:91], v[140:143], v[144:147], v[88:91]
  v_mfma_f32_16x16x32_bf16 v[92:95], v[140:143], v[148:151], v[92:95]
  v_mfma_f32_16x16x32_bf16 v[96:99], v[140:143], v[152:155], v[96:99]
  v_mfma_f32_16x16x32_bf16 v[100:103], v[140:143], v[156:159], v[100:103]
  s_waitcnt vmcnt(16)
  ds_read_b64_tr_b16 v[124:125], v10 offset:5120
  ds_read_b64_tr_b16 v[126:127], v10 offset:7680
  ds_read_b64_tr_b16 v[128:129], v10 offset:5152
  ds_read_b64_tr_b16 v[130:131], v10 offset:7712
  ds_read_b64_tr_b16 v[132:133], v10 offset:5184
  ds_read_b64_tr_b16 v[134:135], v10 offset:7744
  ds_read_b64_tr_b16 v[136:137], v10 offset:5216
  ds_read_b64_tr_b16 v[138:139], v10 offset:7776
  ds_read_b64_tr_b16 v[140:141], v10 offset:5248
  ds_read_b64_tr_b16 v[142:143], v10 offset:7808
  s_waitcnt lgkmcnt(15)
  v_mfma_f32_16x16x32_bf16 v[24:27], v[104:107], v[160:163], v[24:27]
  v_mfma_f32_16x16x32_bf16 v[28:31], v[104:107], v[164:167], v[28:31]
  v_mfma_f32_16x16x32_bf16 v[32:35], v[104:107], v[168:171], v[32:35]
  v_mfma_f32_16x16x32_bf16 v[36:39], v[104:107], v[172:175], v[36:39]
  v_mfma_f32_16x16x32_bf16 v[40:43], v[108:111], v[160:163], v[40:43]
  v_mfma_f32_16x16x32_bf16 v[44:47], v[108:111], v[164:167], v[44:47]
  v_mfma_f32_16x16x32_bf16 v[48:51], v[108:111], v[168:171], v[48:51]
  v_mfma_f32_16x16x32_bf16 v[52:55], v[108:111], v[172:175], v[52:55]
  s_waitcnt lgkmcnt(14)
  v_mfma_f32_16x16x32_bf16 v[56:59], v[112:115], v[160:163], v[56:59]
  v_mfma_f32_16x16x32_bf16 v[60:63], v[112:115], v[164:167], v[60:63]
  v_mfma_f32_16x16x32_bf16 v[64:67], v[112:115], v[168:171], v[64:67]
  v_mfma_f32_16x16x32_bf16 v[68:71], v[112:115], v[172:175], v[68:71]
  s_waitcnt lgkmcnt(12)
  v_mfma_f32_16x16x32_bf16 v[72:75], v[116:119], v[160:163], v[72:75]
  v_mfma_f32_16x16x32_bf16 v[76:79], v[116:119], v[164:167], v[76:79]
  v_mfma_f32_16x16x32_bf16 v[80:83], v[116:119], v[168:171], v[80:83]
  v_mfma_f32_16x16x32_bf16 v[84:87], v[116:119], v[172:175], v[84:87]
  s_waitcnt lgkmcnt(10)
  v_mfma_f32_16x16x32_bf16 v[88:91], v[120:123], v[160:163], v[88:91]
  v_mfma_f32_16x16x32_bf16 v[92:95], v[120:123], v[164:167], v[92:95]
  v_mfma_f32_16x16x32_bf16 v[96:99], v[120:123], v[168:171], v[96:99]
  v_mfma_f32_16x16x32_bf16 v[100:103], v[120:123], v[172:175], v[100:103]
  s_waitcnt vmcnt(0)
  s_waitcnt lgkmcnt(8)
  v_mfma_f32_16x16x32_bf16 v[24:27], v[124:127], v[176:179], v[24:27]
  v_mfma_f32_16x16x32_bf16 v[28:31], v[124:127], v[180:183], v[28:31]
  v_mfma_f32_16x16x32_bf16 v[32:35], v[124:127], v[184:187], v[32:35]
  v_mfma_f32_16x16x32_bf16 v[36:39], v[124:127], v[188:191], v[36:39]
  s_waitcnt lgkmcnt(6)
  v_mfma_f32_16x16x32_bf16 v[40:43], v[128:131], v[176:179], v[40:43]
  v_mfma_f32_16x16x32_bf16 v[44:47], v[128:131], v[180:183], v[44:47]
  v_mfma_f32_16x16x32_bf16 v[48:51], v[128:131], v[184:187], v[48:51]
  v_mfma_f32_16x16x32_bf16 v[52:55], v[128:131], v[188:191], v[52:55]
  s_waitcnt lgkmcnt(4)
  v_mfma_f32_16x16x32_bf16 v[56:59], v[132:135], v[176:179], v[56:59]
  v_mfma_f32_16x16x32_bf16 v[60:63], v[132:135], v[180:183], v[60:63]
  v_mfma_f32_16x16x32_bf16 v[64:67], v[132:135], v[184:187], v[64:67]
  v_mfma_f32_16x16x32_bf16 v[68:71], v[132:135], v[188:191], v[68:71]
  s_waitcnt lgkmcnt(2)
  v_mfma_f32_16x16x32_bf16 v[72:75], v[136:139], v[176:179], v[72:75]
  v_mfma_f32_16x16x32_bf16 v[76:79], v[136:139], v[180:183], v[76:79]
  v_mfma_f32_16x16x32_bf16 v[80:83], v[136:139], v[184:187], v[80:83]
  v_mfma_f32_16x16x32_bf16 v[84:87], v[136:139], v[188:191], v[84:87]
  s_waitcnt lgkmcnt(0)
  v_mfma_f32_16x16x32_bf16 v[88:91], v[140:143], v[176:179], v[88:91]
  v_mfma_f32_16x16x32_bf16 v[92:95], v[140:143], v[180:183], v[92:95]
  v_mfma_f32_16x16x32_bf16 v[96:99], v[140:143], v[184:187], v[96:99]
  v_mfma_f32_16x16x32_bf16 v[100:103], v[140:143], v[188:191], v[100:103]
L_k2_fin:
  s_nop 11
  s_waitcnt vmcnt(0) lgkmcnt(0)
  v_add_u32 v12, s47, v4
  ds_write_b128 v12, v[24:27] offset:0
  ds_write_b128 v12, v[40:43] offset:1024
  ds_write_b128 v12, v[56:59] offset:2048
  ds_write_b128 v12, v[72:75] offset:3072
  ds_write_b128 v12, v[88:91] offset:4096
  ds_write_b128 v12, v[28:31] offset:5120
  ds_write_b128 v12, v[44:47] offset:6144
  ds_write_b128 v12, v[60:63] offset:7168
  ds_write_b128 v12, v[76:79] offset:8192
  ds_write_b128 v12, v[92:95] offset:9216
  ds_write_b128 v12, v[32:35] offset:10240
  ds_write_b128 v12, v[48:51] offset:11264
  ds_write_b128 v12, v[64:67] offset:12288
  ds_write_b128 v12, v[80:83] offset:13312
  ds_write_b128 v12, v[96:99] offset:14336
  ds_write_b128 v12, v[36:39] offset:15360
  ds_write_b128 v12, v[52:55] offset:16384
  ds_write_b128 v12, v[68:71] offset:17408
  ds_write_b128 v12, v[84:87] offset:18432
  ds_write_b128 v12, v[100:103] offset:19456
  s_mov_b32 s20, s4
  s_and_b32 s21, s5, 0xffff
  s_mov_b32 s22, 0x280000
  s_mov_b32 s23, 0x20000
  s_mov_b32 s32, s8
  s_and_b32 s33, s9, 0xffff
  s_mov_b32 s34, 0x280000
  s_mov_b32 s35, 0x20000
  s_and_b32 s44, s42, 3
  s_lshr_b32 s58, s42, 2
  s_mul_i32 s58, s58, 3
  s_lshl_b32 s43, s40, 6
  s_lshl_b32 s45, s44, 4
  s_add_u32 s43, s43, s45
  s_mul_i32 s43, s43, 1280
  s_mul_i32 s45, s41, 160
  s_add_u32 s45, s43, s45
  s_lshl_b32 s43, s58, 5
  s_add_u32 s45, s45, s43
  v_mul_u32_u24 v11, 1280, v2
  v_lshl_add_u32 v11, v3, 3, v11
  v_mov_b32 v14, 0x7ffffff0
  s_cmp_lt_u32 s42, 4
  s_cselect_b64 vcc, -1, 0
  v_cndmask_b32 v14, v14, v11, vcc
  buffer_load_dwordx2 v[104:105], v11, s[20:23], s45 offen offset:0
  buffer_load_dwordx2 v[106:107], v11, s[20:23], s45 offen offset:32
  buffer_load_dwordx2 v[108:109], v14, s[20:23], s45 offen offset:64
  s_mul_i32 s43, s44, 5120
  s_lshl_b32 s58, s58, 10
  s_add_u32 s43, s43, s58
  v_add_u32 v13, s43, v4
  v_add_u32 v15, 61440, v13
  v_add_u32 v16, 122880, v13
  s_waitcnt lgkmcnt(0)
  s_barrier
  ds_read_b128 v[112:115], v13 offset:0
  ds_read_b128 v[116:119], v13 offset:20480
  ds_read_b128 v[120:123], v13 offset:40960
  ds_read_b128 v[124:127], v15 offset:0
  ds_read_b128 v[128:131], v15 offset:20480
  ds_read_b128 v[132:135], v15 offset:40960
  ds_read_b128 v[136:139], v16 offset:0
  ds_read_b128 v[140:143], v16 offset:20480
  ds_read_b128 v[144:147], v13 offset:1024
  ds_read_b128 v[148:151], v13 offset:21504
  ds_read_b128 v[152:155], v13 offset:41984
  ds_read_b128 v[156:159], v15 offset:1024
  ds_read_b128 v[160:163], v15 offset:21504
  ds_read_b128 v[164:167], v15 offset:41984
  ds_read_b128 v[168:171], v16 offset:1024
  ds_read_b128 v[172:175], v16 offset:21504
  ds_read_b128 v[176:179], v13 offset:2048
  ds_read_b128 v[180:183], v13 offset:22528
  ds_read_b128 v[184:187], v13 offset:43008
  ds_read_b128 v[188:191], v15 offset:2048
  ds_read_b128 v[192:195], v15 offset:22528
  ds_read_b128 v[196:199], v15 offset:43008
  ds_read_b128 v[200:203], v16 offset:2048
  ds_read_b128 v[204:207], v16 offset:22528
  s_waitcnt vmcnt(0)
  s_waitcnt lgkmcnt(15)
  v_add_f32 v112, v112, v116
  v_add_f32 v120, v120, v124
  v_add_f32 v128, v128, v132
  v_add_f32 v136, v136, v140
  v_add_f32 v113, v113, v117
  v_add_f32 v121, v121, v125
  v_add_f32 v129, v129, v133
  v_add_f32 v137, v137, v141
  v_add_f32 v114, v114, v118
  v_add_f32 v122, v122, v126
  v_add_f32 v130, v130, v134
  v_add_f32 v138, v138, v142
  v_add_f32 v115, v115, v119
  v_add_f32 v123, v123, v127
  v_add_f32 v131, v131, v135
  v_add_f32 v139, v139, v143
  v_add_f32 v112, v112, v120
  v_add_f32 v113, v113, v121
  v_add_f32 v114, v114, v122
  v_add_f32 v115, v115, v123
  v_add_f32 v112, v112, v128
  v_add_f32 v113, v113, v129
  v_add_f32 v114, v114, v130
  v_add_f32 v115, v115, v131
  v_mul_f32 v116, s46, v112
  v_mul_f32 v117, s46, v113
  v_mul_f32 v118, s46, v114
  v_mul_f32 v119, s46, v115
  v_exp_f32 v116, -v116
  v_exp_f32 v117, -v117
  v_exp_f32 v118, -v118
  v_exp_f32 v119, -v119
  v_add_f32 v116, 1.0, v116
  v_add_f32 v117, 1.0, v117
  v_add_f32 v118, 1.0, v118
  v_add_f32 v119, 1.0, v119
  v_rcp_f32 v116, v116
  v_rcp_f32 v117, v117
  v_rcp_f32 v118, v118
  v_rcp_f32 v119, v119
  v_mul_f32 v116, v116, v112
  v_mul_f32 v117, v117, v113
  v_mul_f32 v118, v118, v114
  v_mul_f32 v119, v119, v115
  v_lshlrev_b32 v120, 16, v104
  v_and_b32 v121, 0xffff0000, v104
  v_lshlrev_b32 v122, 16, v105
  v_and_b32 v123, 0xffff0000, v105
  v_fma_f32 v116, v116, v136, v120
  v_fma_f32 v117, v117, v137, v121
  v_fma_f32 v118, v118, v138, v122
  v_fma_f32 v119, v119, v139, v123
  v_cvt_pk_bf16_f32 v116, v116, v117
  v_cvt_pk_bf16_f32 v117, v118, v119
  buffer_store_dwordx2 v[116:117], v11, s[32:35], s45 offen offset:0
  s_waitcnt lgkmcnt(8)
  v_add_f32 v144, v144, v148
  v_add_f32 v152, v152, v156
  v_add_f32 v160, v160, v164
  v_add_f32 v168, v168, v172
  v_add_f32 v145, v145, v149
  v_add_f32 v153, v153, v157
  v_add_f32 v161, v161, v165
  v_add_f32 v169, v169, v173
  v_add_f32 v146, v146, v150
  v_add_f32 v154, v154, v158
  v_add_f32 v162, v162, v166
  v_add_f32 v170, v170, v174
  v_add_f32 v147, v147, v151
  v_add_f32 v155, v155, v159
  v_add_f32 v163, v163, v167
  v_add_f32 v171, v171, v175
  v_add_f32 v144, v144, v152
  v_add_f32 v145, v145, v153
  v_add_f32 v146, v146, v154
  v_add_f32 v147, v147, v155
  v_add_f32 v144, v144, v160
  v_add_f32 v145, v145, v161
  v_add_f32 v146, v146, v162
  v_add_f32 v147, v147, v163
  v_mul_f32 v148, s46, v144
  v_mul_f32 v149, s46, v145
  v_mul_f32 v150, s46, v146
  v_mul_f32 v151, s46, v147
  v_exp_f32 v148, -v148
  v_exp_f32 v149, -v149
  v_exp_f32 v150, -v150
  v_exp_f32 v151, -v151
  v_add_f32 v148, 1.0, v148
  v_add_f32 v149, 1.0, v149
  v_add_f32 v150, 1.0, v150
  v_add_f32 v151, 1.0, v151
  v_rcp_f32 v148, v148
  v_rcp_f32 v149, v149
  v_rcp_f32 v150, v150
  v_rcp_f32 v151, v151
  v_mul_f32 v148, v148, v144
  v_mul_f32 v149, v149, v145
  v_mul_f32 v150, v150, v146
  v_mul_f32 v151, v151, v147
  v_lshlrev_b32 v152, 16, v106
  v_and_b32 v153, 0xffff0000, v106
  v_lshlrev_b32 v154, 16, v107
  v_and_b32 v155, 0xffff0000, v107
  v_fma_f32 v148, v148, v168, v152
  v_fma_f32 v149, v149, v169, v153
  v_fma_f32 v150, v150, v170, v154
  v_fma_f32 v151, v151, v171, v155
  v_cvt_pk_bf16_f32 v148, v148, v149
  v_cvt_pk_bf16_f32 v149, v150, v151
  buffer_store_dwordx2 v[148:149], v11, s[32:35], s45 offen offset:32
  s_waitcnt lgkmcnt(0)
  v_add_f32 v176, v176, v180
  v_add_f32 v184, v184, v188
  v_add_f32 v192, v192, v196
  v_add_f32 v200, v200, v204
  v_add_f32 v177, v177, v181
  v_add_f32 v185, v185, v189
  v_add_f32 v193, v193, v197
  v_add_f32 v201, v201, v205
  v_add_f32 v178, v178, v182
  v_add_f32 v186, v186, v190
  v_add_f32 v194, v194, v198
  v_add_f32 v202, v202, v206
  v_add_f32 v179, v179, v183
  v_add_f32 v187, v187, v191
  v_add_f32 v195, v195, v199
  v_add_f32 v203, v203, v207
  v_add_f32 v176, v176, v184
  v_add_f32 v177, v177, v185
  v_add_f32 v178, v178, v186
  v_add_f32 v179, v179, v187
  v_add_f32 v176, v176, v192
  v_add_f32 v177, v177, v193
  v_add_f32 v178, v178, v194
  v_add_f32 v179, v179, v195
  v_mul_f32 v180, s46, v176
  v_mul_f32 v181, s46, v177
  v_mul_f32 v182, s46, v178
  v_mul_f32 v183, s46, v179
  v_exp_f32 v180, -v180
  v_exp_f32 v181, -v181
  v_exp_f32 v182, -v182
  v_exp_f32 v183, -v183
  v_add_f32 v180, 1.0, v180
  v_add_f32 v181, 1.0, v181
  v_add_f32 v182, 1.0, v182
  v_add_f32 v183, 1.0, v183
  v_rcp_f32 v180, v180
  v_rcp_f32 v181, v181
  v_rcp_f32 v182, v182
  v_rcp_f32 v183, v183
  v_mul_f32 v180, v180, v176
  v_mul_f32 v181, v181, v177
  v_mul_f32 v182, v182, v178
  v_mul_f32 v183, v183, v179
  v_lshlrev_b32 v184, 16, v108
  v_and_b32 v185, 0xffff0000, v108
  v_lshlrev_b32 v186, 16, v109
  v_and_b32 v187, 0xffff0000, v109
  v_fma_f32 v180, v180, v200, v184
  v_fma_f32 v181, v181, v201, v185
  v_fma_f32 v182, v182, v202, v186
  v_fma_f32 v183, v183, v203, v187
  v_cvt_pk_bf16_f32 v180, v180, v181
  v_cvt_pk_bf16_f32 v181, v182, v183
  buffer_store_dwordx2 v[180:181], v14, s[32:35], s45 offen offset:64
L_k2_end:
  s_waitcnt vmcnt(0)
  s_endpgm
.section .rodata,"a"
.p2align 6
.amdhsa_kernel k1_kernel
  .amdhsa_next_free_vgpr 256
  .amdhsa_next_free_sgpr 102
  .amdhsa_accum_offset 256
  .amdhsa_group_segment_fixed_size 0
  .amdhsa_kernarg_size 88
  .amdhsa_user_sgpr_count 2
  .amdhsa_user_sgpr_kernarg_segment_ptr 1
  .amdhsa_system_sgpr_workgroup_id_x 1
.end_amdhsa_kernel
.p2align 6
.amdhsa_kernel k2_kernel
  .amdhsa_next_free_vgpr 256
  .amdhsa_next_free_sgpr 102
  .amdhsa_accum_offset 256
  .amdhsa_group_segment_fixed_size 0
  .amdhsa_kernarg_size 88
  .amdhsa_user_sgpr_count 2
  .amdhsa_user_sgpr_kernarg_segment_ptr 1
  .amdhsa_system_sgpr_workgroup_id_x 1
.end_amdhsa_kernel
```
